```python
import torch

def _softmax(x, axis=-1):
    return torch.softmax(x, dim=axis)
def _gelu(x):
    return torch.nn.functional.gelu(x, approximate="tanh")
def _silu(x):
    return torch.nn.functional.silu(x)
def _sigmoid(x):
    return torch.sigmoid(x)
def _layernorm(x, axis=-1, eps=1e-5):
    m = x.mean(dim=axis, keepdim=True)
    v = x.var(dim=axis, keepdim=True, unbiased=False)
    return (x - m) / torch.sqrt(v + eps)
def _scatter_add(tgt, idx, src, axis=0):
    return tgt.clone().index_add_(axis, idx, src)
def _segment_sum(src, seg, n):
    out = torch.zeros((n,) + src.shape[1:], dtype=src.dtype)
    return out.index_add_(0, seg, src)
def _pad(x, pw):
    flat = tuple(v for pair in reversed(pw) for v in pair)
    return torch.nn.functional.pad(x, flat)

kernel_name = 'interleave_layers__sliding_local_dilated__swiglu_ffn__prompt'

def setup_inputs():

    _w = (lambda a: (lambda t: t.to(torch.bfloat16) if t.is_floating_point() else t)(torch.as_tensor(a)))
    def _A_setup():
        B, S, D = 1, 2048, 512
        return {
            "x": _w((lambda *s: torch.randn(*s, dtype=torch.bfloat16) * 0.05)(B, S, D)),
            "wqkv": _w((lambda *s: torch.randn(*s, dtype=torch.bfloat16) * 0.05)(D, 3 * D)),
            "wo": _w((lambda *s: torch.randn(*s, dtype=torch.bfloat16) * 0.05)(D, D)),
        }
    _A_in = _A_setup()

    def _B_setup():
        B, S, D, F = 1, 2048, 512, 1792
        return {
            "x": _w((lambda *s: torch.randn(*s, dtype=torch.bfloat16) * 0.05)(B, S, D)),
            "w_gate": _w((lambda *s: torch.randn(*s, dtype=torch.bfloat16) * 0.05)(D, F)),
            "w_up": _w((lambda *s: torch.randn(*s, dtype=torch.bfloat16) * 0.05)(D, F)),
            "w_down": _w((lambda *s: torch.randn(*s, dtype=torch.bfloat16) * 0.05)(F, D)),
        }
    _B_in = _B_setup()

    return {
        "A_x": _A_in["x"],
        "A_wqkv": _A_in["wqkv"],
        "A_wo": _A_in["wo"],
        "B_x": _B_in["x"],
        "B_w_gate": _B_in["w_gate"],
        "B_w_up": _B_in["w_up"],
        "B_w_down": _B_in["w_down"],
    }

def reference(A_x, A_wqkv, A_wo, B_x, B_w_gate, B_w_up, B_w_down):
    def _A_ref(x, wqkv, wo):
        B, S, D = x.shape
        H = 32; Dh = D // H
        W, dil = 8, 2
        qkv = (lambda x, *d: x.permute(*d))((x @ wqkv).reshape(B, S, 3, H, Dh), 2, 0, 3, 1, 4)
        q, k, v = qkv[0], qkv[1], qkv[2]
        scale = Dh ** -0.5
        pos = torch.arange(S)
        off = torch.arange(W) * dil
        idx = pos[:, None] - off[None, :]
        mask = idx >= 0
        idx_c = torch.where(mask, idx, 0).reshape(-1)
        kg = k[:, :, idx_c, :].reshape(B, H, S, W, Dh)
        vg = v[:, :, idx_c, :].reshape(B, H, S, W, Dh)
        logits = torch.einsum("bhsd,bhswd->bhsw", q, kg) * scale
        logits = torch.where(mask[None, None, :, :], logits, -1e9)
        attn = _softmax(logits, axis=-1)
        o = torch.einsum("bhsw,bhswd->bhsd", attn, vg)
        return (lambda x, *d: x.permute(*d))(o, 0, 2, 1, 3).reshape(B, S, D) @ wo

    def _B_ref(x, w_gate, w_up, w_down):
        g = _silu(x @ w_gate)
        u = x @ w_up
        return (g * u) @ w_down

    x = A_x
    x = x + _A_ref(_layernorm(x, axis=-1), A_wqkv, A_wo)
    x = x + _B_ref(_layernorm(x, axis=-1), B_w_gate, B_w_up, B_w_down)
    x = x + _A_ref(_layernorm(x, axis=-1), A_wqkv, A_wo)
    x = x + _B_ref(_layernorm(x, axis=-1), B_w_gate, B_w_up, B_w_down)
    return x
```

```asm
; @launch grid=(256,1,1) block=(256,1,1) lds=163840
.amdgcn_target "amdgcn-amd-amdhsa--gfx950"
.text
.p2align 8
.globl interleave_layers__sliding_local_dilated__swiglu_ffn__prompt_kernel
.type interleave_layers__sliding_local_dilated__swiglu_ffn__prompt_kernel,@function
interleave_layers__sliding_local_dilated__swiglu_ffn__prompt_kernel:
s_cmp_ge_u32 s2, 256
s_cbranch_scc1 L_end
s_load_dwordx16 s[64:79], s[0:1], 0
s_load_dwordx4 s[80:83], s[0:1], 64
s_memrealtime s[96:97]
s_getpc_b64 s[100:101]
L_pc:
v_and_b32 v1, 63, v0
v_lshrrev_b32 v2, 6, v0
s_lshr_b32 s33, s2, 3
s_mul_i32 s32, s33, 43
s_lshr_b32 s32, s32, 8
s_mul_i32 s32, s32, 6
s_sub_u32 s32, s33, s32
s_lshl_b32 s32, s32, 13
v_lshl_add_u32 v3, v2, 11, s32
v_lshl_add_u32 v3, v1, 7, v3
v_min_u32 v3, L_end-L_pc, v3
v_readfirstlane_b32 s3, v2
v_mov_b32_e64 v5, s101
v_add_co_u32 v4, vcc, s100, v3
s_nop 1
v_addc_co_u32 v5, vcc, 0, v5, vcc
s_mov_b64 exec, 0xffff
global_load_dword v175, v[4:5], off
s_mov_b64 exec, -1
s_and_b32 s32, s2, 7
s_and_b32 s5, s33, 15
s_lshr_b32 s33, s33, 4
s_lshl_b32 s32, s32, 1
s_add_u32 s4, s32, s33
s_lshr_b32 s33, s5, 3
s_lshl_b32 s6, s4, 1
s_add_u32 s6, s6, s33
s_and_b32 s7, s5, 7
v_lshlrev_b32 v2, 4, v1
v_lshrrev_b32 v60, 3, v1
v_and_b32 v61, 6, v60
v_and_b32 v62, 7, v1
v_xor_b32 v61, v61, v62
v_lshlrev_b32 v61, 4, v61
v_lshl_add_u32 v152, v60, 10, v61
v_and_b32 v61, 2, v60
s_and_b32 s32, s3, 1
s_lshl_b32 s32, s32, 2
v_or_b32 v61, s32, v61
v_xor_b32 v61, v61, v62
v_lshlrev_b32 v61, 4, v61
v_mul_u32_u24 v60, 3072, v60
v_add_u32 v164, v60, v61
s_add_u32 s84, s6, s7
s_and_b32 s84, s84, 7
s_lshl_b32 s47, s6, 3
s_sub_u32 s48, s47, 2
s_max_i32 s48, s48, 0
s_and_b32 s32, s3, 1
s_add_u32 s48, s48, s32
s_lshl_b32 s48, s48, 13
s_lshl_b32 s32, s3, 1
s_add_u32 s47, s47, s32
s_lshl_b32 s47, s47, 13
s_mul_i32 s51, s3, 24576
s_lshl_b32 s32, s7, 7
s_add_u32 s51, s51, s32
s_mul_i32 s52, s3, 3072
s_lshl_b32 s49, s3, 14
s_and_b32 s32, s3, 1
s_lshl_b32 s50, s32, 13
s_lshr_b32 s32, s3, 1
s_lshl_b32 s33, s32, 10
s_add_u32 s50, s50, s33
s_add_u32 s90, s32, s84
s_waitcnt lgkmcnt(0)
s_mov_b32 s12, s64
s_mov_b32 s13, s65
s_mov_b32 s14, 0x200000
s_mov_b32 s15, 0x20000
s_mov_b32 s16, s66
s_mov_b32 s17, s67
s_mov_b32 s18, 0x180000
s_mov_b32 s19, 0x20000
s_or_b32 s91, s96, 1
s_xor_b32 s99, s2, 128
v_lshrrev_b32 v44, 3, v1
v_and_b32 v43, 7, v1
v_and_b32 v45, 2, v44
v_lshlrev_b32 v45, 1, v45
v_xor_b32 v43, v43, v45
v_lshlrev_b32_e64 v43, 4, v43
s_add_u32 s34, s49, 102400
s_cmp_ge_u32 s99, 112
s_cbranch_scc1 L_pki_small
s_and_b32 s35, s99, 1
s_bfe_u32 s36, s99, 0x10001
s_lshr_b32 s37, s99, 2
s_cmp_eq_u32 s35, 0
s_cselect_b32 s24, s72, s74
s_cselect_b32 s25, s73, s75
s_mov_b32 s26, 0x1c0000
s_mov_b32 s27, 0x20000
v_mul_u32_u24 v46, 3584, v44
v_add_u32_e64 v46, v46, v43
s_lshl_b32 s38, s36, 2
s_add_u32 s38, s38, s3
s_mul_i32 s38, s38, 229376
s_lshl_b32 s39, s37, 7
s_add_u32 s38, s38, s39
s_add_u32 m0, s34, 0
s_add_u32 s39, s38, 0
buffer_load_dwordx4 v46, s[24:27], s39 offen nt lds
s_add_u32 m0, s34, 1024
s_add_u32 s39, s38, 28672
buffer_load_dwordx4 v46, s[24:27], s39 offen nt lds
s_add_u32 m0, s34, 2048
s_add_u32 s39, s38, 57344
buffer_load_dwordx4 v46, s[24:27], s39 offen nt lds
s_add_u32 m0, s34, 3072
s_add_u32 s39, s38, 86016
buffer_load_dwordx4 v46, s[24:27], s39 offen nt lds
s_add_u32 m0, s34, 8192
s_add_u32 s39, s38, 114688
buffer_load_dwordx4 v46, s[24:27], s39 offen nt lds
s_add_u32 m0, s34, 9216
s_add_u32 s39, s38, 143360
buffer_load_dwordx4 v46, s[24:27], s39 offen nt lds
s_add_u32 m0, s34, 10240
s_add_u32 s39, s38, 172032
buffer_load_dwordx4 v46, s[24:27], s39 offen nt lds
s_add_u32 m0, s34, 11264
s_add_u32 s39, s38, 200704
buffer_load_dwordx4 v46, s[24:27], s39 offen nt lds
s_branch L_pki_done
L_pki_small:
s_sub_u32 s35, s99, 112
s_lshl_b32 s35, s35, 3
s_lshl_b32 s36, s3, 1
s_add_u32 s35, s35, s36
s_cmp_lt_u32 s35, 896
s_cselect_b32 s24, s76, s68
s_cselect_b32 s25, s77, s69
s_mov_b32 s26, 0x80000
s_cselect_b32 s26, 0x1c0000, s26
s_mov_b32 s27, 0x20000
s_cselect_b32 s37, 1, 0
s_movk_i32 s38, 896
s_cselect_b32 s38, 0, s38
s_cselect_b32 s39, 0, 1
s_cselect_b32 s70, 14, 15
s_movk_i32 s71, 0x4000
s_cselect_b32 s71, 0x80, s71
s_sub_u32 s35, s35, s38
s_lshr_b32 s35, s35, s39
s_and_b32 s36, s35, 7
s_lshr_b32 s35, s35, 3
v_lshl_add_u32 v46, v44, 10, v43
s_lshl_b32 s38, s35, s70
s_lshl_b32 s39, s36, 7
s_add_u32 s38, s38, s39
s_add_u32 m0, s34, 0
s_add_u32 s39, s38, 0
buffer_load_dwordx4 v46, s[24:27], s39 offen nt lds
s_add_u32 m0, s34, 1024
s_add_u32 s39, s38, 8192
buffer_load_dwordx4 v46, s[24:27], s39 offen nt lds
s_add_u32 s38, s38, s71
s_add_u32 m0, s34, 2048
s_add_u32 s39, s38, 0
buffer_load_dwordx4 v46, s[24:27], s39 offen nt lds
s_add_u32 m0, s34, 3072
s_add_u32 s39, s38, 8192
buffer_load_dwordx4 v46, s[24:27], s39 offen nt lds
L_pki_done:
s_add_u32 s33, s84, 0
s_and_b32 s33, s33, 7
s_lshl_b32 s33, s33, 7
s_add_u32 m0, s49, 98304
s_add_u32 s33, s33, s47
buffer_load_dwordx4 v152, s[12:15], s33 offen  lds
s_add_u32 m0, s49, 106496
s_add_u32 s33, s33, 8192
buffer_load_dwordx4 v152, s[12:15], s33 offen  lds
s_add_u32 s33, s90, 0
s_and_b32 s33, s33, 7
s_lshl_b32 s33, s33, 7
s_add_u32 m0, s50, 81920
s_add_u32 s33, s33, s48
buffer_load_dwordx4 v152, s[12:15], s33 offen  lds
s_add_u32 s63, s84, 0
s_and_b32 s63, s63, 7
s_mul_i32 s63, s63, 196608
s_add_u32 m0, s52, 0
s_add_u32 s63, s63, s51
buffer_load_dwordx4 v164, s[16:19], s63 offen offset:0  lds
buffer_load_dwordx4 v164, s[16:19], s63 offen offset:1024  lds
buffer_load_dwordx4 v164, s[16:19], s63 offen offset:2048  lds
s_mov_b32 s28, s80
s_mov_b32 s29, s81
s_mov_b32 s30, 0x100
s_mov_b32 s31, 0x20000
v_cmp_eq_u32 vcc, 0, v1
v_mov_b32 v9, 0x80000000
s_or_b32 s32, s2, s3
v_cndmask_b32_e64 v9, v9, 0, vcc
s_cmp_eq_u32 s32, 0
s_cselect_b32 s32, 0, 0x40000000
v_mov_b32 v170, s91
buffer_store_dword v170, v9, s[28:31], s32 offen sc1
s_mov_b32 s8, s82
s_mov_b32 s9, s83
s_mov_b32 s10, 0x10000000
s_mov_b32 s11, 0x20000
s_mov_b32 s20, s78
s_mov_b32 s21, s79
s_mov_b32 s22, 0x200000
s_mov_b32 s23, 0x20000
v_and_b32 v60, 15, v1
v_lshrrev_b32 v61, 4, v1
v_and_b32_e64 v62, 7, v1
v_bfe_u32 v63, v1, 3, 1
v_lshlrev_b32_e64 v63, 13, v63
v_add_u32 v63, 98304, v63
v_and_b32 v32, 6, v62
v_xor_b32 v32, v32, v61
v_lshlrev_b32_e64 v32, 4, v32
v_lshl_add_u32 v32, v62, 7, v32
v_add_u32 v3, v32, v63
v_xor_b32 v4, 64, v3
v_lshlrev_b32_e64 v5, 3, v60
v_add_u32 v5, 80896, v5
v_lshlrev_b32_e64 v6, 5, v61
v_add_u32 v6, 80896, v6
v_and_b32_e64 v32, 1, v1
v_cmp_eq_u32 s[40:41], 1, v32
v_lshl_add_u32 v33, v61, 2, v32
v_cmp_le_u32 s[42:43], v33, v60
v_add_u32_e64 v33, 2, v33
v_cmp_le_u32 s[44:45], v33, v60
v_mov_b32 v33, 0xffff
v_mov_b32 v34, 0xffff0000
v_cndmask_b32 v33, v33, v34, s[40:41]
v_mov_b32_e64 v34, 0
v_cndmask_b32 v54, v34, v33, s[42:43]
v_cndmask_b32 v52, v33, v34, s[42:43]
v_cndmask_b32 v55, v34, v33, s[44:45]
v_cndmask_b32 v53, v33, v34, s[44:45]
s_cmp_eq_u32 s6, 0
s_cselect_b32 s70, 0xfe967699, 0
s_mov_b32 s46, 0x3eb8aa3b
v_mov_b32 v28, s70
v_mov_b32 v32, 0x3f803f80
v_mov_b32_e64 v29, s70
v_mov_b32 v33, 0x3f803f80
v_mov_b32_e64 v30, s70
v_mov_b32 v34, 0x3f803f80
v_mov_b32 v31, s70
v_mov_b32 v35, 0x3f803f80
s_lshl_b32 s32, s6, 16
s_add_u32 s32, s32, 7208960
s_lshl_b32 s33, s7, 2
s_add_u32 s33, s33, s3
s_lshl_b32 s53, s33, 10
s_add_u32 s53, s53, s32
s_add_u32 s54, s53, 32768
s_lshl_b32 s32, s6, 5
s_add_u32 s32, s32, s33
s_lshl_b32 s32, s32, 2
s_add_u32 s89, s32, 0
v_lshrrev_b32_e64 v60, 4, v1
v_bfe_u32 v61, v1, 2, 2
v_and_b32 v62, 1, v60
v_lshlrev_b32 v62, 1, v62
v_lshrrev_b32 v63, 1, v61
v_or_b32 v62, v62, v63
v_xor_b32 v62, s3, v62
v_lshlrev_b32 v62, 5, v62
v_mul_u32_u24 v60, 3072, v60
v_lshl_add_u32 v60, v61, 7, v60
v_add_u32 v60, v60, v62
v_and_b32 v61, 3, v1
v_lshl_add_u32 v165, v61, 3, v60
v_and_b32_e64 v60, 15, v1
v_cmp_eq_u32 s[78:79], 0, v60
v_subrev_u32 v166, 16384, v3
v_subrev_u32 v167, 16384, v4
v_add_u32 v168, s49, v3
v_add_u32 v169, s49, v4
v_mov_b32 v60, 0x80000000
v_cmp_gt_u32 vcc, 8, v1
v_mov_b32 v176, 0
v_mov_b32 v177, 0
v_mov_b32 v178, 0
v_mov_b32 v179, 0
v_cndmask_b32 v173, v60, v2, vcc
v_cmp_gt_u32 vcc, 16, v1
s_nop 0
s_lshl_b32 s32, s4, 4
v_cndmask_b32 v172, v60, v2, vcc
s_add_u32 s32, s32, s5
s_lshl_b32 s32, s32, 4
s_cmp_eq_u32 s3, 0
s_cselect_b32 s32, s32, 0x40000000
v_add_u32 v171, s32, v9
s_mov_b32 s98, 400000
s_lshl_b32 s32, s6, 3
s_add_u32 s32, s32, s3
s_lshl_b32 s55, s32, 13
s_lshl_b32 s33, s7, 10
s_add_u32 s55, s55, s33
s_lshl_b32 s57, s32, 13
s_lshl_b32 s33, s7, 7
s_add_u32 s57, s57, s33
s_lshl_b32 s56, s6, 12
s_lshr_b32 s33, s7, 1
s_lshl_b32 s33, s33, 9
s_add_u32 s56, s56, s33
s_and_b32 s33, s7, 1
s_lshl_b32 s33, s33, 3
s_add_u32 s56, s56, s33
s_lshl_b32 s33, s3, 7
s_add_u32 s56, s56, s33
s_lshl_b32 s60, s3, 12
s_mul_i32 s61, s5, 236544
s_add_u32 s61, s61, s60
s_add_u32 s61, s61, 65536
s_mul_i32 s32, s7, 229376
s_mul_i32 s33, s3, 57344
s_add_u32 s32, s32, s33
s_add_u32 s85, s32, 3850240
s_lshl_b32 s32, s7, 16
s_add_u32 s32, s32, s60
s_add_u32 s88, s32, 5685248
s_lshl_b32 s32, s6, 2
s_add_u32 s32, s32, s3
s_lshl_b32 s64, s32, 14
s_lshl_b32 s33, s7, 10
s_add_u32 s64, s64, s33
s_lshr_b32 s32, s32, 1
s_lshl_b32 s80, s32, 15
s_lshl_b32 s65, s32, 11
s_lshl_b32 s66, s32, 3
s_add_u32 s66, s66, s7
s_lshl_b32 s66, s66, 1
s_and_b32 s32, s3, 1
s_add_u32 s66, s66, s32
s_lshl_b32 s66, s66, 2
s_lshl_b32 s32, s32, 8
s_add_u32 s80, s80, s32
s_add_u32 s65, s65, s32
s_lshr_b32 s32, s7, 1
s_lshl_b32 s32, s32, 9
s_add_u32 s65, s65, s32
s_and_b32 s32, s7, 1
s_lshl_b32 s32, s32, 3
s_add_u32 s65, s65, s32
s_add_u32 m0, s52, 12288
s_add_u32 s63, s63, 98304
buffer_load_dwordx4 v164, s[16:19], s63 offen offset:0  lds
buffer_load_dwordx4 v164, s[16:19], s63 offen offset:1024  lds
buffer_load_dwordx4 v164, s[16:19], s63 offen offset:2048  lds
s_getreg_b32 s76, hwreg(HW_REG_XCC_ID, 0, 4)
s_mov_b32 s75, 32440320
s_lshl_b32 s77, s4, 8
s_add_u32 s77, s77, s75
v_bfe_u32 v46, v1, 2, 2
v_and_b32 v47, 3, v1
v_bfe_u32 v48, v1, 4, 1
v_lshrrev_b32 v49, 5, v1
v_and_b32 v50, 2, v46
v_add_u32 v50, v50, v48
v_lshlrev_b32 v50, 5, v50
v_lshl_add_u32 v50, v46, 7, v50
v_lshl_add_u32 v50, v47, 3, v50
v_add_u32 v50, s34, v50
s_cmp_ge_u32 s99, 112
s_cbranch_scc1 L_pk_small
v_lshl_add_u32 v56, v49, 10, v50
v_xor_b32 v57, 64, v56
s_lshl_b32 s39, s37, 2
v_add_u32 v58, s39, v48
s_lshl_b32 s70, s36, 2
s_add_u32 s70, s70, s3
s_lshl_b32 s70, s70, 2
v_and_b32 v66, 15, v1
s_lshl_b32 s71, s35, 8
v_lshl_add_u32 v66, v66, 4, s71
v_add_u32_e64 v59, 0, v58
v_mul_u32_u24 v60, 9363, v59
v_lshrrev_b32 v60, 16, v60
v_mul_u32_u24 v61, 7, v60
v_sub_u32 v61, v59, v61
v_cmp_gt_u32 vcc, 3, v61
v_mul_u32_u24 v67, 33, v61
v_mov_b32 v62, 1
v_mov_b32_e64 v70, 3
v_cndmask_b32 v67, v67, v61, vcc
v_cndmask_b32 v62, v62, v70, vcc
v_mul_u32_u24 v60, 231, v60
v_add_u32_e64 v67, v67, v60
v_lshl_add_u32 v70, v62, 5, v67
v_lshlrev_b32 v70, 10, v70
v_add_u32 v70, v70, v66
s_lshl_b32 s71, s36, 9
v_add_u32 v68, s71, v70
v_mul_lo_u32 v70, v62, s70
v_add_u32 v67, v67, v70
v_lshlrev_b32 v67, 10, v67
v_add_u32_e64 v67, v67, v66
v_lshl_add_u32 v64, v49, 9, v67
v_lshlrev_b32 v62, 10, v62
v_add_u32 v59, 2, v58
v_mul_u32_u24 v60, 9363, v59
v_lshrrev_b32 v60, 16, v60
v_mul_u32_u24 v61, 7, v60
v_sub_u32 v61, v59, v61
v_cmp_gt_u32 vcc, 3, v61
v_mul_u32_u24 v67, 33, v61
v_mov_b32 v63, 1
v_mov_b32_e64 v70, 3
v_cndmask_b32 v67, v67, v61, vcc
v_cndmask_b32 v63, v63, v70, vcc
v_mul_u32_u24 v60, 231, v60
v_add_u32_e64 v67, v67, v60
v_lshl_add_u32 v70, v63, 5, v67
v_lshlrev_b32 v70, 10, v70
v_add_u32 v70, v70, v66
s_lshl_b32 s71, s36, 9
v_add_u32 v69, s71, v70
v_mul_lo_u32 v70, v63, s70
v_add_u32 v67, v67, v70
v_lshlrev_b32 v67, 10, v67
v_add_u32_e64 v67, v67, v66
v_lshl_add_u32 v65, v49, 9, v67
v_lshlrev_b32_e64 v63, 10, v63
v_mov_b32 v71, 0x3f803f80
v_mov_b32 v72, 0
v_mov_b32 v73, 0
v_cmp_gt_u32 vcc, 32, v1
v_mov_b32 v46, 0
v_mov_b32_e64 v47, 0
v_cndmask_b32 v68, v69, v68, vcc
s_lshl_b32 s72, s3, 8
s_add_u32 s72, s72, 0x10000
v_lshl_add_u32 v74, v1, 2, s72
v_lshlrev_b32_e64 v75, 2, v1
v_add_u32 v75, 0x10000, v75
s_mov_b32 s70, 65536
s_mov_b32 s71, s70
s_mov_b32 s72, s70
s_mov_b32 s73, s70
s_cmp_eq_u32 s3, 0
s_cselect_b32 s74, s70, 0x40000000
s_waitcnt vmcnt(10)
ds_read_b64_tr_b16 v[76:77], v56 offset:0
ds_read_b64_tr_b16 v[78:79], v56 offset:512
ds_read_b64_tr_b16 v[80:81], v57 offset:0
ds_read_b64_tr_b16 v[82:83], v57 offset:512
ds_read_b64_tr_b16 v[84:85], v56 offset:2048
ds_read_b64_tr_b16 v[86:87], v56 offset:2560
ds_read_b64_tr_b16 v[88:89], v57 offset:2048
ds_read_b64_tr_b16 v[90:91], v57 offset:2560
ds_read_b64_tr_b16 v[92:93], v56 offset:8192
ds_read_b64_tr_b16 v[94:95], v56 offset:8704
ds_read_b64_tr_b16 v[96:97], v57 offset:8192
ds_read_b64_tr_b16 v[98:99], v57 offset:8704
s_waitcnt lgkmcnt(8)
ds_read_b64_tr_b16 v[36:37], v56 offset:10240
ds_read_b64_tr_b16 v[38:39], v56 offset:10752
ds_read_b64_tr_b16 v[40:41], v57 offset:10240
ds_read_b64_tr_b16 v[42:43], v57 offset:10752
s_add_u32 s33, s84, 1
s_and_b32 s33, s33, 7
s_lshl_b32 s33, s33, 7
s_add_u32 m0, s49, 99328
s_add_u32 s33, s33, s47
buffer_load_dwordx4 v152, s[12:15], s33 offen  lds
s_add_u32 m0, s49, 107520
s_add_u32 s33, s33, 8192
buffer_load_dwordx4 v152, s[12:15], s33 offen  lds
s_add_u32 s63, s84, 1
s_and_b32 s63, s63, 7
s_mul_i32 s63, s63, 196608
s_add_u32 m0, s52, 24576
s_add_u32 s63, s63, s51
buffer_load_dwordx4 v164, s[16:19], s63 offen offset:0  lds
buffer_load_dwordx4 v164, s[16:19], s63 offen offset:1024  lds
buffer_load_dwordx4 v164, s[16:19], s63 offen offset:2048  lds
v_dot2c_f32_bf16 v72, v76, v71
v_dot2c_f32_bf16 v72, v77, v71
v_dot2c_f32_bf16 v72, v78, v71
v_dot2c_f32_bf16 v72, v79, v71
v_dot2c_f32_bf16 v73, v80, v71
v_dot2c_f32_bf16 v73, v81, v71
v_dot2c_f32_bf16 v73, v82, v71
v_dot2c_f32_bf16 v73, v83, v71
s_waitcnt lgkmcnt(10)
v_dot2c_f32_bf16 v72, v84, v71
v_dot2c_f32_bf16 v72, v85, v71
v_dot2c_f32_bf16 v72, v86, v71
v_dot2c_f32_bf16 v72, v87, v71
s_waitcnt lgkmcnt(8)
v_dot2c_f32_bf16 v73, v88, v71
v_dot2c_f32_bf16 v73, v89, v71
v_dot2c_f32_bf16 v73, v90, v71
v_dot2c_f32_bf16 v73, v91, v71
s_waitcnt lgkmcnt(6)
v_dot2c_f32_bf16 v72, v92, v71
v_dot2c_f32_bf16 v72, v93, v71
v_dot2c_f32_bf16 v72, v94, v71
v_dot2c_f32_bf16 v72, v95, v71
s_waitcnt lgkmcnt(4)
v_dot2c_f32_bf16 v73, v96, v71
v_dot2c_f32_bf16 v73, v97, v71
v_dot2c_f32_bf16 v73, v98, v71
v_dot2c_f32_bf16 v73, v99, v71
s_waitcnt lgkmcnt(2)
v_dot2c_f32_bf16 v72, v36, v71
v_dot2c_f32_bf16 v72, v37, v71
v_dot2c_f32_bf16 v72, v38, v71
v_dot2c_f32_bf16 v72, v39, v71
s_waitcnt lgkmcnt(0)
v_dot2c_f32_bf16 v73, v40, v71
v_dot2c_f32_bf16 v73, v41, v71
v_dot2c_f32_bf16 v73, v42, v71
v_dot2c_f32_bf16 v73, v43, v71
s_nop 2
v_permlane32_swap_b32 v72, v73
v_add_f32_e64 v72, v72, v73
ds_write_b32 v74, v72 offset:14336
s_waitcnt lgkmcnt(0)
s_barrier
ds_read_b32 v56, v75 offset:14336
ds_read_b32 v57, v75 offset:14592
ds_read_b32 v58, v75 offset:14848
ds_read_b32 v59, v75 offset:15104
s_add_u32 m0, s52, 36864
s_add_u32 s63, s63, 98304
buffer_load_dwordx4 v164, s[16:19], s63 offen offset:0  lds
buffer_load_dwordx4 v164, s[16:19], s63 offen offset:1024  lds
buffer_load_dwordx4 v164, s[16:19], s63 offen offset:2048  lds
s_lshl_b32 s32, s2, 7
buffer_store_dwordx4 v[176:179], v173, s[8:11], s32 offen sc1
s_lshl_b32 s32, s2, 8
s_add_u32 s32, s32, 32374784
buffer_store_dwordx4 v[176:179], v172, s[8:11], s32 offen sc1
s_waitcnt lgkmcnt(0)
v_add_f32 v56, v56, v57
v_add_f32 v58, v58, v59
v_add_f32 v56, v56, v58
v_cvt_pk_bf16_f32 v45, v56, v46
v_lshlrev_b32 v57, 16, v45
v_sub_f32 v57, v56, v57
v_cvt_pk_bf16_f32 v44, v56, v57
s_nop 0
s_branch L_pk_done
L_pk_small:
v_mov_b32_e64 v64, v2
v_add_u32 v65, 1024, v2
v_mov_b32 v68, v2
s_mov_b32 s72, 0x40000000
s_mov_b32 s73, s72
s_mov_b32 s74, s72
s_cmp_eq_u32 s37, 0
s_cbranch_scc1 L_pk_wo
s_mul_i32 s38, s35, 2341
s_lshr_b32 s38, s38, 16
s_mul_i32 s39, s38, 28
s_sub_u32 s39, s35, s39
s_mul_i32 s70, s39, 9363
s_lshr_b32 s70, s70, 16
s_mul_i32 s71, s70, 7
s_sub_u32 s71, s39, s71
s_mov_b32 s39, s70
s_sub_u32 s39, s39, 0
s_and_b32 s39, s39, 3
s_lshl_b32 s32, s39, 2
s_add_u32 s32, s32, s71
s_mul_i32 s33, s39, 3
s_add_u32 s33, s33, s71
s_add_u32 s33, s33, 12
s_cmp_lt_u32 s71, 4
s_cselect_b32 s32, s32, s33
s_mul_i32 s33, s38, 28
s_add_u32 s32, s32, s33
s_lshl_b32 s35, s32, 11
s_mov_b32 s39, s70
s_sub_u32 s39, s39, 0
s_and_b32 s39, s39, 3
s_lshl_b32 s32, s39, 2
s_add_u32 s32, s32, s71
s_mul_i32 s33, s39, 3
s_add_u32 s33, s33, s71
s_add_u32 s33, s33, 12
s_cmp_lt_u32 s71, 4
s_cselect_b32 s32, s32, s33
s_mul_i32 s33, s38, 28
s_add_u32 s32, s32, s33
s_lshl_b32 s37, s32, 11
v_lshl_add_u32 v56, v49, 9, v50
v_xor_b32 v57, 64, v56
v_mov_b32 v62, 229376
v_mov_b32 v63, 229376
s_mul_i32 s36, s36, 229376
s_add_u32 s36, s36, 3850240
s_add_u32 s70, s36, s35
s_add_u32 s71, s36, s37
s_waitcnt vmcnt(10)
ds_read_b64_tr_b16 v[76:77], v56 offset:0
ds_read_b64_tr_b16 v[78:79], v56 offset:1024
ds_read_b64_tr_b16 v[80:81], v57 offset:0
ds_read_b64_tr_b16 v[82:83], v57 offset:1024
ds_read_b64_tr_b16 v[84:85], v56 offset:2048
ds_read_b64_tr_b16 v[86:87], v56 offset:3072
ds_read_b64_tr_b16 v[88:89], v57 offset:2048
ds_read_b64_tr_b16 v[90:91], v57 offset:3072
s_add_u32 s33, s84, 1
s_and_b32 s33, s33, 7
s_lshl_b32 s33, s33, 7
s_add_u32 m0, s49, 99328
s_add_u32 s33, s33, s47
buffer_load_dwordx4 v152, s[12:15], s33 offen  lds
s_add_u32 m0, s49, 107520
s_add_u32 s33, s33, 8192
buffer_load_dwordx4 v152, s[12:15], s33 offen  lds
s_add_u32 s63, s84, 1
s_and_b32 s63, s63, 7
s_mul_i32 s63, s63, 196608
s_add_u32 m0, s52, 24576
s_add_u32 s63, s63, s51
buffer_load_dwordx4 v164, s[16:19], s63 offen offset:0  lds
buffer_load_dwordx4 v164, s[16:19], s63 offen offset:1024  lds
buffer_load_dwordx4 v164, s[16:19], s63 offen offset:2048  lds
s_add_u32 m0, s52, 36864
s_add_u32 s63, s63, 98304
buffer_load_dwordx4 v164, s[16:19], s63 offen offset:0  lds
buffer_load_dwordx4 v164, s[16:19], s63 offen offset:1024  lds
buffer_load_dwordx4 v164, s[16:19], s63 offen offset:2048  lds
s_lshl_b32 s32, s2, 7
buffer_store_dwordx4 v[176:179], v173, s[8:11], s32 offen sc1
s_lshl_b32 s32, s2, 8
s_add_u32 s32, s32, 32374784
buffer_store_dwordx4 v[176:179], v172, s[8:11], s32 offen sc1
s_waitcnt lgkmcnt(0)
s_branch L_pk_done
L_pk_wo:
v_and_b32 v56, 2, v46
v_lshlrev_b32 v56, 1, v56
v_xor_b32 v56, v56, v47
v_lshlrev_b32_e64 v56, 4, v56
v_lshl_add_u32 v56, v46, 7, v56
v_lshrrev_b32_e64 v57, 4, v1
v_lshl_add_u32 v56, v57, 10, v56
v_add_u32 v56, s34, v56
v_xor_b32 v57, 64, v56
v_mov_b32 v62, 0x800
v_mov_b32 v63, 0x800
s_lshl_b32 s36, s36, 16
s_lshl_b32 s35, s35, 12
s_add_u32 s70, s36, s35
s_add_u32 s70, s70, 5685248
s_mov_b32 s71, s70
s_waitcnt vmcnt(10)
ds_read_b64_tr_b16 v[76:77], v56 offset:0
ds_read_b64_tr_b16 v[78:79], v56 offset:512
ds_read_b64_tr_b16 v[80:81], v56 offset:8
ds_read_b64_tr_b16 v[82:83], v56 offset:520
ds_read_b64_tr_b16 v[84:85], v57 offset:0
ds_read_b64_tr_b16 v[86:87], v57 offset:512
ds_read_b64_tr_b16 v[88:89], v57 offset:8
ds_read_b64_tr_b16 v[90:91], v57 offset:520
s_add_u32 s33, s84, 1
s_and_b32 s33, s33, 7
s_lshl_b32 s33, s33, 7
s_add_u32 m0, s49, 99328
s_add_u32 s33, s33, s47
buffer_load_dwordx4 v152, s[12:15], s33 offen  lds
s_add_u32 m0, s49, 107520
s_add_u32 s33, s33, 8192
buffer_load_dwordx4 v152, s[12:15], s33 offen  lds
s_add_u32 s63, s84, 1
s_and_b32 s63, s63, 7
s_mul_i32 s63, s63, 196608
s_add_u32 m0, s52, 24576
s_add_u32 s63, s63, s51
buffer_load_dwordx4 v164, s[16:19], s63 offen offset:0  lds
buffer_load_dwordx4 v164, s[16:19], s63 offen offset:1024  lds
buffer_load_dwordx4 v164, s[16:19], s63 offen offset:2048  lds
s_add_u32 m0, s52, 36864
s_add_u32 s63, s63, 98304
buffer_load_dwordx4 v164, s[16:19], s63 offen offset:0  lds
buffer_load_dwordx4 v164, s[16:19], s63 offen offset:1024  lds
buffer_load_dwordx4 v164, s[16:19], s63 offen offset:2048  lds
s_lshl_b32 s32, s2, 7
buffer_store_dwordx4 v[176:179], v173, s[8:11], s32 offen sc1
s_lshl_b32 s32, s2, 8
s_add_u32 s32, s32, 32374784
buffer_store_dwordx4 v[176:179], v172, s[8:11], s32 offen sc1
s_waitcnt lgkmcnt(0)
s_nop 0
L_pk_done:
buffer_load_dword v170, v9, s[28:31], 0 offen sc1
s_waitcnt vmcnt(15)
s_barrier
ds_read_b64_tr_b16 a[0:1], v165 offset:0
ds_read_b64_tr_b16 a[2:3], v165 offset:512
ds_read_b128 v[104:107], v3 offset:0
ds_read_b128 v[108:111], v3 offset:16384
ds_read_b128 v[112:115], v3 offset:32768
ds_read_b128 v[116:119], v3 offset:49152
ds_read_b64_tr_b16 a[4:5], v165 offset:1024
ds_read_b64_tr_b16 a[6:7], v165 offset:1536
ds_read_b64_tr_b16 a[8:9], v165 offset:2048
ds_read_b64_tr_b16 a[10:11], v165 offset:2560
ds_read_b128 v[120:123], v166 offset:0
ds_read_b128 v[124:127], v168 offset:0
s_waitcnt lgkmcnt(6)
v_mfma_f32_16x16x32_bf16 v[184:187], a[0:3], v[104:107], 0
buffer_store_dwordx4 v[76:79], v64, s[8:11], s70 offen sc1
v_add_u32_e64 v64, v64, v62
v_mfma_f32_16x16x32_bf16 v[196:199], a[0:3], v[108:111], 0
v_mfma_f32_16x16x32_bf16 v[208:211], a[0:3], v[112:115], 0
v_mfma_f32_16x16x32_bf16 v[220:223], a[0:3], v[116:119], 0
s_waitcnt lgkmcnt(0)
v_cndmask_b32 v120, v120, v32, s[78:79]
v_cndmask_b32 v121, v121, v32, s[78:79]
v_mfma_f32_16x16x32_bf16 v[188:191], a[4:7], v[104:107], 0
v_cndmask_b32 v122, v122, v32, s[78:79]
v_cndmask_b32 v123, v123, v32, s[78:79]
v_mfma_f32_16x16x32_bf16 v[192:195], v[104:107], a[8:11], 0
s_waitcnt vmcnt(12)
s_barrier
v_mfma_f32_16x16x32_bf16 v[200:203], a[4:7], v[108:111], 0
ds_read_b64_tr_b16 a[12:13], v165 offset:12288
buffer_store_dwordx4 v[80:83], v65, s[8:11], s70 offen sc1
v_mfma_f32_16x16x32_bf16 v[204:207], v[108:111], a[8:11], 0
ds_read_b64_tr_b16 a[14:15], v165 offset:12800
v_add_u32_e64 v65, v65, v63
v_mfma_f32_16x16x32_bf16 v[212:215], a[4:7], v[112:115], 0
ds_read_b128 v[128:131], v4 offset:0
v_mfma_f32_16x16x32_bf16 v[216:219], v[112:115], a[8:11], 0
ds_read_b128 v[132:135], v4 offset:16384
buffer_store_dwordx4 v[84:87], v64, s[8:11], s71 offen sc1
v_mfma_f32_16x16x32_bf16 v[224:227], a[4:7], v[116:119], 0
ds_read_b128 v[136:139], v4 offset:32768
v_add_u32_e64 v64, v64, v62
v_mfma_f32_16x16x32_bf16 v[228:231], v[116:119], a[8:11], 0
ds_read_b128 v[140:143], v4 offset:49152
v_mfma_f32_16x16x32_bf16 v[232:235], a[4:7], v[120:123], 0
ds_read_b64_tr_b16 a[16:17], v165 offset:13312
v_mfma_f32_16x16x32_bf16 v[236:239], v[120:123], a[8:11], 0
ds_read_b64_tr_b16 a[18:19], v165 offset:13824
v_mfma_f32_16x16x32_bf16 v[100:103], a[0:3], v[120:123], 0
ds_read_b64_tr_b16 a[20:21], v165 offset:14336
v_mfma_f32_16x16x32_bf16 v[240:243], v[32:35], v[124:127], 0
ds_read_b64_tr_b16 a[22:23], v165 offset:14848
v_mfma_f32_16x16x32_bf16 v[244:247], v[124:127], v[124:127], 0
ds_read_b128 v[144:147], v167 offset:0
v_mfma_f32_16x16x32_bf16 v[252:255], v[120:123], v[120:123], 0
ds_read_b128 v[148:151], v169 offset:0
s_waitcnt lgkmcnt(6)
v_mfma_f32_16x16x32_bf16 v[184:187], a[12:15], v[128:131], v[184:187]
s_add_u32 s33, s84, 2
s_and_b32 s33, s33, 7
s_lshl_b32 s33, s33, 7
v_mfma_f32_16x16x32_bf16 v[196:199], a[12:15], v[132:135], v[196:199]
s_add_u32 m0, s49, 100352
s_add_u32 s33, s33, s47
buffer_load_dwordx4 v152, s[12:15], s33 offen  lds
v_mfma_f32_16x16x32_bf16 v[208:211], a[12:15], v[136:139], v[208:211]
s_add_u32 m0, s49, 108544
s_add_u32 s33, s33, 8192
v_mfma_f32_16x16x32_bf16 v[220:223], a[12:15], v[140:143], v[220:223]
s_waitcnt lgkmcnt(0)
v_cndmask_b32 v144, v144, v32, s[78:79]
v_cndmask_b32 v145, v145, v32, s[78:79]
v_mfma_f32_16x16x32_bf16 v[188:191], a[16:19], v[128:131], v[188:191]
v_cndmask_b32 v146, v146, v32, s[78:79]
v_cndmask_b32 v147, v147, v32, s[78:79]
v_mfma_f32_16x16x32_bf16 v[192:195], v[128:131], a[20:23], v[192:195]
s_waitcnt vmcnt(10)
s_barrier
v_mfma_f32_16x16x32_bf16 v[200:203], a[16:19], v[132:135], v[200:203]
ds_read_b64_tr_b16 a[24:25], v165 offset:24576
buffer_load_dwordx4 v152, s[12:15], s33 offen  lds
v_mfma_f32_16x16x32_bf16 v[204:207], v[132:135], a[20:23], v[204:207]
s_add_u32 s33, s90, 2
ds_read_b64_tr_b16 a[26:27], v165 offset:25088
s_and_b32 s33, s33, 7
v_mfma_f32_16x16x32_bf16 v[212:215], a[16:19], v[136:139], v[212:215]
s_lshl_b32 s33, s33, 7
ds_read_b128 v[104:107], v3 offset:1024
s_add_u32 m0, s50, 83968
v_mfma_f32_16x16x32_bf16 v[216:219], v[136:139], a[20:23], v[216:219]
s_add_u32 s33, s33, s48
ds_read_b128 v[108:111], v3 offset:17408
buffer_load_dwordx4 v152, s[12:15], s33 offen  lds
v_mfma_f32_16x16x32_bf16 v[224:227], a[16:19], v[140:143], v[224:227]
s_add_u32 s63, s84, 2
ds_read_b128 v[112:115], v3 offset:33792
s_and_b32 s63, s63, 7
v_mfma_f32_16x16x32_bf16 v[228:231], v[140:143], a[20:23], v[228:231]
s_mul_i32 s63, s63, 196608
ds_read_b128 v[116:119], v3 offset:50176
s_add_u32 m0, s52, 49152
v_mfma_f32_16x16x32_bf16 v[232:235], a[16:19], v[144:147], v[232:235]
s_add_u32 s63, s63, s51
ds_read_b64_tr_b16 a[28:29], v165 offset:25600
buffer_load_dwordx4 v164, s[16:19], s63 offen offset:0  lds
v_mfma_f32_16x16x32_bf16 v[236:239], v[144:147], a[20:23], v[236:239]
ds_read_b64_tr_b16 a[30:31], v165 offset:26112
v_mfma_f32_16x16x32_bf16 v[100:103], a[12:15], v[144:147], v[100:103]
ds_read_b64_tr_b16 a[32:33], v165 offset:26624
v_mfma_f32_16x16x32_bf16 v[240:243], v[32:35], v[148:151], v[240:243]
ds_read_b64_tr_b16 a[34:35], v165 offset:27136
buffer_load_dwordx4 v164, s[16:19], s63 offen offset:1024  lds
v_mfma_f32_16x16x32_bf16 v[244:247], v[148:151], v[148:151], v[244:247]
ds_read_b128 v[120:123], v166 offset:1024
v_mfma_f32_16x16x32_bf16 v[252:255], v[144:147], v[144:147], v[252:255]
ds_read_b128 v[124:127], v168 offset:1024
buffer_load_dwordx4 v164, s[16:19], s63 offen offset:2048  lds
buffer_store_dwordx4 v[88:91], v65, s[8:11], s71 offen sc1
v_add_u32 v65, v65, v63
buffer_store_dwordx4 v[92:95], v64, s[8:11], s72 offen sc1
v_add_u32_e64 v64, v64, v62
buffer_store_dwordx4 v[96:99], v65, s[8:11], s72 offen sc1
v_add_u32_e64 v65, v65, v63
s_waitcnt lgkmcnt(6)
v_mfma_f32_16x16x32_bf16 v[184:187], a[24:27], v[104:107], v[184:187]
s_add_u32 m0, s52, 61440
s_add_u32 s63, s63, 98304
buffer_load_dwordx4 v164, s[16:19], s63 offen offset:0  lds
v_mfma_f32_16x16x32_bf16 v[196:199], a[24:27], v[108:111], v[196:199]
v_mfma_f32_16x16x32_bf16 v[208:211], a[24:27], v[112:115], v[208:211]
v_mfma_f32_16x16x32_bf16 v[220:223], a[24:27], v[116:119], v[220:223]
s_waitcnt lgkmcnt(0)
v_cndmask_b32 v120, v120, v32, s[78:79]
v_cndmask_b32 v121, v121, v32, s[78:79]
v_mfma_f32_16x16x32_bf16 v[188:191], a[28:31], v[104:107], v[188:191]
v_cndmask_b32 v122, v122, v32, s[78:79]
v_cndmask_b32 v123, v123, v32, s[78:79]
v_mfma_f32_16x16x32_bf16 v[192:195], v[104:107], a[32:35], v[192:195]
s_waitcnt vmcnt(16)
s_barrier
v_mfma_f32_16x16x32_bf16 v[200:203], a[28:31], v[108:111], v[200:203]
ds_read_b64_tr_b16 a[36:37], v165 offset:36864
buffer_load_dwordx4 v164, s[16:19], s63 offen offset:1024  lds
v_mfma_f32_16x16x32_bf16 v[204:207], v[108:111], a[32:35], v[204:207]
ds_read_b64_tr_b16 a[38:39], v165 offset:37376
v_mfma_f32_16x16x32_bf16 v[212:215], a[28:31], v[112:115], v[212:215]
ds_read_b128 v[128:131], v4 offset:1024
v_mfma_f32_16x16x32_bf16 v[216:219], v[112:115], a[32:35], v[216:219]
ds_read_b128 v[132:135], v4 offset:17408
buffer_load_dwordx4 v164, s[16:19], s63 offen offset:2048  lds
v_mfma_f32_16x16x32_bf16 v[224:227], a[28:31], v[116:119], v[224:227]
ds_read_b128 v[136:139], v4 offset:33792
v_mfma_f32_16x16x32_bf16 v[228:231], v[116:119], a[32:35], v[228:231]
ds_read_b128 v[140:143], v4 offset:50176
v_mfma_f32_16x16x32_bf16 v[232:235], a[28:31], v[120:123], v[232:235]
ds_read_b64_tr_b16 a[40:41], v165 offset:37888
buffer_store_dwordx4 v[36:39], v64, s[8:11], s73 offen sc1
v_mfma_f32_16x16x32_bf16 v[236:239], v[120:123], a[32:35], v[236:239]
ds_read_b64_tr_b16 a[42:43], v165 offset:38400
v_mfma_f32_16x16x32_bf16 v[100:103], a[24:27], v[120:123], v[100:103]
ds_read_b64_tr_b16 a[44:45], v165 offset:38912
v_mfma_f32_16x16x32_bf16 v[240:243], v[32:35], v[124:127], v[240:243]
ds_read_b64_tr_b16 a[46:47], v165 offset:39424
buffer_store_dwordx4 v[40:43], v65, s[8:11], s73 offen sc1
v_mfma_f32_16x16x32_bf16 v[244:247], v[124:127], v[124:127], v[244:247]
ds_read_b128 v[144:147], v167 offset:1024
v_mfma_f32_16x16x32_bf16 v[252:255], v[120:123], v[120:123], v[252:255]
ds_read_b128 v[148:151], v169 offset:1024
buffer_store_dwordx4 v[44:47], v68, s[8:11], s74 offen sc1
s_waitcnt lgkmcnt(6)
v_mfma_f32_16x16x32_bf16 v[184:187], a[36:39], v[128:131], v[184:187]
s_add_u32 s33, s84, 3
s_and_b32 s33, s33, 7
s_lshl_b32 s33, s33, 7
v_mfma_f32_16x16x32_bf16 v[196:199], a[36:39], v[132:135], v[196:199]
s_add_u32 m0, s49, 101376
s_add_u32 s33, s33, s47
buffer_load_dwordx4 v152, s[12:15], s33 offen  lds
v_mfma_f32_16x16x32_bf16 v[208:211], a[36:39], v[136:139], v[208:211]
s_add_u32 m0, s49, 109568
s_add_u32 s33, s33, 8192
v_mfma_f32_16x16x32_bf16 v[220:223], a[36:39], v[140:143], v[220:223]
s_waitcnt lgkmcnt(0)
v_cndmask_b32 v144, v144, v32, s[78:79]
v_cndmask_b32 v145, v145, v32, s[78:79]
v_mfma_f32_16x16x32_bf16 v[188:191], a[40:43], v[128:131], v[188:191]
v_cndmask_b32 v146, v146, v32, s[78:79]
v_cndmask_b32 v147, v147, v32, s[78:79]
v_mfma_f32_16x16x32_bf16 v[192:195], v[128:131], a[44:47], v[192:195]
s_waitcnt vmcnt(10)
s_barrier
v_mfma_f32_16x16x32_bf16 v[200:203], a[40:43], v[132:135], v[200:203]
ds_read_b64_tr_b16 a[48:49], v165 offset:49152
buffer_load_dwordx4 v152, s[12:15], s33 offen  lds
v_mfma_f32_16x16x32_bf16 v[204:207], v[132:135], a[44:47], v[204:207]
s_add_u32 s63, s84, 3
ds_read_b64_tr_b16 a[50:51], v165 offset:49664
s_and_b32 s63, s63, 7
v_mfma_f32_16x16x32_bf16 v[212:215], a[40:43], v[136:139], v[212:215]
s_mul_i32 s63, s63, 196608
ds_read_b128 v[104:107], v3 offset:2048
s_add_u32 m0, s52, 0
v_mfma_f32_16x16x32_bf16 v[216:219], v[136:139], a[44:47], v[216:219]
s_add_u32 s63, s63, s51
ds_read_b128 v[108:111], v3 offset:18432
buffer_load_dwordx4 v164, s[16:19], s63 offen offset:0  lds
v_mfma_f32_16x16x32_bf16 v[224:227], a[40:43], v[140:143], v[224:227]
ds_read_b128 v[112:115], v3 offset:34816
v_mfma_f32_16x16x32_bf16 v[228:231], v[140:143], a[44:47], v[228:231]
ds_read_b128 v[116:119], v3 offset:51200
v_mfma_f32_16x16x32_bf16 v[232:235], a[40:43], v[144:147], v[232:235]
ds_read_b64_tr_b16 a[52:53], v165 offset:50176
buffer_load_dwordx4 v164, s[16:19], s63 offen offset:1024  lds
v_mfma_f32_16x16x32_bf16 v[236:239], v[144:147], a[44:47], v[236:239]
ds_read_b64_tr_b16 a[54:55], v165 offset:50688
v_mfma_f32_16x16x32_bf16 v[100:103], a[36:39], v[144:147], v[100:103]
ds_read_b64_tr_b16 a[56:57], v165 offset:51200
v_mfma_f32_16x16x32_bf16 v[240:243], v[32:35], v[148:151], v[240:243]
ds_read_b64_tr_b16 a[58:59], v165 offset:51712
buffer_load_dwordx4 v164, s[16:19], s63 offen offset:2048  lds
v_mfma_f32_16x16x32_bf16 v[244:247], v[148:151], v[148:151], v[244:247]
ds_read_b128 v[120:123], v166 offset:2048
v_mfma_f32_16x16x32_bf16 v[252:255], v[144:147], v[144:147], v[252:255]
ds_read_b128 v[124:127], v168 offset:2048
s_waitcnt lgkmcnt(6)
v_mfma_f32_16x16x32_bf16 v[184:187], a[48:51], v[104:107], v[184:187]
s_add_u32 m0, s52, 12288
s_add_u32 s63, s63, 98304
buffer_load_dwordx4 v164, s[16:19], s63 offen offset:0  lds
v_mfma_f32_16x16x32_bf16 v[196:199], a[48:51], v[108:111], v[196:199]
v_mfma_f32_16x16x32_bf16 v[208:211], a[48:51], v[112:115], v[208:211]
v_mfma_f32_16x16x32_bf16 v[220:223], a[48:51], v[116:119], v[220:223]
s_waitcnt lgkmcnt(0)
v_cndmask_b32 v120, v120, v32, s[78:79]
v_cndmask_b32 v121, v121, v32, s[78:79]
v_mfma_f32_16x16x32_bf16 v[188:191], a[52:55], v[104:107], v[188:191]
v_cndmask_b32 v122, v122, v32, s[78:79]
v_cndmask_b32 v123, v123, v32, s[78:79]
v_mfma_f32_16x16x32_bf16 v[192:195], v[104:107], a[56:59], v[192:195]
s_waitcnt vmcnt(6)
s_barrier
v_mfma_f32_16x16x32_bf16 v[200:203], a[52:55], v[108:111], v[200:203]
ds_read_b64_tr_b16 a[60:61], v165 offset:61440
buffer_load_dwordx4 v164, s[16:19], s63 offen offset:1024  lds
v_mfma_f32_16x16x32_bf16 v[204:207], v[108:111], a[56:59], v[204:207]
ds_read_b64_tr_b16 a[62:63], v165 offset:61952
v_mfma_f32_16x16x32_bf16 v[212:215], a[52:55], v[112:115], v[212:215]
ds_read_b128 v[128:131], v4 offset:2048
v_mfma_f32_16x16x32_bf16 v[216:219], v[112:115], a[56:59], v[216:219]
ds_read_b128 v[132:135], v4 offset:18432
buffer_load_dwordx4 v164, s[16:19], s63 offen offset:2048  lds
v_mfma_f32_16x16x32_bf16 v[224:227], a[52:55], v[116:119], v[224:227]
ds_read_b128 v[136:139], v4 offset:34816
v_mfma_f32_16x16x32_bf16 v[228:231], v[116:119], a[56:59], v[228:231]
ds_read_b128 v[140:143], v4 offset:51200
v_mfma_f32_16x16x32_bf16 v[232:235], a[52:55], v[120:123], v[232:235]
ds_read_b64_tr_b16 a[64:65], v165 offset:62464
v_mfma_f32_16x16x32_bf16 v[236:239], v[120:123], a[56:59], v[236:239]
ds_read_b64_tr_b16 a[66:67], v165 offset:62976
v_mfma_f32_16x16x32_bf16 v[100:103], a[48:51], v[120:123], v[100:103]
ds_read_b64_tr_b16 a[68:69], v165 offset:63488
v_mfma_f32_16x16x32_bf16 v[240:243], v[32:35], v[124:127], v[240:243]
ds_read_b64_tr_b16 a[70:71], v165 offset:64000
v_mfma_f32_16x16x32_bf16 v[244:247], v[124:127], v[124:127], v[244:247]
ds_read_b128 v[144:147], v167 offset:2048
v_mfma_f32_16x16x32_bf16 v[252:255], v[120:123], v[120:123], v[252:255]
ds_read_b128 v[148:151], v169 offset:2048
v_readfirstlane_b32 s91, v170
s_nop 0
s_cmp_eq_u32 s91, 0
s_cbranch_scc1 L_tag_spin
L_tag_ok:
v_mov_b32 v176, s91
v_not_b32 v177, v176
v_mov_b32_e64 v178, s76
buffer_store_dwordx4 v[176:179], v171, s[8:11], s75 offen sc1
s_waitcnt lgkmcnt(6)
v_mfma_f32_16x16x32_bf16 v[184:187], a[60:63], v[128:131], v[184:187]
s_add_u32 s33, s84, 4
s_and_b32 s33, s33, 7
s_lshl_b32 s33, s33, 7
v_mfma_f32_16x16x32_bf16 v[196:199], a[60:63], v[132:135], v[196:199]
s_add_u32 m0, s49, 102400
s_add_u32 s33, s33, s47
buffer_load_dwordx4 v152, s[12:15], s33 offen  lds
v_mfma_f32_16x16x32_bf16 v[208:211], a[60:63], v[136:139], v[208:211]
s_add_u32 m0, s49, 110592
s_add_u32 s33, s33, 8192
v_mfma_f32_16x16x32_bf16 v[220:223], a[60:63], v[140:143], v[220:223]
s_waitcnt lgkmcnt(0)
v_cndmask_b32 v144, v144, v32, s[78:79]
v_cndmask_b32 v145, v145, v32, s[78:79]
v_mfma_f32_16x16x32_bf16 v[188:191], a[64:67], v[128:131], v[188:191]
v_cndmask_b32 v146, v146, v32, s[78:79]
v_cndmask_b32 v147, v147, v32, s[78:79]
v_mfma_f32_16x16x32_bf16 v[192:195], v[128:131], a[68:71], v[192:195]
s_waitcnt vmcnt(5)
s_barrier
v_mfma_f32_16x16x32_bf16 v[200:203], a[64:67], v[132:135], v[200:203]
ds_read_b64_tr_b16 a[72:73], v165 offset:0
buffer_load_dwordx4 v152, s[12:15], s33 offen  lds
v_mfma_f32_16x16x32_bf16 v[204:207], v[132:135], a[68:71], v[204:207]
s_add_u32 s33, s90, 4
ds_read_b64_tr_b16 a[74:75], v165 offset:512
s_and_b32 s33, s33, 7
v_mfma_f32_16x16x32_bf16 v[212:215], a[64:67], v[136:139], v[212:215]
s_lshl_b32 s33, s33, 7
ds_read_b128 v[104:107], v3 offset:3072
s_add_u32 m0, s50, 86016
v_mfma_f32_16x16x32_bf16 v[216:219], v[136:139], a[68:71], v[216:219]
s_add_u32 s33, s33, s48
ds_read_b128 v[108:111], v3 offset:19456
buffer_load_dwordx4 v152, s[12:15], s33 offen  lds
v_mfma_f32_16x16x32_bf16 v[224:227], a[64:67], v[140:143], v[224:227]
s_add_u32 s63, s84, 4
ds_read_b128 v[112:115], v3 offset:35840
s_and_b32 s63, s63, 7
v_mfma_f32_16x16x32_bf16 v[228:231], v[140:143], a[68:71], v[228:231]
s_mul_i32 s63, s63, 196608
ds_read_b128 v[116:119], v3 offset:52224
s_add_u32 m0, s52, 24576
v_mfma_f32_16x16x32_bf16 v[232:235], a[64:67], v[144:147], v[232:235]
s_add_u32 s63, s63, s51
ds_read_b64_tr_b16 a[76:77], v165 offset:1024
buffer_load_dwordx4 v164, s[16:19], s63 offen offset:0  lds
v_mfma_f32_16x16x32_bf16 v[236:239], v[144:147], a[68:71], v[236:239]
ds_read_b64_tr_b16 a[78:79], v165 offset:1536
v_mfma_f32_16x16x32_bf16 v[100:103], a[60:63], v[144:147], v[100:103]
ds_read_b64_tr_b16 a[80:81], v165 offset:2048
v_mfma_f32_16x16x32_bf16 v[240:243], v[32:35], v[148:151], v[240:243]
ds_read_b64_tr_b16 a[82:83], v165 offset:2560
buffer_load_dwordx4 v164, s[16:19], s63 offen offset:1024  lds
v_mfma_f32_16x16x32_bf16 v[244:247], v[148:151], v[148:151], v[244:247]
ds_read_b128 v[120:123], v166 offset:3072
v_mfma_f32_16x16x32_bf16 v[252:255], v[144:147], v[144:147], v[252:255]
ds_read_b128 v[124:127], v168 offset:3072
buffer_load_dwordx4 v164, s[16:19], s63 offen offset:2048  lds
s_waitcnt lgkmcnt(6)
v_mfma_f32_16x16x32_bf16 v[184:187], a[72:75], v[104:107], v[184:187]
s_add_u32 m0, s52, 36864
s_add_u32 s63, s63, 98304
buffer_load_dwordx4 v164, s[16:19], s63 offen offset:0  lds
v_mfma_f32_16x16x32_bf16 v[196:199], a[72:75], v[108:111], v[196:199]
v_mfma_f32_16x16x32_bf16 v[208:211], a[72:75], v[112:115], v[208:211]
v_mfma_f32_16x16x32_bf16 v[220:223], a[72:75], v[116:119], v[220:223]
s_waitcnt lgkmcnt(0)
v_cndmask_b32 v120, v120, v32, s[78:79]
v_cndmask_b32 v121, v121, v32, s[78:79]
v_mfma_f32_16x16x32_bf16 v[188:191], a[76:79], v[104:107], v[188:191]
v_cndmask_b32 v122, v122, v32, s[78:79]
v_cndmask_b32 v123, v123, v32, s[78:79]
v_mfma_f32_16x16x32_bf16 v[192:195], v[104:107], a[80:83], v[192:195]
s_waitcnt vmcnt(8)
s_barrier
v_mfma_f32_16x16x32_bf16 v[200:203], a[76:79], v[108:111], v[200:203]
ds_read_b64_tr_b16 a[84:85], v165 offset:12288
buffer_load_dwordx4 v164, s[16:19], s63 offen offset:1024  lds
v_mfma_f32_16x16x32_bf16 v[204:207], v[108:111], a[80:83], v[204:207]
ds_read_b64_tr_b16 a[86:87], v165 offset:12800
v_mfma_f32_16x16x32_bf16 v[212:215], a[76:79], v[112:115], v[212:215]
ds_read_b128 v[128:131], v4 offset:3072
v_mfma_f32_16x16x32_bf16 v[216:219], v[112:115], a[80:83], v[216:219]
ds_read_b128 v[132:135], v4 offset:19456
buffer_load_dwordx4 v164, s[16:19], s63 offen offset:2048  lds
v_mfma_f32_16x16x32_bf16 v[224:227], a[76:79], v[116:119], v[224:227]
ds_read_b128 v[136:139], v4 offset:35840
v_mfma_f32_16x16x32_bf16 v[228:231], v[116:119], a[80:83], v[228:231]
ds_read_b128 v[140:143], v4 offset:52224
v_mfma_f32_16x16x32_bf16 v[232:235], a[76:79], v[120:123], v[232:235]
ds_read_b64_tr_b16 a[88:89], v165 offset:13312
v_mfma_f32_16x16x32_bf16 v[236:239], v[120:123], a[80:83], v[236:239]
ds_read_b64_tr_b16 a[90:91], v165 offset:13824
v_mfma_f32_16x16x32_bf16 v[100:103], a[72:75], v[120:123], v[100:103]
ds_read_b64_tr_b16 a[92:93], v165 offset:14336
v_mfma_f32_16x16x32_bf16 v[240:243], v[32:35], v[124:127], v[240:243]
ds_read_b64_tr_b16 a[94:95], v165 offset:14848
v_mfma_f32_16x16x32_bf16 v[244:247], v[124:127], v[124:127], v[244:247]
ds_read_b128 v[144:147], v167 offset:3072
v_mfma_f32_16x16x32_bf16 v[252:255], v[120:123], v[120:123], v[252:255]
ds_read_b128 v[148:151], v169 offset:3072
s_waitcnt lgkmcnt(6)
v_mfma_f32_16x16x32_bf16 v[184:187], a[84:87], v[128:131], v[184:187]
s_add_u32 s33, s84, 5
s_and_b32 s33, s33, 7
s_lshl_b32 s33, s33, 7
v_mfma_f32_16x16x32_bf16 v[196:199], a[84:87], v[132:135], v[196:199]
s_add_u32 m0, s49, 103424
s_add_u32 s33, s33, s47
buffer_load_dwordx4 v152, s[12:15], s33 offen  lds
v_mfma_f32_16x16x32_bf16 v[208:211], a[84:87], v[136:139], v[208:211]
s_add_u32 m0, s49, 111616
s_add_u32 s33, s33, 8192
v_mfma_f32_16x16x32_bf16 v[220:223], a[84:87], v[140:143], v[220:223]
s_waitcnt lgkmcnt(0)
v_cndmask_b32 v144, v144, v32, s[78:79]
v_cndmask_b32 v145, v145, v32, s[78:79]
v_mfma_f32_16x16x32_bf16 v[188:191], a[88:91], v[128:131], v[188:191]
v_cndmask_b32 v146, v146, v32, s[78:79]
v_cndmask_b32 v147, v147, v32, s[78:79]
v_mfma_f32_16x16x32_bf16 v[192:195], v[128:131], a[92:95], v[192:195]
s_waitcnt vmcnt(4)
s_barrier
v_mfma_f32_16x16x32_bf16 v[200:203], a[88:91], v[132:135], v[200:203]
ds_read_b64_tr_b16 a[96:97], v165 offset:24576
buffer_load_dwordx4 v152, s[12:15], s33 offen  lds
v_mfma_f32_16x16x32_bf16 v[204:207], v[132:135], a[92:95], v[204:207]
s_add_u32 s63, s84, 5
ds_read_b64_tr_b16 a[98:99], v165 offset:25088
s_and_b32 s63, s63, 7
v_mfma_f32_16x16x32_bf16 v[212:215], a[88:91], v[136:139], v[212:215]
s_mul_i32 s63, s63, 196608
ds_read_b128 v[104:107], v3 offset:4096
s_add_u32 m0, s52, 49152
v_mfma_f32_16x16x32_bf16 v[216:219], v[136:139], a[92:95], v[216:219]
s_add_u32 s63, s63, s51
ds_read_b128 v[108:111], v3 offset:20480
buffer_load_dwordx4 v164, s[16:19], s63 offen offset:0  lds
v_mfma_f32_16x16x32_bf16 v[224:227], a[88:91], v[140:143], v[224:227]
ds_read_b128 v[112:115], v3 offset:36864
v_mfma_f32_16x16x32_bf16 v[228:231], v[140:143], a[92:95], v[228:231]
ds_read_b128 v[116:119], v3 offset:53248
v_mfma_f32_16x16x32_bf16 v[232:235], a[88:91], v[144:147], v[232:235]
ds_read_b64_tr_b16 a[100:101], v165 offset:25600
buffer_load_dwordx4 v164, s[16:19], s63 offen offset:1024  lds
v_mfma_f32_16x16x32_bf16 v[236:239], v[144:147], a[92:95], v[236:239]
ds_read_b64_tr_b16 a[102:103], v165 offset:26112
v_mfma_f32_16x16x32_bf16 v[100:103], a[84:87], v[144:147], v[100:103]
ds_read_b64_tr_b16 a[104:105], v165 offset:26624
v_mfma_f32_16x16x32_bf16 v[240:243], v[32:35], v[148:151], v[240:243]
ds_read_b64_tr_b16 a[106:107], v165 offset:27136
buffer_load_dwordx4 v164, s[16:19], s63 offen offset:2048  lds
v_mfma_f32_16x16x32_bf16 v[244:247], v[148:151], v[148:151], v[244:247]
ds_read_b128 v[120:123], v166 offset:4096
v_mfma_f32_16x16x32_bf16 v[252:255], v[144:147], v[144:147], v[252:255]
ds_read_b128 v[124:127], v168 offset:4096
s_waitcnt lgkmcnt(6)
v_mfma_f32_16x16x32_bf16 v[184:187], a[96:99], v[104:107], v[184:187]
s_add_u32 m0, s52, 61440
s_add_u32 s63, s63, 98304
buffer_load_dwordx4 v164, s[16:19], s63 offen offset:0  lds
v_mfma_f32_16x16x32_bf16 v[196:199], a[96:99], v[108:111], v[196:199]
v_mfma_f32_16x16x32_bf16 v[208:211], a[96:99], v[112:115], v[208:211]
v_mfma_f32_16x16x32_bf16 v[220:223], a[96:99], v[116:119], v[220:223]
s_waitcnt lgkmcnt(0)
v_cndmask_b32 v120, v120, v32, s[78:79]
v_cndmask_b32 v121, v121, v32, s[78:79]
v_mfma_f32_16x16x32_bf16 v[188:191], a[100:103], v[104:107], v[188:191]
v_cndmask_b32 v122, v122, v32, s[78:79]
v_cndmask_b32 v123, v123, v32, s[78:79]
v_mfma_f32_16x16x32_bf16 v[192:195], v[104:107], a[104:107], v[192:195]
s_waitcnt vmcnt(6)
s_barrier
v_mfma_f32_16x16x32_bf16 v[200:203], a[100:103], v[108:111], v[200:203]
ds_read_b64_tr_b16 a[108:109], v165 offset:36864
buffer_load_dwordx4 v164, s[16:19], s63 offen offset:1024  lds
v_mfma_f32_16x16x32_bf16 v[204:207], v[108:111], a[104:107], v[204:207]
ds_read_b64_tr_b16 a[110:111], v165 offset:37376
v_mfma_f32_16x16x32_bf16 v[212:215], a[100:103], v[112:115], v[212:215]
ds_read_b128 v[128:131], v4 offset:4096
v_mfma_f32_16x16x32_bf16 v[216:219], v[112:115], a[104:107], v[216:219]
ds_read_b128 v[132:135], v4 offset:20480
buffer_load_dwordx4 v164, s[16:19], s63 offen offset:2048  lds
v_mfma_f32_16x16x32_bf16 v[224:227], a[100:103], v[116:119], v[224:227]
ds_read_b128 v[136:139], v4 offset:36864
v_mfma_f32_16x16x32_bf16 v[228:231], v[116:119], a[104:107], v[228:231]
ds_read_b128 v[140:143], v4 offset:53248
v_mfma_f32_16x16x32_bf16 v[232:235], a[100:103], v[120:123], v[232:235]
ds_read_b64_tr_b16 a[112:113], v165 offset:37888
v_mfma_f32_16x16x32_bf16 v[236:239], v[120:123], a[104:107], v[236:239]
ds_read_b64_tr_b16 a[114:115], v165 offset:38400
v_mfma_f32_16x16x32_bf16 v[100:103], a[96:99], v[120:123], v[100:103]
ds_read_b64_tr_b16 a[116:117], v165 offset:38912
v_mfma_f32_16x16x32_bf16 v[240:243], v[32:35], v[124:127], v[240:243]
ds_read_b64_tr_b16 a[118:119], v165 offset:39424
v_mfma_f32_16x16x32_bf16 v[244:247], v[124:127], v[124:127], v[244:247]
ds_read_b128 v[144:147], v167 offset:4096
v_mfma_f32_16x16x32_bf16 v[252:255], v[120:123], v[120:123], v[252:255]
ds_read_b128 v[148:151], v169 offset:4096
s_waitcnt lgkmcnt(6)
v_mfma_f32_16x16x32_bf16 v[184:187], a[108:111], v[128:131], v[184:187]
s_add_u32 s33, s84, 6
s_and_b32 s33, s33, 7
s_lshl_b32 s33, s33, 7
v_mfma_f32_16x16x32_bf16 v[196:199], a[108:111], v[132:135], v[196:199]
s_add_u32 m0, s49, 104448
s_add_u32 s33, s33, s47
buffer_load_dwordx4 v152, s[12:15], s33 offen  lds
v_mfma_f32_16x16x32_bf16 v[208:211], a[108:111], v[136:139], v[208:211]
s_add_u32 m0, s49, 112640
s_add_u32 s33, s33, 8192
v_mfma_f32_16x16x32_bf16 v[220:223], a[108:111], v[140:143], v[220:223]
s_waitcnt lgkmcnt(0)
v_cndmask_b32 v144, v144, v32, s[78:79]
v_cndmask_b32 v145, v145, v32, s[78:79]
v_mfma_f32_16x16x32_bf16 v[188:191], a[112:115], v[128:131], v[188:191]
v_cndmask_b32 v146, v146, v32, s[78:79]
v_cndmask_b32 v147, v147, v32, s[78:79]
v_mfma_f32_16x16x32_bf16 v[192:195], v[128:131], a[116:119], v[192:195]
s_waitcnt vmcnt(4)
s_barrier
v_mfma_f32_16x16x32_bf16 v[200:203], a[112:115], v[132:135], v[200:203]
ds_read_b64_tr_b16 a[120:121], v165 offset:49152
buffer_load_dwordx4 v152, s[12:15], s33 offen  lds
v_mfma_f32_16x16x32_bf16 v[204:207], v[132:135], a[116:119], v[204:207]
s_add_u32 s33, s90, 6
ds_read_b64_tr_b16 a[122:123], v165 offset:49664
s_and_b32 s33, s33, 7
v_mfma_f32_16x16x32_bf16 v[212:215], a[112:115], v[136:139], v[212:215]
s_lshl_b32 s33, s33, 7
ds_read_b128 v[104:107], v3 offset:5120
s_add_u32 m0, s50, 88064
v_mfma_f32_16x16x32_bf16 v[216:219], v[136:139], a[116:119], v[216:219]
s_add_u32 s33, s33, s48
ds_read_b128 v[108:111], v3 offset:21504
buffer_load_dwordx4 v152, s[12:15], s33 offen  lds
v_mfma_f32_16x16x32_bf16 v[224:227], a[112:115], v[140:143], v[224:227]
s_add_u32 s63, s84, 6
ds_read_b128 v[112:115], v3 offset:37888
s_and_b32 s63, s63, 7
v_mfma_f32_16x16x32_bf16 v[228:231], v[140:143], a[116:119], v[228:231]
s_mul_i32 s63, s63, 196608
ds_read_b128 v[116:119], v3 offset:54272
s_add_u32 m0, s52, 0
v_mfma_f32_16x16x32_bf16 v[232:235], a[112:115], v[144:147], v[232:235]
s_add_u32 s63, s63, s51
ds_read_b64_tr_b16 a[124:125], v165 offset:50176
buffer_load_dwordx4 v164, s[16:19], s63 offen offset:0  lds
v_mfma_f32_16x16x32_bf16 v[236:239], v[144:147], a[116:119], v[236:239]
ds_read_b64_tr_b16 a[126:127], v165 offset:50688
v_mfma_f32_16x16x32_bf16 v[100:103], a[108:111], v[144:147], v[100:103]
ds_read_b64_tr_b16 a[128:129], v165 offset:51200
v_mfma_f32_16x16x32_bf16 v[240:243], v[32:35], v[148:151], v[240:243]
ds_read_b64_tr_b16 a[130:131], v165 offset:51712
buffer_load_dwordx4 v164, s[16:19], s63 offen offset:1024  lds
v_mfma_f32_16x16x32_bf16 v[244:247], v[148:151], v[148:151], v[244:247]
ds_read_b128 v[120:123], v166 offset:5120
v_mfma_f32_16x16x32_bf16 v[252:255], v[144:147], v[144:147], v[252:255]
ds_read_b128 v[124:127], v168 offset:5120
buffer_load_dwordx4 v164, s[16:19], s63 offen offset:2048  lds
s_waitcnt lgkmcnt(6)
v_mfma_f32_16x16x32_bf16 v[184:187], a[120:123], v[104:107], v[184:187]
s_add_u32 m0, s52, 12288
s_add_u32 s63, s63, 98304
buffer_load_dwordx4 v164, s[16:19], s63 offen offset:0  lds
v_mfma_f32_16x16x32_bf16 v[196:199], a[120:123], v[108:111], v[196:199]
v_mfma_f32_16x16x32_bf16 v[208:211], a[120:123], v[112:115], v[208:211]
v_mfma_f32_16x16x32_bf16 v[220:223], a[120:123], v[116:119], v[220:223]
s_waitcnt lgkmcnt(0)
v_cndmask_b32 v120, v120, v32, s[78:79]
v_cndmask_b32 v121, v121, v32, s[78:79]
v_mfma_f32_16x16x32_bf16 v[188:191], a[124:127], v[104:107], v[188:191]
v_cndmask_b32 v122, v122, v32, s[78:79]
v_cndmask_b32 v123, v123, v32, s[78:79]
v_mfma_f32_16x16x32_bf16 v[192:195], v[104:107], a[128:131], v[192:195]
s_waitcnt vmcnt(7)
s_barrier
v_mfma_f32_16x16x32_bf16 v[200:203], a[124:127], v[108:111], v[200:203]
ds_read_b64_tr_b16 a[132:133], v165 offset:61440
buffer_load_dwordx4 v164, s[16:19], s63 offen offset:1024  lds
v_mfma_f32_16x16x32_bf16 v[204:207], v[108:111], a[128:131], v[204:207]
ds_read_b64_tr_b16 a[134:135], v165 offset:61952
v_mfma_f32_16x16x32_bf16 v[212:215], a[124:127], v[112:115], v[212:215]
ds_read_b128 v[128:131], v4 offset:5120
v_mfma_f32_16x16x32_bf16 v[216:219], v[112:115], a[128:131], v[216:219]
ds_read_b128 v[132:135], v4 offset:21504
buffer_load_dwordx4 v164, s[16:19], s63 offen offset:2048  lds
v_mfma_f32_16x16x32_bf16 v[224:227], a[124:127], v[116:119], v[224:227]
ds_read_b128 v[136:139], v4 offset:37888
v_mfma_f32_16x16x32_bf16 v[228:231], v[116:119], a[128:131], v[228:231]
ds_read_b128 v[140:143], v4 offset:54272
v_mfma_f32_16x16x32_bf16 v[232:235], a[124:127], v[120:123], v[232:235]
ds_read_b64_tr_b16 a[136:137], v165 offset:62464
v_mfma_f32_16x16x32_bf16 v[236:239], v[120:123], a[128:131], v[236:239]
ds_read_b64_tr_b16 a[138:139], v165 offset:62976
v_mfma_f32_16x16x32_bf16 v[100:103], a[120:123], v[120:123], v[100:103]
ds_read_b64_tr_b16 a[140:141], v165 offset:63488
v_mfma_f32_16x16x32_bf16 v[240:243], v[32:35], v[124:127], v[240:243]
ds_read_b64_tr_b16 a[142:143], v165 offset:64000
v_mfma_f32_16x16x32_bf16 v[244:247], v[124:127], v[124:127], v[244:247]
ds_read_b128 v[144:147], v167 offset:5120
v_mfma_f32_16x16x32_bf16 v[252:255], v[120:123], v[120:123], v[252:255]
ds_read_b128 v[148:151], v169 offset:5120
s_waitcnt lgkmcnt(6)
v_mfma_f32_16x16x32_bf16 v[184:187], a[132:135], v[128:131], v[184:187]
s_add_u32 s33, s84, 7
s_and_b32 s33, s33, 7
s_lshl_b32 s33, s33, 7
v_mfma_f32_16x16x32_bf16 v[196:199], a[132:135], v[132:135], v[196:199]
s_add_u32 m0, s49, 105472
s_add_u32 s33, s33, s47
buffer_load_dwordx4 v152, s[12:15], s33 offen  lds
v_mfma_f32_16x16x32_bf16 v[208:211], a[132:135], v[136:139], v[208:211]
s_add_u32 m0, s49, 113664
s_add_u32 s33, s33, 8192
v_mfma_f32_16x16x32_bf16 v[220:223], a[132:135], v[140:143], v[220:223]
s_waitcnt lgkmcnt(0)
v_cndmask_b32 v144, v144, v32, s[78:79]
v_cndmask_b32 v145, v145, v32, s[78:79]
v_mfma_f32_16x16x32_bf16 v[188:191], a[136:139], v[128:131], v[188:191]
v_cndmask_b32 v146, v146, v32, s[78:79]
v_cndmask_b32 v147, v147, v32, s[78:79]
v_mfma_f32_16x16x32_bf16 v[192:195], v[128:131], a[140:143], v[192:195]
s_waitcnt vmcnt(4)
s_barrier
v_mfma_f32_16x16x32_bf16 v[200:203], a[136:139], v[132:135], v[200:203]
ds_read_b64_tr_b16 a[144:145], v165 offset:0
buffer_load_dwordx4 v152, s[12:15], s33 offen  lds
v_mfma_f32_16x16x32_bf16 v[204:207], v[132:135], a[140:143], v[204:207]
s_add_u32 s63, s84, 7
ds_read_b64_tr_b16 a[146:147], v165 offset:512
s_and_b32 s63, s63, 7
v_mfma_f32_16x16x32_bf16 v[212:215], a[136:139], v[136:139], v[212:215]
s_mul_i32 s63, s63, 196608
ds_read_b128 v[104:107], v3 offset:6144
s_add_u32 m0, s52, 24576
v_mfma_f32_16x16x32_bf16 v[216:219], v[136:139], a[140:143], v[216:219]
s_add_u32 s63, s63, s51
ds_read_b128 v[108:111], v3 offset:22528
buffer_load_dwordx4 v164, s[16:19], s63 offen offset:0  lds
v_mfma_f32_16x16x32_bf16 v[224:227], a[136:139], v[140:143], v[224:227]
ds_read_b128 v[112:115], v3 offset:38912
v_mfma_f32_16x16x32_bf16 v[228:231], v[140:143], a[140:143], v[228:231]
ds_read_b128 v[116:119], v3 offset:55296
v_mfma_f32_16x16x32_bf16 v[232:235], a[136:139], v[144:147], v[232:235]
ds_read_b64_tr_b16 a[148:149], v165 offset:1024
buffer_load_dwordx4 v164, s[16:19], s63 offen offset:1024  lds
v_mfma_f32_16x16x32_bf16 v[236:239], v[144:147], a[140:143], v[236:239]
ds_read_b64_tr_b16 a[150:151], v165 offset:1536
v_mfma_f32_16x16x32_bf16 v[100:103], a[132:135], v[144:147], v[100:103]
ds_read_b64_tr_b16 a[152:153], v165 offset:2048
v_mfma_f32_16x16x32_bf16 v[240:243], v[32:35], v[148:151], v[240:243]
ds_read_b64_tr_b16 a[154:155], v165 offset:2560
buffer_load_dwordx4 v164, s[16:19], s63 offen offset:2048  lds
v_mfma_f32_16x16x32_bf16 v[244:247], v[148:151], v[148:151], v[244:247]
ds_read_b128 v[120:123], v166 offset:6144
v_mfma_f32_16x16x32_bf16 v[252:255], v[144:147], v[144:147], v[252:255]
ds_read_b128 v[124:127], v168 offset:6144
s_waitcnt lgkmcnt(6)
v_mfma_f32_16x16x32_bf16 v[184:187], a[144:147], v[104:107], v[184:187]
s_add_u32 m0, s52, 36864
s_add_u32 s63, s63, 98304
buffer_load_dwordx4 v164, s[16:19], s63 offen offset:0  lds
v_mfma_f32_16x16x32_bf16 v[196:199], a[144:147], v[108:111], v[196:199]
v_mfma_f32_16x16x32_bf16 v[208:211], a[144:147], v[112:115], v[208:211]
v_mfma_f32_16x16x32_bf16 v[220:223], a[144:147], v[116:119], v[220:223]
s_waitcnt lgkmcnt(0)
v_cndmask_b32 v120, v120, v32, s[78:79]
v_cndmask_b32 v121, v121, v32, s[78:79]
v_mfma_f32_16x16x32_bf16 v[188:191], a[148:151], v[104:107], v[188:191]
v_cndmask_b32 v122, v122, v32, s[78:79]
v_cndmask_b32 v123, v123, v32, s[78:79]
v_mfma_f32_16x16x32_bf16 v[192:195], v[104:107], a[152:155], v[192:195]
s_waitcnt vmcnt(6)
s_barrier
v_mfma_f32_16x16x32_bf16 v[200:203], a[148:151], v[108:111], v[200:203]
ds_read_b64_tr_b16 a[156:157], v165 offset:12288
buffer_load_dwordx4 v164, s[16:19], s63 offen offset:1024  lds
v_mfma_f32_16x16x32_bf16 v[204:207], v[108:111], a[152:155], v[204:207]
ds_read_b64_tr_b16 a[158:159], v165 offset:12800
v_and_b32 v73, 15, v1
v_mfma_f32_16x16x32_bf16 v[212:215], a[148:151], v[112:115], v[212:215]
ds_read_b128 v[128:131], v4 offset:6144
v_lshrrev_b32_e64 v74, 4, v1
v_mfma_f32_16x16x32_bf16 v[216:219], v[112:115], a[152:155], v[216:219]
ds_read_b128 v[132:135], v4 offset:22528
buffer_load_dwordx4 v164, s[16:19], s63 offen offset:2048  lds
v_mfma_f32_16x16x32_bf16 v[224:227], a[148:151], v[116:119], v[224:227]
ds_read_b128 v[136:139], v4 offset:38912
v_lshlrev_b32 v73, 10, v73
v_mfma_f32_16x16x32_bf16 v[228:231], v[116:119], a[152:155], v[228:231]
ds_read_b128 v[140:143], v4 offset:55296
v_lshl_add_u32 v73, v74, 4, v73
v_mfma_f32_16x16x32_bf16 v[232:235], a[148:151], v[120:123], v[232:235]
ds_read_b64_tr_b16 a[160:161], v165 offset:13312
s_lshl_b32 s58, s6, 2
s_add_u32 s58, s58, s3
s_lshl_b32 s58, s58, 14
s_lshl_b32 s59, s7, 7
s_add_u32 s58, s58, s59
v_mfma_f32_16x16x32_bf16 v[236:239], v[120:123], a[152:155], v[236:239]
ds_read_b64_tr_b16 a[162:163], v165 offset:13824
buffer_load_dwordx4 v[20:23], v73, s[12:15], s58 offen offset:0
v_mfma_f32_16x16x32_bf16 v[100:103], a[144:147], v[120:123], v[100:103]
ds_read_b64_tr_b16 a[164:165], v165 offset:14336
v_mfma_f32_16x16x32_bf16 v[240:243], v[32:35], v[124:127], v[240:243]
ds_read_b64_tr_b16 a[166:167], v165 offset:14848
v_mfma_f32_16x16x32_bf16 v[244:247], v[124:127], v[124:127], v[244:247]
ds_read_b128 v[144:147], v167 offset:6144
buffer_load_dwordx4 v[24:27], v73, s[12:15], s58 offen offset:64
v_mfma_f32_16x16x32_bf16 v[252:255], v[120:123], v[120:123], v[252:255]
ds_read_b128 v[148:151], v169 offset:6144
v_and_b32_e64 v75, 3, v1
v_cmp_eq_u32 s[34:35], 1, v75
v_cmp_eq_u32 s[36:37], 2, v75
v_cmp_eq_u32 s[38:39], 3, v75
v_bfe_u32 v75, v1, 2, 2
v_cmp_eq_u32 vcc, v75, v74
v_mov_b32 v72, 81664
s_lshl_b32 s59, s3, 7
v_add_u32 v74, s59, v5
v_cndmask_b32 v74, v72, v74, vcc
v_cndmask_b32 v75, v72, v5, vcc
v_and_b32 v66, 15, v1
v_lshrrev_b32 v67, 4, v1
v_lshlrev_b32 v152, 4, v66
v_lshl_add_u32 v155, v67, 2, v152
v_lshl_add_u32 v152, v67, 9, v152
v_and_b32 v154, 7, v1
v_lshlrev_b32 v154, 4, v154
v_lshl_add_u32 v154, v67, 7, v154
v_lshrrev_b32 v66, 3, v66
v_lshl_add_u32 v154, v66, 13, v154
v_add_u32 v156, 98304, v2
v_cmp_gt_u32 vcc, 32, v1
v_mov_b32 v67, 0x80000000
s_nop 0
v_cndmask_b32 v155, v67, v155, vcc
s_waitcnt lgkmcnt(6)
v_mfma_f32_16x16x32_bf16 v[184:187], a[156:159], v[128:131], v[184:187]
v_mfma_f32_16x16x32_bf16 v[196:199], a[156:159], v[132:135], v[196:199]
buffer_load_dwordx4 v[36:39], v2, s[8:11], s75 offen offset:0 sc1
v_mfma_f32_16x16x32_bf16 v[208:211], a[156:159], v[136:139], v[208:211]
v_mfma_f32_16x16x32_bf16 v[220:223], a[156:159], v[140:143], v[220:223]
s_waitcnt lgkmcnt(0)
v_cndmask_b32 v144, v144, v32, s[78:79]
v_cndmask_b32 v145, v145, v32, s[78:79]
v_mfma_f32_16x16x32_bf16 v[188:191], a[160:163], v[128:131], v[188:191]
v_cndmask_b32 v146, v146, v32, s[78:79]
v_cndmask_b32 v147, v147, v32, s[78:79]
v_mfma_f32_16x16x32_bf16 v[192:195], v[128:131], a[164:167], v[192:195]
s_waitcnt vmcnt(6)
s_barrier
v_mfma_f32_16x16x32_bf16 v[200:203], a[160:163], v[132:135], v[200:203]
ds_read_b64_tr_b16 a[168:169], v165 offset:24576
buffer_load_dwordx4 v[40:43], v2, s[8:11], s75 offen offset:1024 sc1
v_mfma_f32_16x16x32_bf16 v[204:207], v[132:135], a[164:167], v[204:207]
ds_read_b64_tr_b16 a[170:171], v165 offset:25088
v_mfma_f32_16x16x32_bf16 v[212:215], a[160:163], v[136:139], v[212:215]
ds_read_b128 v[104:107], v3 offset:7168
v_mfma_f32_16x16x32_bf16 v[216:219], v[136:139], a[164:167], v[216:219]
ds_read_b128 v[108:111], v3 offset:23552
buffer_load_dwordx4 v[44:47], v2, s[8:11], s75 offen offset:2048 sc1
v_mfma_f32_16x16x32_bf16 v[224:227], a[160:163], v[140:143], v[224:227]
ds_read_b128 v[112:115], v3 offset:39936
v_mfma_f32_16x16x32_bf16 v[228:231], v[140:143], a[164:167], v[228:231]
ds_read_b128 v[116:119], v3 offset:56320
v_mfma_f32_16x16x32_bf16 v[232:235], a[160:163], v[144:147], v[232:235]
ds_read_b64_tr_b16 a[172:173], v165 offset:25600
buffer_load_dwordx4 v[48:51], v2, s[8:11], s75 offen offset:3072 sc1
v_mfma_f32_16x16x32_bf16 v[236:239], v[144:147], a[164:167], v[236:239]
ds_read_b64_tr_b16 a[174:175], v165 offset:26112
v_mfma_f32_16x16x32_bf16 v[100:103], a[156:159], v[144:147], v[100:103]
ds_read_b64_tr_b16 a[176:177], v165 offset:26624
v_mfma_f32_16x16x32_bf16 v[240:243], v[32:35], v[148:151], v[240:243]
ds_read_b64_tr_b16 a[178:179], v165 offset:27136
buffer_load_dword v10, v172, s[8:11], s77 offen offset:8 sc1
v_mfma_f32_16x16x32_bf16 v[244:247], v[148:151], v[148:151], v[244:247]
ds_read_b128 v[120:123], v166 offset:7168
v_mfma_f32_16x16x32_bf16 v[252:255], v[144:147], v[144:147], v[252:255]
ds_read_b128 v[124:127], v168 offset:7168
s_waitcnt lgkmcnt(6)
v_mfma_f32_16x16x32_bf16 v[184:187], a[168:171], v[104:107], v[184:187]
v_mfma_f32_16x16x32_bf16 v[196:199], a[168:171], v[108:111], v[196:199]
v_mfma_f32_16x16x32_bf16 v[208:211], a[168:171], v[112:115], v[208:211]
v_mfma_f32_16x16x32_bf16 v[220:223], a[168:171], v[116:119], v[220:223]
s_waitcnt lgkmcnt(0)
v_cndmask_b32 v120, v120, v32, s[78:79]
v_cndmask_b32 v121, v121, v32, s[78:79]
v_mfma_f32_16x16x32_bf16 v[188:191], a[172:175], v[104:107], v[188:191]
v_cndmask_b32 v122, v122, v32, s[78:79]
v_cndmask_b32 v123, v123, v32, s[78:79]
v_mfma_f32_16x16x32_bf16 v[192:195], v[104:107], a[176:179], v[192:195]
s_waitcnt vmcnt(7)
s_barrier
v_mfma_f32_16x16x32_bf16 v[200:203], a[172:175], v[108:111], v[200:203]
ds_read_b64_tr_b16 a[180:181], v165 offset:36864
v_mfma_f32_16x16x32_bf16 v[204:207], v[108:111], a[176:179], v[204:207]
ds_read_b64_tr_b16 a[182:183], v165 offset:37376
v_mfma_f32_16x16x32_bf16 v[212:215], a[172:175], v[112:115], v[212:215]
ds_read_b128 v[128:131], v4 offset:7168
v_mfma_f32_16x16x32_bf16 v[216:219], v[112:115], a[176:179], v[216:219]
ds_read_b128 v[132:135], v4 offset:23552
v_mfma_f32_16x16x32_bf16 v[224:227], a[172:175], v[116:119], v[224:227]
ds_read_b128 v[136:139], v4 offset:39936
v_mfma_f32_16x16x32_bf16 v[228:231], v[116:119], a[176:179], v[228:231]
ds_read_b128 v[140:143], v4 offset:56320
v_mfma_f32_16x16x32_bf16 v[232:235], a[172:175], v[120:123], v[232:235]
ds_read_b64_tr_b16 a[184:185], v165 offset:37888
v_mfma_f32_16x16x32_bf16 v[236:239], v[120:123], a[176:179], v[236:239]
ds_read_b64_tr_b16 a[186:187], v165 offset:38400
v_mfma_f32_16x16x32_bf16 v[100:103], a[168:171], v[120:123], v[100:103]
ds_read_b64_tr_b16 a[188:189], v165 offset:38912
v_mfma_f32_16x16x32_bf16 v[240:243], v[32:35], v[124:127], v[240:243]
ds_read_b64_tr_b16 a[190:191], v165 offset:39424
v_mfma_f32_16x16x32_bf16 v[244:247], v[124:127], v[124:127], v[244:247]
ds_read_b128 v[144:147], v167 offset:7168
v_mfma_f32_16x16x32_bf16 v[252:255], v[120:123], v[120:123], v[252:255]
ds_read_b128 v[148:151], v169 offset:7168
s_waitcnt lgkmcnt(6)
v_mfma_f32_16x16x32_bf16 v[184:187], a[180:183], v[128:131], v[184:187]
v_mfma_f32_16x16x32_bf16 v[196:199], a[180:183], v[132:135], v[196:199]
v_mfma_f32_16x16x32_bf16 v[208:211], a[180:183], v[136:139], v[208:211]
v_cmp_gt_u32 vcc, 16, v1
v_lshrrev_b32 v157, 3, v1
v_lshlrev_b32 v157, 15, v157
v_and_b32 v8, 7, v1
v_lshl_add_u32 v157, v8, 7, v157
v_mov_b32 v8, 0x80000000
s_mov_b32 s32, s53
v_cndmask_b32 v157, v8, v157, vcc
buffer_load_dword v157, v157, s[8:11], s32 offen
v_mfma_f32_16x16x32_bf16 v[220:223], a[180:183], v[140:143], v[220:223]
s_waitcnt lgkmcnt(0)
v_cndmask_b32 v144, v144, v32, s[78:79]
v_cndmask_b32 v145, v145, v32, s[78:79]
v_mfma_f32_16x16x32_bf16 v[188:191], a[184:187], v[128:131], v[188:191]
v_cndmask_b32 v146, v146, v32, s[78:79]
v_cndmask_b32 v147, v147, v32, s[78:79]
v_mfma_f32_16x16x32_bf16 v[192:195], v[128:131], a[188:191], v[192:195]
v_cmp_gt_u32 vcc, 16, v1
v_lshrrev_b32 v158, 3, v1
v_lshlrev_b32_e64 v158, 13, v158
v_and_b32 v8, 7, v1
v_lshl_add_u32 v158, v8, 7, v158
v_mov_b32 v8, 0x80000000
s_add_u32 s32, s64, 11403264
v_cndmask_b32 v158, v8, v158, vcc
buffer_load_dword v158, v158, s[8:11], s32 offen
v_mfma_f32_16x16x32_bf16 v[200:203], a[184:187], v[132:135], v[200:203]
v_mfma_f32_16x16x32_bf16 v[204:207], v[132:135], a[188:191], v[204:207]
v_mfma_f32_16x16x32_bf16 v[212:215], a[184:187], v[136:139], v[212:215]
v_mfma_f32_16x16x32_bf16 v[216:219], v[136:139], a[188:191], v[216:219]
v_mfma_f32_16x16x32_bf16 v[224:227], a[184:187], v[140:143], v[224:227]
v_mfma_f32_16x16x32_bf16 v[228:231], v[140:143], a[188:191], v[228:231]
v_mfma_f32_16x16x32_bf16 v[232:235], a[184:187], v[144:147], v[232:235]
v_mfma_f32_16x16x32_bf16 v[236:239], v[144:147], a[188:191], v[236:239]
v_mfma_f32_16x16x32_bf16 v[100:103], a[180:183], v[144:147], v[100:103]
v_mfma_f32_16x16x32_bf16 v[240:243], v[32:35], v[148:151], v[240:243]
v_mfma_f32_16x16x32_bf16 v[244:247], v[148:151], v[148:151], v[244:247]
v_mfma_f32_16x16x32_bf16 v[252:255], v[144:147], v[144:147], v[252:255]
s_waitcnt vmcnt(2)
s_not_b32 s32, s91
v_xor_b32 v36, s91, v36
v_xor_b32 v37, s32, v37
v_xor_b32 v40, s91, v40
v_xor_b32 v41, s32, v41
v_xor_b32 v44, s91, v44
v_xor_b32 v45, s32, v45
v_xor_b32 v48, s91, v48
v_xor_b32 v49, s32, v49
v_or3_b32 v36, v36, v37, v40
v_or3_b32 v44, v44, v45, v41
v_or3_b32 v36, v36, v48, v49
v_or_b32 v36, v36, v44
v_cmp_ne_u32 vcc, 0, v36
s_cbranch_vccnz L_gb_spin
L_gb_ok:
v_cmp_ne_u32 vcc, s76, v10
s_nop 0
s_and_b32 s99, vcc_lo, 0xffff
s_cselect_b32 s68, 0x40000000, 0
s_cselect_b32 s69, 0, 0x40000000
v_cmp_gt_u32 vcc, 2, v1
v_lshlrev_b32 v72, 7, v1
v_mov_b32 v8, 0x80000000
s_add_u32 s32, s65, 6209536
v_cndmask_b32 v72, v8, v72, vcc
s_or_b32 s32, s32, s68
buffer_load_dword v72, v72, s[8:11], s32 offen
s_add_u32 s63, s85, 0
buffer_load_dwordx4 a[192:195], v2, s[8:11], s63 offen offset:0
buffer_load_dwordx4 a[196:199], v2, s[8:11], s63 offen offset:1024
v_mov_b32_dpp v12, v100 row_newbcast:0 row_mask:0xf bank_mask:0xf
v_mov_b32_dpp v16, v232 row_newbcast:0 row_mask:0xf bank_mask:0xf
v_mov_b32_dpp v13, v101 row_newbcast:0 row_mask:0xf bank_mask:0xf
v_mov_b32_dpp v17, v233 row_newbcast:0 row_mask:0xf bank_mask:0xf
v_mov_b32_dpp v14, v102 row_newbcast:0 row_mask:0xf bank_mask:0xf
v_mov_b32_dpp v18, v234 row_newbcast:0 row_mask:0xf bank_mask:0xf
v_mov_b32_dpp v15, v103 row_newbcast:0 row_mask:0xf bank_mask:0xf
v_mov_b32_dpp v19, v235 row_newbcast:0 row_mask:0xf bank_mask:0xf
v_mov_b32 v11, v236
v_mov_b32 v45, v236
s_nop 1
v_permlane16_swap_b32 v11, v45
v_mov_b32 v45, v11
s_nop 1
v_permlane32_swap_b32 v11, v45
v_mov_b32 v248, v252
v_mov_b32 v45, v252
s_nop 1
v_permlane16_swap_b32 v248, v45
v_mov_b32 v45, v248
s_nop 1
v_permlane32_swap_b32 v248, v45
v_cndmask_b32 v241, v244, v245, s[34:35]
v_cndmask_b32 v241, v241, v246, s[36:37]
v_cndmask_b32 v241, v241, v247, s[38:39]
v_mul_f32 v240, 0xbb000000, v240
v_mul_f32 v241, 0x3b000000, v241
v_fma_f32 v241, -v240, v240, v241
v_max_f32_e64 v241, 0, v241
v_add_f32 v241, 0x3727c5ac, v241
v_rsq_f32_e64 v241, v241
v_cndmask_b32 v249, v252, v253, s[34:35]
v_cndmask_b32 v249, v249, v254, s[36:37]
v_cndmask_b32 v249, v249, v255, s[38:39]
v_mul_f32 v248, 0xbb000000, v248
v_mul_f32 v249, 0x3b000000, v249
v_fma_f32 v249, -v248, v248, v249
v_max_f32_e64 v249, 0, v249
v_add_f32 v249, 0x3727c5ac, v249
v_rsq_f32_e64 v249, v249
ds_write_b64 v74, v[240:241] offset:128
ds_write_b64 v75, v[248:249] offset:0
s_waitcnt lgkmcnt(0)
s_barrier
ds_read_b64 v[104:105], v5 offset:384
ds_read_b128 v[106:109], v6 offset:384
ds_read_b128 v[110:113], v6 offset:400
s_waitcnt lgkmcnt(0)
s_add_u32 m0, s60, 98304
s_add_u32 s63, s88, 0
buffer_load_dwordx4 v2, s[8:11], s63 offen offset:0 lds
ds_read_b64 v[56:57], v5 offset:256
ds_read_b128 v[58:61], v6 offset:256
ds_read_b128 v[62:65], v6 offset:272
v_pk_fma_f32 v[208:209], v[104:105], v[12:13], v[208:209] op_sel_hi:[0,1,1]
v_pk_fma_f32 v[210:211], v[104:105], v[14:15], v[210:211] op_sel_hi:[0,1,1]
v_mul_f32_e64 v70, s46, v105
v_cvt_pk_bf16_f32 v100, v208, v209
v_cvt_pk_bf16_f32 v101, v210, v211
v_pk_fma_f32 v[212:213], v[104:105], v[16:17], v[212:213] op_sel_hi:[0,1,1]
v_pk_fma_f32 v[214:215], v[104:105], v[18:19], v[214:215] op_sel_hi:[0,1,1]
v_pk_mul_f32 v[212:213], v[104:105], v[212:213] op_sel:[1,0] op_sel_hi:[1,1]
v_pk_mul_f32 v[214:215], v[104:105], v[214:215] op_sel:[1,0] op_sel_hi:[1,1]
buffer_load_dwordx4 v2, s[8:11], s63 offen offset:1024 lds
v_cvt_pk_bf16_f32 v82, v212, v213
v_cvt_pk_bf16_f32 v83, v214, v215
v_fmac_f32 v216, v106, v11
v_fmac_f32 v217, v108, v11
v_fmac_f32 v218, v110, v11
v_fmac_f32 v219, v112, v11
v_mul_f32 v216, v107, v216
v_mul_f32 v217, v109, v217
v_mul_f32_e64 v218, v111, v218
v_mul_f32 v219, v113, v219
v_cvt_pk_bf16_f32 v92, v216, v217
v_cvt_pk_bf16_f32 v93, v218, v219
buffer_load_dwordx4 v2, s[8:11], s63 offen offset:2048 lds
s_waitcnt lgkmcnt(0)
ds_read_b64 v[104:105], v5 offset:512
ds_read_b128 v[106:109], v6 offset:512
ds_read_b128 v[110:113], v6 offset:528
v_pk_fma_f32 v[196:197], v[56:57], v[12:13], v[196:197] op_sel_hi:[0,1,1]
v_pk_fma_f32 v[198:199], v[56:57], v[14:15], v[198:199] op_sel_hi:[0,1,1]
v_mul_f32_e64 v69, s46, v57
v_cvt_pk_bf16_f32 v98, v196, v197
v_cvt_pk_bf16_f32 v99, v198, v199
v_pk_fma_f32 v[200:201], v[56:57], v[16:17], v[200:201] op_sel_hi:[0,1,1]
v_pk_fma_f32 v[202:203], v[56:57], v[18:19], v[202:203] op_sel_hi:[0,1,1]
v_pk_mul_f32 v[200:201], v[56:57], v[200:201] op_sel:[1,0] op_sel_hi:[1,1]
buffer_load_dwordx4 v2, s[8:11], s63 offen offset:3072 lds
v_pk_mul_f32 v[202:203], v[56:57], v[202:203] op_sel:[1,0] op_sel_hi:[1,1]
v_cvt_pk_bf16_f32 v80, v200, v201
v_cvt_pk_bf16_f32 v81, v202, v203
v_fmac_f32 v204, v58, v11
v_fmac_f32 v205, v60, v11
v_fmac_f32 v206, v62, v11
v_fmac_f32 v207, v64, v11
v_mul_f32 v204, v59, v204
v_mul_f32 v205, v61, v205
v_mul_f32 v206, v63, v206
v_mul_f32 v207, v65, v207
v_cvt_pk_bf16_f32 v90, v204, v205
s_add_u32 m0, s60, 114688
s_add_u32 s63, s88, 16384
buffer_load_dwordx4 v2, s[8:11], s63 offen offset:0 lds
v_cvt_pk_bf16_f32 v91, v206, v207
s_waitcnt lgkmcnt(0)
ds_read_b64 v[56:57], v5 offset:128
ds_read_b128 v[58:61], v6 offset:128
ds_read_b128 v[62:65], v6 offset:144
v_pk_fma_f32 v[220:221], v[104:105], v[12:13], v[220:221] op_sel_hi:[0,1,1]
v_pk_fma_f32 v[222:223], v[104:105], v[14:15], v[222:223] op_sel_hi:[0,1,1]
v_mul_f32 v71, s46, v105
v_cvt_pk_bf16_f32 v102, v220, v221
v_cvt_pk_bf16_f32 v103, v222, v223
v_pk_fma_f32 v[224:225], v[104:105], v[16:17], v[224:225] op_sel_hi:[0,1,1]
v_pk_fma_f32 v[226:227], v[104:105], v[18:19], v[226:227] op_sel_hi:[0,1,1]
buffer_load_dwordx4 v2, s[8:11], s63 offen offset:1024 lds
v_pk_mul_f32 v[224:225], v[104:105], v[224:225] op_sel:[1,0] op_sel_hi:[1,1]
v_pk_mul_f32 v[226:227], v[104:105], v[226:227] op_sel:[1,0] op_sel_hi:[1,1]
v_cvt_pk_bf16_f32 v84, v224, v225
v_cvt_pk_bf16_f32 v85, v226, v227
v_fmac_f32 v228, v106, v11
v_fmac_f32 v229, v108, v11
v_fmac_f32 v230, v110, v11
v_fmac_f32 v231, v112, v11
v_mul_f32 v228, v107, v228
v_mul_f32 v229, v109, v229
v_mul_f32_e64 v230, v111, v230
v_mul_f32 v231, v113, v231
buffer_load_dwordx4 v2, s[8:11], s63 offen offset:2048 lds
v_cvt_pk_bf16_f32 v94, v228, v229
v_cvt_pk_bf16_f32 v95, v230, v231
v_mfma_f32_16x16x16_bf16 v[116:119], v[82:83], v[100:101], 0
v_mfma_f32_16x16x16_bf16 v[120:123], v[80:81], v[100:101], 0
s_waitcnt lgkmcnt(0)
ds_read_b64 v[104:105], v5 offset:0
ds_read_b128 v[106:109], v6 offset:0
ds_read_b128 v[110:113], v6 offset:16
v_pk_fma_f32 v[184:185], v[56:57], v[12:13], v[184:185] op_sel_hi:[0,1,1]
buffer_load_dwordx4 v2, s[8:11], s63 offen offset:3072 lds
v_pk_fma_f32 v[186:187], v[56:57], v[14:15], v[186:187] op_sel_hi:[0,1,1]
v_mul_f32_e64 v68, s46, v57
v_cvt_pk_bf16_f32 v96, v184, v185
v_cvt_pk_bf16_f32 v97, v186, v187
v_pk_fma_f32 v[188:189], v[56:57], v[16:17], v[188:189] op_sel_hi:[0,1,1]
v_pk_fma_f32 v[190:191], v[56:57], v[18:19], v[190:191] op_sel_hi:[0,1,1]
v_pk_mul_f32 v[188:189], v[56:57], v[188:189] op_sel:[1,0] op_sel_hi:[1,1]
v_pk_mul_f32 v[190:191], v[56:57], v[190:191] op_sel:[1,0] op_sel_hi:[1,1]
v_cvt_pk_bf16_f32 v78, v188, v189
v_cvt_pk_bf16_f32 v79, v190, v191
v_fmac_f32 v192, v58, v11
v_fmac_f32 v193, v60, v11
s_add_u32 m0, s60, 131072
s_add_u32 s63, s88, 32768
buffer_load_dwordx4 v2, s[8:11], s63 offen offset:0 lds
v_fmac_f32 v194, v62, v11
v_fmac_f32 v195, v64, v11
v_mul_f32 v192, v59, v192
v_mul_f32 v193, v61, v193
v_mul_f32 v194, v63, v194
v_mul_f32 v195, v65, v195
v_cvt_pk_bf16_f32 v88, v192, v193
v_cvt_pk_bf16_f32 v89, v194, v195
v_cndmask_b32 v138, v116, v117, s[40:41]
v_cndmask_b32 v139, v120, v121, s[40:41]
v_cndmask_b32 v136, v139, v138, s[42:43]
v_cndmask_b32 v138, v118, v119, s[40:41]
buffer_load_dwordx4 v2, s[8:11], s63 offen offset:1024 lds
v_cndmask_b32 v139, v122, v123, s[40:41]
v_cndmask_b32 v137, v139, v138, s[44:45]
v_max_f32_e64 v138, v136, v137
v_mov_b32 v139, v138
v_mfma_f32_16x16x16_bf16 v[160:163], v[84:85], v[102:103], 0
v_mfma_f32_16x16x16_bf16 v[164:167], v[82:83], v[102:103], 0
s_waitcnt lgkmcnt(0)
v_pk_fma_f32 v[232:233], v[104:105], v[16:17], v[232:233] op_sel_hi:[0,1,1]
v_pk_fma_f32 v[234:235], v[104:105], v[18:19], v[234:235] op_sel_hi:[0,1,1]
buffer_load_dwordx4 v2, s[8:11], s63 offen offset:2048 lds
v_pk_mul_f32 v[232:233], v[104:105], v[232:233] op_sel:[1,0] op_sel_hi:[1,1]
v_pk_mul_f32 v[234:235], v[104:105], v[234:235] op_sel:[1,0] op_sel_hi:[1,1]
v_cvt_pk_bf16_f32 v76, v232, v233
v_cvt_pk_bf16_f32 v77, v234, v235
v_fmac_f32 v236, v106, v11
v_fmac_f32 v237, v108, v11
v_fmac_f32 v238, v110, v11
v_fmac_f32 v239, v112, v11
v_mul_f32 v236, v107, v236
v_mul_f32 v237, v109, v237
v_mul_f32 v238, v111, v238
v_mul_f32 v239, v113, v239
buffer_load_dwordx4 v2, s[8:11], s63 offen offset:3072 lds
v_cvt_pk_bf16_f32 v86, v236, v237
v_cvt_pk_bf16_f32 v87, v238, v239
v_permlane16_swap_b32 v138, v139
v_max_f32 v138, v138, v139
v_mov_b32_e64 v139, v138
v_cndmask_b32 v182, v160, v161, s[40:41]
v_cndmask_b32 v183, v164, v165, s[40:41]
v_cndmask_b32 v180, v183, v182, s[42:43]
v_cndmask_b32 v182, v162, v163, s[40:41]
v_cndmask_b32 v183, v166, v167, s[40:41]
v_cndmask_b32 v181, v183, v182, s[44:45]
s_add_u32 m0, s60, 147456
s_add_u32 s63, s88, 49152
buffer_load_dwordx4 v2, s[8:11], s63 offen offset:0 lds
v_max_f32 v182, v180, v181
v_mov_b32 v183, v182
v_permlane32_swap_b32 v138, v139
v_max_f32 v138, v138, v139
v_mul_f32_e64 v138, v70, v138
v_fma_f32 v136, v136, v70, -v138
v_fma_f32 v137, v137, v70, -v138
v_exp_f32 v136, v136
v_exp_f32 v137, v137
buffer_load_dwordx4 v2, s[8:11], s63 offen offset:1024 lds
v_cvt_pk_bf16_f32 v136, v136, v136
v_cvt_pk_bf16_f32 v137, v137, v137
v_and_b32 v124, v136, v52
v_and_b32 v125, v137, v53
v_and_b32 v126, v136, v54
v_and_b32 v127, v137, v55
v_permlane16_swap_b32 v182, v183
v_max_f32 v182, v182, v183
v_mov_b32_e64 v183, v182
v_mfma_f32_16x16x32_bf16 v[132:135], v[32:35], v[124:127], 0
v_mfma_f32_16x16x32_bf16 v[128:131], v[90:93], v[124:127], 0
buffer_load_dwordx4 v2, s[8:11], s63 offen offset:2048 lds
v_permlane32_swap_b32 v182, v183
v_max_f32 v182, v182, v183
v_mul_f32_e64 v182, v71, v182
v_fma_f32 v180, v180, v71, -v182
v_fma_f32 v181, v181, v71, -v182
v_exp_f32 v180, v180
v_exp_f32 v181, v181
v_cvt_pk_bf16_f32 v180, v180, v180
v_cvt_pk_bf16_f32 v181, v181, v181
buffer_load_dwordx4 v2, s[8:11], s63 offen offset:3072 lds
v_and_b32 v168, v180, v52
v_and_b32 v169, v181, v53
v_and_b32 v170, v180, v54
v_and_b32 v171, v181, v55
v_rcp_f32 v136, v132
s_nop 0
v_mfma_f32_16x16x32_bf16 v[176:179], v[32:35], v[168:171], 0
v_mfma_f32_16x16x32_bf16 v[172:175], v[92:95], v[168:171], 0
v_mul_f32_e64 v128, v136, v128
s_add_u32 m0, s60, 0
s_add_u32 s62, s61, 0
buffer_load_dwordx4 v2, s[8:11], s62 offen offset:0  lds
v_mul_f32 v129, v136, v129
v_mul_f32 v130, v136, v130
v_mul_f32_e64 v131, v136, v131
v_cvt_pk_bf16_f32 v148, v128, v129
v_cvt_pk_bf16_f32 v149, v130, v131
v_rcp_f32_e64 v180, v176
v_mfma_f32_16x16x16_bf16 v[116:119], v[80:81], v[98:99], 0
v_mfma_f32_16x16x16_bf16 v[120:123], v[78:79], v[98:99], 0
v_mul_f32 v172, v180, v172
v_mul_f32 v173, v180, v173
v_mul_f32 v174, v180, v174
v_mul_f32 v175, v180, v175
v_cvt_pk_bf16_f32 v150, v172, v173
buffer_load_dwordx4 v2, s[8:11], s62 offen offset:1024  lds
v_cvt_pk_bf16_f32 v151, v174, v175
v_cndmask_b32 v138, v116, v117, s[40:41]
v_cndmask_b32 v139, v120, v121, s[40:41]
v_cndmask_b32 v136, v139, v138, s[42:43]
v_cndmask_b32 v138, v118, v119, s[40:41]
v_cndmask_b32 v139, v122, v123, s[40:41]
v_cndmask_b32 v137, v139, v138, s[44:45]
v_max_f32 v138, v136, v137
v_mov_b32 v139, v138
v_permlane16_swap_b32 v148, v150
v_permlane16_swap_b32 v149, v151
s_cmp_lg_u32 s68, 0
s_cbranch_scc1 L_alt0
buffer_store_dwordx4 v[148:151], v2, s[8:11], s54 offen
L_back0:
v_permlane16_swap_b32 v138, v139
buffer_load_dwordx4 v2, s[8:11], s62 offen offset:2048  lds
v_max_f32 v138, v138, v139
v_mov_b32_e64 v139, v138
v_mfma_f32_16x16x16_bf16 v[160:163], v[78:79], v[96:97], 0
v_mfma_f32_16x16x16_bf16 v[164:167], v[76:77], v[96:97], v[28:31]
v_permlane32_swap_b32 v138, v139
v_max_f32 v138, v138, v139
v_mul_f32_e64 v138, v69, v138
v_fma_f32 v136, v136, v69, -v138
v_fma_f32 v137, v137, v69, -v138
v_exp_f32 v136, v136
v_exp_f32 v137, v137
buffer_load_dwordx4 v2, s[8:11], s62 offen offset:3072  lds
v_cvt_pk_bf16_f32 v136, v136, v136
v_cvt_pk_bf16_f32 v137, v137, v137
v_and_b32 v124, v136, v52
v_and_b32 v125, v137, v53
v_and_b32 v126, v136, v54
v_and_b32 v127, v137, v55
v_cndmask_b32 v182, v160, v161, s[40:41]
v_cndmask_b32 v183, v164, v165, s[40:41]
v_cndmask_b32 v180, v183, v182, s[42:43]
v_cndmask_b32 v182, v162, v163, s[40:41]
v_cndmask_b32 v183, v166, v167, s[40:41]
v_cndmask_b32 v181, v183, v182, s[44:45]
v_max_f32 v182, v180, v181
v_mov_b32 v183, v182
v_mfma_f32_16x16x32_bf16 v[132:135], v[32:35], v[124:127], 0
v_mfma_f32_16x16x32_bf16 v[128:131], v[88:91], v[124:127], 0
s_add_u32 m0, s60, 16384
s_add_u32 s62, s61, 16384
buffer_load_dwordx4 v2, s[8:11], s62 offen offset:0  lds
v_permlane16_swap_b32 v182, v183
v_max_f32 v182, v182, v183
v_mov_b32 v183, v182
s_nop 0
v_rcp_f32 v136, v132
v_permlane32_swap_b32 v182, v183
v_max_f32 v182, v182, v183
v_mul_f32 v182, v68, v182
v_fma_f32 v180, v180, v68, -v182
v_fma_f32 v181, v181, v68, -v182
v_exp_f32 v180, v180
v_exp_f32 v181, v181
v_cvt_pk_bf16_f32 v180, v180, v180
v_cvt_pk_bf16_f32 v181, v181, v181
buffer_load_dwordx4 v2, s[8:11], s62 offen offset:1024  lds
v_and_b32 v168, v180, v52
v_and_b32 v169, v181, v53
v_and_b32 v170, v180, v54
v_and_b32 v171, v181, v55
v_mul_f32 v128, v136, v128
v_mul_f32 v129, v136, v129
v_mul_f32 v130, v136, v130
v_mul_f32 v131, v136, v131
v_cvt_pk_bf16_f32 v146, v128, v129
v_cvt_pk_bf16_f32 v147, v130, v131
v_mfma_f32_16x16x32_bf16 v[176:179], v[32:35], v[168:171], 0
v_mfma_f32_16x16x32_bf16 v[172:175], v[86:89], v[168:171], 0
s_nop 6
v_rcp_f32 v180, v176
buffer_load_dwordx4 v2, s[8:11], s62 offen offset:2048  lds
s_waitcnt vmcnt(5)
v_mov_b32 v8, 1
s_or_b32 s99, s89, s68
buffer_store_dword v8, v9, s[8:11], s99 offen
s_or_b32 s99, s89, s69
buffer_store_dword v8, v9, s[8:11], s99 offen sc1
v_mul_f32 v172, v180, v172
v_mul_f32 v173, v180, v173
v_mul_f32 v174, v180, v174
v_mul_f32 v175, v180, v175
v_cvt_pk_bf16_f32 v144, v172, v173
v_cvt_pk_bf16_f32 v145, v174, v175
v_cmp_gt_u32 vcc, 32, v1
v_lshlrev_b32 v153, 2, v1
v_mov_b32 v10, 0x80000000
v_cndmask_b32 v153, v10, v153, vcc
s_lshl_b32 s32, s6, 7
s_add_u32 s86, s32, 0
s_lshl_b32 s59, s6, 16
s_add_u32 s59, s59, 7208960
s_and_b32 s32, s80, 0xffff
s_add_u32 s59, s59, s32
buffer_load_dword v10, v153, s[8:11], s86 offen sc1
v_permlane16_swap_b32 v144, v146
v_permlane16_swap_b32 v145, v147
s_cmp_lg_u32 s68, 0
s_cbranch_scc1 L_alt1
buffer_store_dwordx4 v[144:147], v2, s[8:11], s53 offen
L_back1:
s_barrier
ds_read_b128 v[160:163], v156 offset:0
ds_read_b128 v[164:167], v156 offset:1024
ds_read_b128 v[168:171], v156 offset:2048
ds_read_b128 v[172:175], v156 offset:3072
ds_read_b128 v[176:179], v156 offset:4096
ds_read_b128 v[180:183], v156 offset:5120
ds_read_b128 v[184:187], v156 offset:6144
ds_read_b128 v[188:191], v156 offset:7168
s_add_u32 s87, s66, 4096
s_lshl_b32 s50, s4, 1
s_and_b32 s33, s3, 1
s_add_u32 s50, s50, s33
s_lshl_b32 s50, s50, 1
s_lshr_b32 s33, s3, 1
s_add_u32 s50, s50, s33
v_and_b32 v240, 31, v1
v_mov_b32 v3, v2
v_add_u32 v4, 0x10000, v2
v_add_u32 v5, 0x20000, v2
v_lshrrev_b32 v241, 5, v1
v_lshlrev_b32 v31, 4, v240
v_lshl_add_u32 v31, v241, 10, v31
v_lshrrev_b32 v243, 3, v240
v_lshlrev_b32 v243, 13, v243
v_lshl_add_u32 v243, v241, 7, v243
v_and_b32_e64 v240, 7, v1
v_lshl_add_u32 v243, v240, 4, v243
s_lshl_b32 s32, s50, 11
s_add_u32 s51, s32, 6209536
s_lshl_b32 s32, s50, 15
s_add_u32 s52, s32, 11403264
s_add_u32 s53, s52, 4096
s_lshl_b32 s54, s4, 1
s_and_b32 s33, s3, 1
s_add_u32 s54, s54, s33
s_lshl_b32 s54, s54, 1
s_lshr_b32 s33, s3, 1
s_add_u32 s54, s54, s33
s_mul_i32 s54, s54, 112
s_mul_i32 s33, s5, 7
s_add_u32 s54, s54, s33
s_lshl_b32 s54, s54, 10
s_add_u32 s54, s54, 17694720
s_lshr_b32 s32, s50, 1
s_lshl_b32 s32, s32, 4
s_add_u32 s32, s32, s5
s_lshl_b32 s32, s32, 1
s_and_b32 s33, s50, 1
s_add_u32 s32, s32, s33
s_lshl_b32 s32, s32, 2
s_add_u32 s81, s32, 8192
s_waitcnt vmcnt(0)
v_mov_b32_e64 v8, 2
s_or_b32 s99, s89, s68
buffer_store_dword v8, v9, s[8:11], s99 offen
s_or_b32 s99, s89, s69
buffer_store_dword v8, v9, s[8:11], s99 offen sc1
s_cmp_lt_u32 s3, 2
s_cbranch_scc1 L_wo_late0
v_cmp_gt_u32 vcc, 1, v10
s_nop 0
s_and_b32 s99, vcc_lo, 0xffffffff
s_cbranch_scc1 L_spin2
L_back2:
s_add_u32 s58, s59, 0
buffer_load_dwordx4 v[32:35], v152, s[8:11], s58 offen offset:0 sc1
buffer_load_dwordx4 v[36:39], v152, s[8:11], s58 offen offset:2048 sc1
s_add_u32 s58, s59, 4096
buffer_load_dwordx4 v[40:43], v152, s[8:11], s58 offen offset:0 sc1
buffer_load_dwordx4 v[44:47], v152, s[8:11], s58 offen offset:2048 sc1
s_add_u32 s58, s59, 8192
buffer_load_dwordx4 v[48:51], v152, s[8:11], s58 offen offset:0 sc1
buffer_load_dwordx4 v[52:55], v152, s[8:11], s58 offen offset:2048 sc1
s_branch L_wo_join0
L_wo_late0:
buffer_load_dword v10, v153, s[8:11], s86 offen sc1
s_sleep 2
buffer_load_dword v157, v153, s[8:11], s86 offen sc1
s_waitcnt vmcnt(1)
v_cmp_gt_u32 vcc, 2, v10
s_nop 0
s_and_b32 s99, vcc_lo, 0xffffffff
s_cbranch_scc1 L_spin3
L_back3:
s_add_u32 s58, s59, 0
buffer_load_dwordx4 v[32:35], v152, s[8:11], s58 offen offset:0 sc1
buffer_load_dwordx4 v[36:39], v152, s[8:11], s58 offen offset:2048 sc1
s_add_u32 s58, s59, 4096
buffer_load_dwordx4 v[40:43], v152, s[8:11], s58 offen offset:0 sc1
buffer_load_dwordx4 v[44:47], v152, s[8:11], s58 offen offset:2048 sc1
s_add_u32 s58, s59, 8192
buffer_load_dwordx4 v[48:51], v152, s[8:11], s58 offen offset:0 sc1
buffer_load_dwordx4 v[52:55], v152, s[8:11], s58 offen offset:2048 sc1
L_wo_join0:
s_waitcnt vmcnt(5) lgkmcnt(7)
v_mfma_f32_16x16x32_bf16 v[192:195], v[160:163], v[32:35], 0
s_waitcnt lgkmcnt(6)
ds_read_b128 v[160:163], v156 offset:8192
s_add_u32 s58, s59, 12288
buffer_load_dwordx4 v[56:59], v152, s[8:11], s58 offen offset:0 sc1
v_mfma_f32_16x16x32_bf16 v[196:199], v[164:167], v[32:35], 0
s_waitcnt lgkmcnt(6)
ds_read_b128 v[164:167], v156 offset:9216
v_mfma_f32_16x16x32_bf16 v[200:203], v[168:171], v[32:35], 0
s_waitcnt lgkmcnt(6)
ds_read_b128 v[168:171], v156 offset:10240
buffer_load_dwordx4 v[60:63], v152, s[8:11], s58 offen offset:2048 sc1
v_mfma_f32_16x16x32_bf16 v[204:207], v[172:175], v[32:35], 0
s_waitcnt vmcnt(6) lgkmcnt(6)
ds_read_b128 v[172:175], v156 offset:11264
v_mfma_f32_16x16x32_bf16 v[192:195], v[176:179], v[36:39], v[192:195]
s_waitcnt lgkmcnt(6)
ds_read_b128 v[176:179], v156 offset:12288
s_add_u32 s58, s59, 16384
buffer_load_dwordx4 v[64:67], v152, s[8:11], s58 offen offset:0 sc1
v_mfma_f32_16x16x32_bf16 v[196:199], v[180:183], v[36:39], v[196:199]
s_waitcnt lgkmcnt(6)
ds_read_b128 v[180:183], v156 offset:13312
v_mfma_f32_16x16x32_bf16 v[200:203], v[184:187], v[36:39], v[200:203]
s_waitcnt lgkmcnt(6)
ds_read_b128 v[184:187], v156 offset:14336
buffer_load_dwordx4 v[68:71], v152, s[8:11], s58 offen offset:2048 sc1
v_mfma_f32_16x16x32_bf16 v[204:207], v[188:191], v[36:39], v[204:207]
s_waitcnt vmcnt(7) lgkmcnt(6)
ds_read_b128 v[188:191], v156 offset:15360
v_mfma_f32_16x16x32_bf16 v[192:195], v[160:163], v[40:43], v[192:195]
s_waitcnt lgkmcnt(6)
ds_read_b128 v[160:163], v156 offset:16384
s_add_u32 s58, s59, 20480
buffer_load_dwordx4 v[72:75], v152, s[8:11], s58 offen offset:0 sc1
v_mfma_f32_16x16x32_bf16 v[196:199], v[164:167], v[40:43], v[196:199]
s_waitcnt lgkmcnt(6)
ds_read_b128 v[164:167], v156 offset:17408
v_mfma_f32_16x16x32_bf16 v[200:203], v[168:171], v[40:43], v[200:203]
s_waitcnt lgkmcnt(6)
ds_read_b128 v[168:171], v156 offset:18432
buffer_load_dwordx4 v[76:79], v152, s[8:11], s58 offen offset:2048 sc1
v_mfma_f32_16x16x32_bf16 v[204:207], v[172:175], v[40:43], v[204:207]
s_waitcnt vmcnt(8) lgkmcnt(6)
ds_read_b128 v[172:175], v156 offset:19456
v_lshlrev_b32 v208, 16, v20
v_mfma_f32_16x16x32_bf16 v[192:195], v[176:179], v[44:47], v[192:195]
s_waitcnt lgkmcnt(6)
ds_read_b128 v[176:179], v156 offset:20480
s_add_u32 s58, s59, 24576
buffer_load_dwordx4 v[80:83], v152, s[8:11], s58 offen offset:0 sc1
v_mfma_f32_16x16x32_bf16 v[196:199], v[180:183], v[44:47], v[196:199]
s_waitcnt lgkmcnt(6)
ds_read_b128 v[180:183], v156 offset:21504
v_and_b32 v209, 0xffff0000, v20
v_mfma_f32_16x16x32_bf16 v[200:203], v[184:187], v[44:47], v[200:203]
s_waitcnt lgkmcnt(6)
ds_read_b128 v[184:187], v156 offset:22528
buffer_load_dwordx4 v[84:87], v152, s[8:11], s58 offen offset:2048 sc1
v_mfma_f32_16x16x32_bf16 v[204:207], v[188:191], v[44:47], v[204:207]
s_waitcnt vmcnt(9) lgkmcnt(6)
ds_read_b128 v[188:191], v156 offset:23552
v_lshlrev_b32 v210, 16, v21
v_mfma_f32_16x16x32_bf16 v[192:195], v[160:163], v[48:51], v[192:195]
s_waitcnt lgkmcnt(6)
ds_read_b128 v[160:163], v156 offset:24576
s_add_u32 s58, s59, 28672
buffer_load_dwordx4 v[88:91], v152, s[8:11], s58 offen offset:0 sc1
v_mfma_f32_16x16x32_bf16 v[196:199], v[164:167], v[48:51], v[196:199]
s_waitcnt lgkmcnt(6)
ds_read_b128 v[164:167], v156 offset:25600
v_and_b32 v211, 0xffff0000, v21
v_mfma_f32_16x16x32_bf16 v[200:203], v[168:171], v[48:51], v[200:203]
s_waitcnt lgkmcnt(6)
ds_read_b128 v[168:171], v156 offset:26624
buffer_load_dwordx4 v[92:95], v152, s[8:11], s58 offen offset:2048 sc1
v_mfma_f32_16x16x32_bf16 v[204:207], v[172:175], v[48:51], v[204:207]
s_waitcnt vmcnt(10) lgkmcnt(6)
ds_read_b128 v[172:175], v156 offset:27648
v_lshlrev_b32 v212, 16, v22
v_mfma_f32_16x16x32_bf16 v[192:195], v[176:179], v[52:55], v[192:195]
s_waitcnt lgkmcnt(6)
ds_read_b128 v[176:179], v156 offset:28672
v_and_b32 v213, 0xffff0000, v22
v_mfma_f32_16x16x32_bf16 v[196:199], v[180:183], v[52:55], v[196:199]
s_waitcnt lgkmcnt(6)
ds_read_b128 v[180:183], v156 offset:29696
v_lshlrev_b32 v214, 16, v23
v_mfma_f32_16x16x32_bf16 v[200:203], v[184:187], v[52:55], v[200:203]
s_waitcnt lgkmcnt(6)
ds_read_b128 v[184:187], v156 offset:30720
v_and_b32 v215, 0xffff0000, v23
v_mfma_f32_16x16x32_bf16 v[204:207], v[188:191], v[52:55], v[204:207]
s_waitcnt vmcnt(9) lgkmcnt(6)
ds_read_b128 v[188:191], v156 offset:31744
v_lshlrev_b32 v216, 16, v24
v_mfma_f32_16x16x32_bf16 v[192:195], v[160:163], v[56:59], v[192:195]
s_waitcnt lgkmcnt(6)
ds_read_b128 v[160:163], v156 offset:32768
v_and_b32 v217, 0xffff0000, v24
v_mfma_f32_16x16x32_bf16 v[196:199], v[164:167], v[56:59], v[196:199]
s_waitcnt lgkmcnt(6)
ds_read_b128 v[164:167], v156 offset:33792
v_lshlrev_b32 v218, 16, v25
v_mfma_f32_16x16x32_bf16 v[200:203], v[168:171], v[56:59], v[200:203]
s_waitcnt lgkmcnt(6)
ds_read_b128 v[168:171], v156 offset:34816
v_and_b32 v219, 0xffff0000, v25
v_mfma_f32_16x16x32_bf16 v[204:207], v[172:175], v[56:59], v[204:207]
s_waitcnt vmcnt(8) lgkmcnt(6)
ds_read_b128 v[172:175], v156 offset:35840
v_lshlrev_b32 v220, 16, v26
v_mfma_f32_16x16x32_bf16 v[192:195], v[176:179], v[60:63], v[192:195]
s_waitcnt lgkmcnt(6)
ds_read_b128 v[176:179], v156 offset:36864
v_and_b32 v221, 0xffff0000, v26
v_mfma_f32_16x16x32_bf16 v[196:199], v[180:183], v[60:63], v[196:199]
s_waitcnt lgkmcnt(6)
ds_read_b128 v[180:183], v156 offset:37888
v_lshlrev_b32 v222, 16, v27
v_mfma_f32_16x16x32_bf16 v[200:203], v[184:187], v[60:63], v[200:203]
s_waitcnt lgkmcnt(6)
ds_read_b128 v[184:187], v156 offset:38912
v_and_b32 v223, 0xffff0000, v27
v_mfma_f32_16x16x32_bf16 v[204:207], v[188:191], v[60:63], v[204:207]
s_waitcnt vmcnt(7) lgkmcnt(6)
ds_read_b128 v[188:191], v156 offset:39936
v_mfma_f32_16x16x32_bf16 v[192:195], v[160:163], v[64:67], v[192:195]
s_waitcnt lgkmcnt(6)
ds_read_b128 v[160:163], v156 offset:40960
v_mfma_f32_16x16x32_bf16 v[196:199], v[164:167], v[64:67], v[196:199]
s_waitcnt lgkmcnt(6)
ds_read_b128 v[164:167], v156 offset:41984
v_mfma_f32_16x16x32_bf16 v[200:203], v[168:171], v[64:67], v[200:203]
s_waitcnt lgkmcnt(6)
ds_read_b128 v[168:171], v156 offset:43008
v_mfma_f32_16x16x32_bf16 v[204:207], v[172:175], v[64:67], v[204:207]
s_waitcnt vmcnt(6) lgkmcnt(6)
ds_read_b128 v[172:175], v156 offset:44032
v_mfma_f32_16x16x32_bf16 v[192:195], v[176:179], v[68:71], v[192:195]
s_waitcnt lgkmcnt(6)
ds_read_b128 v[176:179], v156 offset:45056
v_mfma_f32_16x16x32_bf16 v[196:199], v[180:183], v[68:71], v[196:199]
s_waitcnt lgkmcnt(6)
ds_read_b128 v[180:183], v156 offset:46080
v_mfma_f32_16x16x32_bf16 v[200:203], v[184:187], v[68:71], v[200:203]
s_waitcnt lgkmcnt(6)
ds_read_b128 v[184:187], v156 offset:47104
v_mfma_f32_16x16x32_bf16 v[204:207], v[188:191], v[68:71], v[204:207]
s_waitcnt vmcnt(5) lgkmcnt(6)
ds_read_b128 v[188:191], v156 offset:48128
v_mfma_f32_16x16x32_bf16 v[192:195], v[160:163], v[72:75], v[192:195]
s_waitcnt lgkmcnt(6)
ds_read_b128 v[160:163], v156 offset:49152
v_mfma_f32_16x16x32_bf16 v[196:199], v[164:167], v[72:75], v[196:199]
s_waitcnt lgkmcnt(6)
ds_read_b128 v[164:167], v156 offset:50176
v_mfma_f32_16x16x32_bf16 v[200:203], v[168:171], v[72:75], v[200:203]
s_waitcnt lgkmcnt(6)
ds_read_b128 v[168:171], v156 offset:51200
v_mfma_f32_16x16x32_bf16 v[204:207], v[172:175], v[72:75], v[204:207]
s_waitcnt vmcnt(4) lgkmcnt(6)
ds_read_b128 v[172:175], v156 offset:52224
v_mfma_f32_16x16x32_bf16 v[192:195], v[176:179], v[76:79], v[192:195]
s_waitcnt lgkmcnt(6)
ds_read_b128 v[176:179], v156 offset:53248
v_mfma_f32_16x16x32_bf16 v[196:199], v[180:183], v[76:79], v[196:199]
s_waitcnt lgkmcnt(6)
ds_read_b128 v[180:183], v156 offset:54272
s_add_u32 m0, s60, 16384
s_add_u32 s62, s61, 16384
buffer_load_dwordx4 v2, s[8:11], s62 offen offset:3072  lds
v_mfma_f32_16x16x32_bf16 v[200:203], v[184:187], v[76:79], v[200:203]
s_waitcnt lgkmcnt(6)
ds_read_b128 v[184:187], v156 offset:55296
v_mfma_f32_16x16x32_bf16 v[204:207], v[188:191], v[76:79], v[204:207]
s_waitcnt vmcnt(4) lgkmcnt(6)
ds_read_b128 v[188:191], v156 offset:56320
s_add_u32 m0, s60, 32768
s_add_u32 s62, s61, 32768
buffer_load_dwordx4 v2, s[8:11], s62 offen offset:0  lds
v_mfma_f32_16x16x32_bf16 v[192:195], v[160:163], v[80:83], v[192:195]
s_waitcnt lgkmcnt(6)
ds_read_b128 v[160:163], v156 offset:57344
v_mfma_f32_16x16x32_bf16 v[196:199], v[164:167], v[80:83], v[196:199]
s_waitcnt lgkmcnt(6)
ds_read_b128 v[164:167], v156 offset:58368
buffer_load_dwordx4 v2, s[8:11], s62 offen offset:1024  lds
v_mfma_f32_16x16x32_bf16 v[200:203], v[168:171], v[80:83], v[200:203]
s_waitcnt lgkmcnt(6)
ds_read_b128 v[168:171], v156 offset:59392
v_mfma_f32_16x16x32_bf16 v[204:207], v[172:175], v[80:83], v[204:207]
s_waitcnt vmcnt(5) lgkmcnt(6)
ds_read_b128 v[172:175], v156 offset:60416
buffer_load_dwordx4 v2, s[8:11], s62 offen offset:2048  lds
v_mfma_f32_16x16x32_bf16 v[192:195], v[176:179], v[84:87], v[192:195]
s_waitcnt lgkmcnt(6)
ds_read_b128 v[176:179], v156 offset:61440
v_mfma_f32_16x16x32_bf16 v[196:199], v[180:183], v[84:87], v[196:199]
s_waitcnt lgkmcnt(6)
ds_read_b128 v[180:183], v156 offset:62464
buffer_load_dwordx4 v2, s[8:11], s62 offen offset:3072  lds
v_mfma_f32_16x16x32_bf16 v[200:203], v[184:187], v[84:87], v[200:203]
s_waitcnt lgkmcnt(6)
ds_read_b128 v[184:187], v156 offset:63488
v_mfma_f32_16x16x32_bf16 v[204:207], v[188:191], v[84:87], v[204:207]
s_waitcnt vmcnt(6) lgkmcnt(6)
ds_read_b128 v[188:191], v156 offset:64512
s_add_u32 m0, s60, 49152
s_add_u32 s62, s61, 49152
buffer_load_dwordx4 v2, s[8:11], s62 offen offset:0  lds
v_mfma_f32_16x16x32_bf16 v[192:195], v[160:163], v[88:91], v[192:195]
s_waitcnt lgkmcnt(6)
v_mfma_f32_16x16x32_bf16 v[196:199], v[164:167], v[88:91], v[196:199]
s_waitcnt lgkmcnt(5)
buffer_load_dwordx4 v2, s[8:11], s62 offen offset:1024  lds
v_mfma_f32_16x16x32_bf16 v[200:203], v[168:171], v[88:91], v[200:203]
s_waitcnt lgkmcnt(4)
v_mfma_f32_16x16x32_bf16 v[204:207], v[172:175], v[88:91], v[204:207]
s_waitcnt vmcnt(7) lgkmcnt(3)
buffer_load_dwordx4 v2, s[8:11], s62 offen offset:2048  lds
v_mfma_f32_16x16x32_bf16 v[192:195], v[176:179], v[92:95], v[192:195]
s_waitcnt lgkmcnt(2)
v_mfma_f32_16x16x32_bf16 v[196:199], v[180:183], v[92:95], v[196:199]
s_waitcnt lgkmcnt(1)
buffer_load_dwordx4 v2, s[8:11], s62 offen offset:3072  lds
v_mfma_f32_16x16x32_bf16 v[200:203], v[184:187], v[92:95], v[200:203]
s_waitcnt lgkmcnt(0)
v_mfma_f32_16x16x32_bf16 v[204:207], v[188:191], v[92:95], v[204:207]
s_nop 0
v_pk_add_f32 v[208:209], v[208:209], v[192:193]
v_pk_add_f32 v[210:211], v[210:211], v[194:195]
v_pk_add_f32 v[212:213], v[212:213], v[196:197]
v_pk_add_f32 v[214:215], v[214:215], v[198:199]
s_nop 0
v_pk_add_f32 v[216:217], v[216:217], v[200:201]
v_pk_add_f32 v[218:219], v[218:219], v[202:203]
v_pk_add_f32 v[220:221], v[220:221], v[204:205]
v_pk_add_f32 v[222:223], v[222:223], v[206:207]
s_add_u32 s58, s64, 11403264
v_cvt_pk_bf16_f32 v20, v208, v209
v_cvt_pk_bf16_f32 v21, v210, v211
v_cvt_pk_bf16_f32 v22, v212, v213
v_cvt_pk_bf16_f32 v23, v214, v215
s_cmp_lg_u32 s68, 0
s_cbranch_scc1 L_alt4
buffer_store_dwordx4 v[20:23], v154, s[8:11], s58 offen
L_back4:
s_add_u32 s58, s64, 11403776
v_cvt_pk_bf16_f32 v24, v216, v217
v_cvt_pk_bf16_f32 v25, v218, v219
v_cvt_pk_bf16_f32 v26, v220, v221
v_cvt_pk_bf16_f32 v27, v222, v223
s_cmp_lg_u32 s68, 0
s_cbranch_scc1 L_alt5
buffer_store_dwordx4 v[24:27], v154, s[8:11], s58 offen
L_back5:
v_pk_add_f32 v[224:225], v[208:209], v[210:211]
v_pk_mul_f32 v[226:227], v[208:209], v[208:209]
v_pk_fma_f32 v[226:227], v[210:211], v[210:211], v[226:227]
v_pk_add_f32 v[224:225], v[224:225], v[212:213]
v_pk_fma_f32 v[226:227], v[212:213], v[212:213], v[226:227]
v_pk_add_f32 v[224:225], v[224:225], v[214:215]
v_pk_fma_f32 v[226:227], v[214:215], v[214:215], v[226:227]
v_pk_add_f32 v[224:225], v[224:225], v[216:217]
v_pk_fma_f32 v[226:227], v[216:217], v[216:217], v[226:227]
v_pk_add_f32 v[224:225], v[224:225], v[218:219]
v_pk_fma_f32 v[226:227], v[218:219], v[218:219], v[226:227]
v_pk_add_f32 v[224:225], v[224:225], v[220:221]
v_pk_fma_f32 v[226:227], v[220:221], v[220:221], v[226:227]
v_pk_add_f32 v[224:225], v[224:225], v[222:223]
v_pk_fma_f32 v[226:227], v[222:223], v[222:223], v[226:227]
v_add_f32 v224, v224, v225
v_add_f32 v226, v226, v227
s_add_u32 s58, s65, 6209536
s_nop 0
v_permlane16_swap_b32 v224, v226
v_add_f32 v224, v224, v226
v_mov_b32 v226, v224
s_nop 1
v_permlane32_swap_b32 v224, v226
v_add_f32_e64 v224, v224, v226
s_cmp_lg_u32 s68, 0
s_cbranch_scc1 L_alt6
buffer_store_dword v224, v155, s[8:11], s58 offen
L_back6:
s_add_u32 m0, s60, 65536
s_add_u32 s62, s61, 65536
buffer_load_dwordx4 v2, s[8:11], s62 offen offset:0  lds
buffer_load_dwordx4 v2, s[8:11], s62 offen offset:1024  lds
buffer_load_dwordx4 v2, s[8:11], s62 offen offset:2048  lds
buffer_load_dwordx4 v2, s[8:11], s62 offen offset:3072  lds
v_cmp_gt_u32 vcc, 16, v1
v_lshlrev_b32 v242, 2, v1
v_mov_b32 v10, 0x80000000
v_cndmask_b32 v242, v10, v242, vcc
s_lshl_b32 s32, s50, 6
s_add_u32 s86, s32, 4096
s_waitcnt vmcnt(4)
v_mov_b32 v8, 1
s_or_b32 s99, s87, s68
buffer_store_dword v8, v9, s[8:11], s99 offen
s_or_b32 s99, s87, s69
buffer_store_dword v8, v9, s[8:11], s99 offen sc1
buffer_load_dword v10, v242, s[8:11], s86 offen sc1
s_mov_b32 s87, s81
s_sleep 2
buffer_load_dword v20, v242, s[8:11], s86 offen sc1
s_waitcnt vmcnt(1)
v_cmp_gt_u32 vcc, 1, v10
s_nop 0
s_and_b32 s99, vcc_lo, 0xffff
s_cbranch_scc1 L_spin7
L_back7:
buffer_load_dwordx4 v[32:35], v243, s[8:11], s52 offen offset:0 sc1
buffer_load_dwordx4 v[36:39], v243, s[8:11], s52 offen offset:256 sc1
buffer_load_dwordx4 v[40:43], v243, s[8:11], s52 offen offset:512 sc1
buffer_load_dwordx4 v[44:47], v243, s[8:11], s52 offen offset:768 sc1
buffer_load_dwordx4 v[48:51], v243, s[8:11], s52 offen offset:1024 sc1
buffer_load_dwordx4 v[52:55], v243, s[8:11], s52 offen offset:1280 sc1
buffer_load_dwordx4 v[56:59], v243, s[8:11], s52 offen offset:1536 sc1
buffer_load_dwordx4 v[60:63], v243, s[8:11], s52 offen offset:1792 sc1
buffer_load_dwordx4 v[64:67], v243, s[8:11], s52 offen offset:2048 sc1
buffer_load_dwordx4 v[244:247], v31, s[8:11], s51 offen offset:0 sc1
buffer_load_dwordx4 v[248:251], v31, s[8:11], s51 offen offset:512 sc1
s_barrier
ds_read_b128 v[224:227], v3 offset:0
ds_read_b128 v[228:231], v3 offset:1024
ds_read_b128 v[232:235], v3 offset:2048
ds_read_b128 v[236:239], v3 offset:3072
ds_read_b128 v[252:255], v3 offset:4096
s_add_u32 s82, s54, 4096
s_lshl_b32 s32, s3, 0
s_add_u32 s32, s32, s5
s_add_u32 s32, s32, s4
s_and_b32 s83, s32, 0
s_waitcnt vmcnt(10) lgkmcnt(4)
v_mfma_f32_32x32x16_bf16 v[160:175], v[224:227], v[32:35], 0
s_waitcnt lgkmcnt(3)
ds_read_b128 v[224:227], v3 offset:5120
buffer_load_dwordx4 v[68:71], v243, s[8:11], s52 offen offset:2304 sc1
v_mfma_f32_32x32x16_bf16 v[176:191], v[228:231], v[32:35], 0
s_waitcnt lgkmcnt(3)
ds_read_b128 v[228:231], v3 offset:6144
v_mfma_f32_32x32x16_bf16 v[192:207], v[232:235], v[32:35], 0
s_waitcnt vmcnt(10) lgkmcnt(3)
ds_read_b128 v[232:235], v3 offset:7168
buffer_load_dwordx4 v[72:75], v243, s[8:11], s52 offen offset:2560 sc1
v_mfma_f32_32x32x16_bf16 v[160:175], v[236:239], v[36:39], v[160:175]
s_waitcnt lgkmcnt(3)
ds_read_b128 v[236:239], v3 offset:8192
v_mfma_f32_32x32x16_bf16 v[176:191], v[252:255], v[36:39], v[176:191]
s_waitcnt lgkmcnt(3)
ds_read_b128 v[252:255], v3 offset:9216
v_mfma_f32_32x32x16_bf16 v[192:207], v[224:227], v[36:39], v[192:207]
s_waitcnt vmcnt(10) lgkmcnt(3)
ds_read_b128 v[224:227], v3 offset:10240
buffer_load_dwordx4 v[76:79], v243, s[8:11], s52 offen offset:2816 sc1
v_mfma_f32_32x32x16_bf16 v[160:175], v[228:231], v[40:43], v[160:175]
s_waitcnt lgkmcnt(3)
ds_read_b128 v[228:231], v3 offset:11264
v_mfma_f32_32x32x16_bf16 v[176:191], v[232:235], v[40:43], v[176:191]
s_waitcnt lgkmcnt(3)
ds_read_b128 v[232:235], v3 offset:12288
buffer_load_dwordx4 v[80:83], v243, s[8:11], s52 offen offset:3072 sc1
v_mfma_f32_32x32x16_bf16 v[192:207], v[236:239], v[40:43], v[192:207]
s_waitcnt vmcnt(11) lgkmcnt(3)
ds_read_b128 v[236:239], v3 offset:13312
v_mfma_f32_32x32x16_bf16 v[160:175], v[252:255], v[44:47], v[160:175]
s_waitcnt lgkmcnt(3)
ds_read_b128 v[252:255], v3 offset:14336
s_add_u32 m0, s60, 81920
s_add_u32 s62, s61, 81920
buffer_load_dwordx4 v2, s[8:11], s62 offen offset:0  lds
v_mfma_f32_32x32x16_bf16 v[176:191], v[224:227], v[44:47], v[176:191]
s_waitcnt lgkmcnt(3)
ds_read_b128 v[224:227], v3 offset:15360
buffer_load_dwordx4 v[84:87], v243, s[8:11], s52 offen offset:3328 sc1
v_mfma_f32_32x32x16_bf16 v[192:207], v[228:231], v[44:47], v[192:207]
s_waitcnt vmcnt(12) lgkmcnt(3)
ds_read_b128 v[228:231], v3 offset:16384
v_mfma_f32_32x32x16_bf16 v[160:175], v[232:235], v[48:51], v[160:175]
s_waitcnt lgkmcnt(3)
ds_read_b128 v[232:235], v3 offset:17408
v_mfma_f32_32x32x16_bf16 v[176:191], v[236:239], v[48:51], v[176:191]
s_waitcnt lgkmcnt(3)
ds_read_b128 v[236:239], v3 offset:18432
buffer_load_dwordx4 v[88:91], v243, s[8:11], s52 offen offset:3584 sc1
buffer_load_dwordx4 v2, s[8:11], s62 offen offset:1024  lds
v_mfma_f32_32x32x16_bf16 v[192:207], v[252:255], v[48:51], v[192:207]
s_waitcnt vmcnt(13) lgkmcnt(3)
ds_read_b128 v[252:255], v3 offset:19456
v_mfma_f32_32x32x16_bf16 v[160:175], v[224:227], v[52:55], v[160:175]
s_waitcnt lgkmcnt(3)
ds_read_b128 v[224:227], v3 offset:20480
buffer_load_dwordx4 v[92:95], v243, s[8:11], s52 offen offset:3840 sc1
v_mfma_f32_32x32x16_bf16 v[176:191], v[228:231], v[52:55], v[176:191]
s_waitcnt lgkmcnt(3)
ds_read_b128 v[228:231], v3 offset:21504
v_mfma_f32_32x32x16_bf16 v[192:207], v[232:235], v[52:55], v[192:207]
s_waitcnt vmcnt(13) lgkmcnt(3)
ds_read_b128 v[232:235], v3 offset:22528
buffer_load_dwordx4 v2, s[8:11], s62 offen offset:2048  lds
v_mfma_f32_32x32x16_bf16 v[160:175], v[236:239], v[56:59], v[160:175]
s_waitcnt lgkmcnt(3)
ds_read_b128 v[236:239], v3 offset:23552
buffer_load_dwordx4 v[96:99], v243, s[8:11], s53 offen offset:0 sc1
v_mfma_f32_32x32x16_bf16 v[176:191], v[252:255], v[56:59], v[176:191]
s_waitcnt lgkmcnt(3)
ds_read_b128 v[252:255], v3 offset:24576
v_mfma_f32_32x32x16_bf16 v[192:207], v[224:227], v[56:59], v[192:207]
s_waitcnt vmcnt(14) lgkmcnt(3)
ds_read_b128 v[224:227], v3 offset:25600
buffer_load_dwordx4 v[100:103], v243, s[8:11], s53 offen offset:256 sc1
v_mfma_f32_32x32x16_bf16 v[160:175], v[228:231], v[60:63], v[160:175]
s_waitcnt lgkmcnt(3)
ds_read_b128 v[228:231], v3 offset:26624
buffer_load_dwordx4 v2, s[8:11], s62 offen offset:3072  lds
v_mfma_f32_32x32x16_bf16 v[176:191], v[232:235], v[60:63], v[176:191]
s_waitcnt lgkmcnt(3)
ds_read_b128 v[232:235], v3 offset:27648
v_mfma_f32_32x32x16_bf16 v[192:207], v[236:239], v[60:63], v[192:207]
s_waitcnt vmcnt(15) lgkmcnt(3)
ds_read_b128 v[236:239], v3 offset:28672
buffer_load_dwordx4 v[104:107], v243, s[8:11], s53 offen offset:512 sc1
v_mfma_f32_32x32x16_bf16 v[160:175], v[252:255], v[64:67], v[160:175]
s_waitcnt lgkmcnt(3)
ds_read_b128 v[252:255], v3 offset:29696
v_mfma_f32_32x32x16_bf16 v[176:191], v[224:227], v[64:67], v[176:191]
s_waitcnt lgkmcnt(3)
ds_read_b128 v[224:227], v3 offset:30720
s_add_u32 m0, s60, 98304
s_add_u32 s62, s61, 98304
buffer_load_dwordx4 v2, s[8:11], s62 offen offset:0  lds
v_mfma_f32_32x32x16_bf16 v[192:207], v[228:231], v[64:67], v[192:207]
s_waitcnt vmcnt(14) lgkmcnt(3)
ds_read_b128 v[228:231], v3 offset:31744
buffer_load_dwordx4 v[108:111], v243, s[8:11], s53 offen offset:768 sc1
v_mfma_f32_32x32x16_bf16 v[160:175], v[232:235], v[68:71], v[160:175]
s_waitcnt lgkmcnt(3)
s_barrier
ds_read_b128 v[232:235], v3 offset:32768
v_add_f32 v244, v244, v246
v_mfma_f32_32x32x16_bf16 v[176:191], v[236:239], v[68:71], v[176:191]
s_waitcnt lgkmcnt(3)
ds_read_b128 v[236:239], v3 offset:33792
buffer_load_dwordx4 v[112:115], v243, s[8:11], s53 offen offset:1024 sc1
v_add_f32 v245, v245, v247
v_add_f32 v248, v248, v250
v_add_f32 v249, v249, v251
v_mfma_f32_32x32x16_bf16 v[192:207], v[252:255], v[68:71], v[192:207]
s_waitcnt vmcnt(15) lgkmcnt(3)
ds_read_b128 v[252:255], v3 offset:34816
v_add_f32 v244, v244, v248
v_add_f32 v245, v245, v249
v_mfma_f32_32x32x16_bf16 v[160:175], v[224:227], v[72:75], v[160:175]
s_waitcnt lgkmcnt(3)
ds_read_b128 v[224:227], v3 offset:35840
buffer_load_dwordx4 v2, s[8:11], s62 offen offset:1024  lds
v_permlane32_swap_b32 v244, v245
v_add_f32 v244, v244, v245
v_mfma_f32_32x32x16_bf16 v[176:191], v[228:231], v[72:75], v[176:191]
s_waitcnt lgkmcnt(3)
ds_read_b128 v[228:231], v3 offset:36864
buffer_load_dwordx4 v[116:119], v243, s[8:11], s53 offen offset:1280 sc1
v_mov_b32 v245, v244
v_mfma_f32_32x32x16_bf16 v[192:207], v[232:235], v[72:75], v[192:207]
s_waitcnt vmcnt(16) lgkmcnt(3)
ds_read_b128 v[232:235], v3 offset:37888
v_permlane32_swap_b32 v244, v245
v_mul_f32 v244, 0xbb000000, v244
v_mul_f32 v245, 0x3b000000, v245
v_mfma_f32_32x32x16_bf16 v[160:175], v[236:239], v[76:79], v[160:175]
s_waitcnt lgkmcnt(3)
ds_read_b128 v[236:239], v3 offset:38912
buffer_load_dwordx4 v[120:123], v243, s[8:11], s53 offen offset:1536 sc1
v_fma_f32 v245, -v244, v244, v245
v_max_f32 v245, 0, v245
v_add_f32 v245, 0x3727c5ac, v245
v_mfma_f32_32x32x16_bf16 v[176:191], v[252:255], v[76:79], v[176:191]
s_waitcnt lgkmcnt(3)
ds_read_b128 v[252:255], v3 offset:39936
buffer_load_dwordx4 v2, s[8:11], s62 offen offset:2048  lds
v_mov_b32 v7, v245
v_rsq_f32 v6, v245
v_mfma_f32_32x32x16_bf16 v[192:207], v[224:227], v[76:79], v[192:207]
s_waitcnt vmcnt(17) lgkmcnt(3)
ds_read_b128 v[224:227], v3 offset:40960
v_cvt_pk_bf16_f32 v28, v244, v244
v_mul_f32 v6, 0xbfb8aa3b, v6
v_and_b32 v245, 0xffff0000, v28
v_sub_f32 v245, v244, v245
v_mfma_f32_32x32x16_bf16 v[160:175], v[228:231], v[80:83], v[160:175]
s_waitcnt lgkmcnt(3)
ds_read_b128 v[228:231], v3 offset:41984
buffer_load_dwordx4 v[124:127], v243, s[8:11], s53 offen offset:1792 sc1
v_mov_b32_e64 v30, 0
v_cvt_pk_bf16_f32 v29, v245, v30
v_mov_b32_e64 v31, 0
v_mfma_f32_32x32x16_bf16 v[176:191], v[232:235], v[80:83], v[176:191]
s_waitcnt lgkmcnt(3)
ds_read_b128 v[232:235], v3 offset:43008
v_mfma_f32_32x32x16_bf16 v[192:207], v[236:239], v[80:83], v[192:207]
s_waitcnt vmcnt(16) lgkmcnt(3)
ds_read_b128 v[236:239], v3 offset:44032
buffer_load_dwordx4 v2, s[8:11], s62 offen offset:3072  lds
v_mfma_f32_32x32x16_bf16 v[160:175], v[252:255], v[84:87], v[160:175]
s_waitcnt lgkmcnt(3)
ds_read_b128 v[252:255], v3 offset:45056
buffer_load_dwordx4 v[128:131], v243, s[8:11], s53 offen offset:2048 sc1
v_mfma_f32_32x32x16_bf16 v[176:191], v[224:227], v[84:87], v[176:191]
s_waitcnt lgkmcnt(3)
ds_read_b128 v[224:227], v3 offset:46080
v_mfma_f32_32x32x16_bf16 v[192:207], v[228:231], v[84:87], v[192:207]
s_waitcnt vmcnt(17) lgkmcnt(3)
ds_read_b128 v[228:231], v3 offset:47104
buffer_load_dwordx4 v[132:135], v243, s[8:11], s53 offen offset:2304 sc1
v_mfma_f32_32x32x16_bf16 v[160:175], v[232:235], v[88:91], v[160:175]
s_waitcnt lgkmcnt(3)
ds_read_b128 v[232:235], v3 offset:48128
s_add_u32 m0, s60, 114688
s_add_u32 s62, s61, 114688
buffer_load_dwordx4 v2, s[8:11], s62 offen offset:0  lds
v_mfma_f32_32x32x16_bf16 v[176:191], v[236:239], v[88:91], v[176:191]
s_waitcnt lgkmcnt(3)
ds_read_b128 v[236:239], v3 offset:49152
v_mfma_f32_32x32x16_bf16 v[192:207], v[252:255], v[88:91], v[192:207]
s_waitcnt vmcnt(17) lgkmcnt(3)
ds_read_b128 v[252:255], v3 offset:50176
buffer_load_dwordx4 v[136:139], v243, s[8:11], s53 offen offset:2560 sc1
v_mfma_f32_32x32x16_bf16 v[160:175], v[224:227], v[92:95], v[160:175]
s_waitcnt lgkmcnt(3)
ds_read_b128 v[224:227], v3 offset:51200
v_mfma_f32_32x32x16_bf16 v[176:191], v[228:231], v[92:95], v[176:191]
s_waitcnt lgkmcnt(3)
ds_read_b128 v[228:231], v3 offset:52224
buffer_load_dwordx4 v[140:143], v243, s[8:11], s53 offen offset:2816 sc1
buffer_load_dwordx4 v2, s[8:11], s62 offen offset:1024  lds
v_mfma_f32_32x32x16_bf16 v[192:207], v[232:235], v[92:95], v[192:207]
s_waitcnt vmcnt(18) lgkmcnt(3)
ds_read_b128 v[232:235], v3 offset:53248
v_mfma_f32_32x32x16_bf16 v[160:175], v[236:239], v[96:99], v[160:175]
s_waitcnt lgkmcnt(3)
ds_read_b128 v[236:239], v3 offset:54272
v_mfma_f32_32x32x16_bf16 v[176:191], v[252:255], v[96:99], v[176:191]
s_waitcnt lgkmcnt(3)
ds_read_b128 v[252:255], v3 offset:55296
buffer_load_dwordx4 v[144:147], v243, s[8:11], s53 offen offset:3072 sc1
v_mfma_f32_32x32x16_bf16 v[192:207], v[224:227], v[96:99], v[192:207]
s_waitcnt vmcnt(18) lgkmcnt(3)
ds_read_b128 v[224:227], v3 offset:56320
buffer_load_dwordx4 v2, s[8:11], s62 offen offset:2048  lds
v_mfma_f32_32x32x16_bf16 v[160:175], v[228:231], v[100:103], v[160:175]
s_waitcnt lgkmcnt(3)
ds_read_b128 v[228:231], v3 offset:57344
v_mfma_f32_32x32x16_bf16 v[176:191], v[232:235], v[100:103], v[176:191]
s_waitcnt lgkmcnt(3)
ds_read_b128 v[232:235], v3 offset:58368
buffer_load_dwordx4 v[148:151], v243, s[8:11], s53 offen offset:3328 sc1
v_mfma_f32_32x32x16_bf16 v[192:207], v[236:239], v[100:103], v[192:207]
s_waitcnt vmcnt(18) lgkmcnt(3)
ds_read_b128 v[236:239], v3 offset:59392
v_mfma_f32_32x32x16_bf16 v[160:175], v[252:255], v[104:107], v[160:175]
s_waitcnt lgkmcnt(3)
ds_read_b128 v[252:255], v3 offset:60416
buffer_load_dwordx4 v[152:155], v243, s[8:11], s53 offen offset:3584 sc1
buffer_load_dwordx4 v2, s[8:11], s62 offen offset:3072  lds
v_mfma_f32_32x32x16_bf16 v[176:191], v[224:227], v[104:107], v[176:191]
s_waitcnt lgkmcnt(3)
ds_read_b128 v[224:227], v3 offset:61440
v_mfma_f32_32x32x16_bf16 v[192:207], v[228:231], v[104:107], v[192:207]
s_waitcnt vmcnt(18) lgkmcnt(3)
ds_read_b128 v[228:231], v3 offset:62464
v_mfma_f32_32x32x16_bf16 v[160:175], v[232:235], v[108:111], v[160:175]
s_waitcnt lgkmcnt(3)
ds_read_b128 v[232:235], v3 offset:63488
buffer_load_dwordx4 v[156:159], v243, s[8:11], s53 offen offset:3840 sc1
v_mfma_f32_32x32x16_bf16 v[176:191], v[236:239], v[108:111], v[176:191]
s_waitcnt lgkmcnt(3)
ds_read_b128 v[236:239], v3 offset:64512
s_add_u32 m0, s60, 131072
s_add_u32 s62, s61, 131072
buffer_load_dwordx4 v2, s[8:11], s62 offen offset:0  lds
v_mfma_f32_32x32x16_bf16 v[192:207], v[252:255], v[108:111], v[192:207]
s_waitcnt vmcnt(19) lgkmcnt(3)
s_barrier
ds_read_b128 v[252:255], v4 offset:0
v_mfma_f32_32x32x16_bf16 v[160:175], v[224:227], v[112:115], v[160:175]
s_waitcnt lgkmcnt(3)
ds_read_b128 v[224:227], v4 offset:1024
v_mfma_f32_32x32x16_bf16 v[176:191], v[228:231], v[112:115], v[176:191]
s_waitcnt lgkmcnt(3)
ds_read_b128 v[228:231], v4 offset:2048
v_mfma_f32_32x32x16_bf16 v[192:207], v[232:235], v[112:115], v[192:207]
s_waitcnt vmcnt(17) lgkmcnt(3)
ds_read_b128 v[232:235], v4 offset:3072
buffer_load_dwordx4 v2, s[8:11], s62 offen offset:1024  lds
v_mfma_f32_32x32x16_bf16 v[160:175], v[236:239], v[116:119], v[160:175]
s_waitcnt lgkmcnt(3)
ds_read_b128 v[236:239], v4 offset:4096
v_mfma_f32_32x32x16_bf16 v[176:191], v[252:255], v[116:119], v[176:191]
s_waitcnt lgkmcnt(3)
ds_read_b128 v[252:255], v4 offset:5120
v_mfma_f32_32x32x16_bf16 v[192:207], v[224:227], v[116:119], v[192:207]
s_waitcnt vmcnt(17) lgkmcnt(3)
ds_read_b128 v[224:227], v4 offset:6144
buffer_load_dwordx4 v2, s[8:11], s62 offen offset:2048  lds
v_mfma_f32_32x32x16_bf16 v[160:175], v[228:231], v[120:123], v[160:175]
s_waitcnt lgkmcnt(3)
ds_read_b128 v[228:231], v4 offset:7168
v_mfma_f32_32x32x16_bf16 v[176:191], v[232:235], v[120:123], v[176:191]
s_waitcnt lgkmcnt(3)
ds_read_b128 v[232:235], v4 offset:8192
v_mfma_f32_32x32x16_bf16 v[192:207], v[236:239], v[120:123], v[192:207]
s_waitcnt vmcnt(16) lgkmcnt(3)
ds_read_b128 v[236:239], v4 offset:9216
buffer_load_dwordx4 v2, s[8:11], s62 offen offset:3072  lds
v_mfma_f32_32x32x16_bf16 v[160:175], v[252:255], v[124:127], v[160:175]
s_waitcnt lgkmcnt(3)
ds_read_b128 v[252:255], v4 offset:10240
v_mfma_f32_32x32x16_bf16 v[176:191], v[224:227], v[124:127], v[176:191]
s_waitcnt lgkmcnt(3)
ds_read_b128 v[224:227], v4 offset:11264
v_mfma_f32_32x32x16_bf16 v[192:207], v[228:231], v[124:127], v[192:207]
s_waitcnt vmcnt(15) lgkmcnt(3)
ds_read_b128 v[228:231], v4 offset:12288
s_add_u32 m0, s60, 147456
s_add_u32 s62, s61, 147456
buffer_load_dwordx4 v2, s[8:11], s62 offen offset:0  lds
v_mfma_f32_32x32x16_bf16 v[160:175], v[232:235], v[128:131], v[160:175]
s_waitcnt lgkmcnt(3)
ds_read_b128 v[232:235], v4 offset:13312
v_mfma_f32_32x32x16_bf16 v[176:191], v[236:239], v[128:131], v[176:191]
s_waitcnt lgkmcnt(3)
ds_read_b128 v[236:239], v4 offset:14336
v_mfma_f32_32x32x16_bf16 v[192:207], v[252:255], v[128:131], v[192:207]
s_waitcnt vmcnt(15) lgkmcnt(3)
ds_read_b128 v[252:255], v4 offset:15360
v_mfma_f32_32x32x16_bf16 v[160:175], v[224:227], v[132:135], v[160:175]
s_waitcnt lgkmcnt(3)
ds_read_b128 v[224:227], v4 offset:16384
buffer_load_dwordx4 v2, s[8:11], s62 offen offset:1024  lds
v_mfma_f32_32x32x16_bf16 v[176:191], v[228:231], v[132:135], v[176:191]
s_waitcnt lgkmcnt(3)
ds_read_b128 v[228:231], v4 offset:17408
v_mfma_f32_32x32x16_bf16 v[192:207], v[232:235], v[132:135], v[192:207]
s_waitcnt vmcnt(14) lgkmcnt(3)
ds_read_b128 v[232:235], v4 offset:18432
v_mfma_f32_32x32x16_bf16 v[160:175], v[236:239], v[136:139], v[160:175]
s_waitcnt lgkmcnt(3)
ds_read_b128 v[236:239], v4 offset:19456
buffer_load_dwordx4 v2, s[8:11], s62 offen offset:2048  lds
v_mfma_f32_32x32x16_bf16 v[176:191], v[252:255], v[136:139], v[176:191]
s_waitcnt lgkmcnt(3)
ds_read_b128 v[252:255], v4 offset:20480
v_mfma_f32_32x32x16_bf16 v[192:207], v[224:227], v[136:139], v[192:207]
s_waitcnt vmcnt(14) lgkmcnt(3)
ds_read_b128 v[224:227], v4 offset:21504
v_mfma_f32_32x32x16_bf16 v[160:175], v[228:231], v[140:143], v[160:175]
s_waitcnt lgkmcnt(3)
ds_read_b128 v[228:231], v4 offset:22528
buffer_load_dwordx4 v2, s[8:11], s62 offen offset:3072  lds
v_mfma_f32_32x32x16_bf16 v[176:191], v[232:235], v[140:143], v[176:191]
s_waitcnt lgkmcnt(3)
ds_read_b128 v[232:235], v4 offset:23552
v_mfma_f32_32x32x16_bf16 v[192:207], v[236:239], v[140:143], v[192:207]
s_waitcnt vmcnt(13) lgkmcnt(3)
ds_read_b128 v[236:239], v4 offset:24576
v_mfma_f32_32x32x16_bf16 v[160:175], v[252:255], v[144:147], v[160:175]
s_waitcnt lgkmcnt(3)
ds_read_b128 v[252:255], v4 offset:25600
s_add_u32 m0, s60, 0
s_add_u32 s62, s61, 163840
buffer_load_dwordx4 v2, s[8:11], s62 offen offset:0  lds
v_mfma_f32_32x32x16_bf16 v[176:191], v[224:227], v[144:147], v[176:191]
s_waitcnt lgkmcnt(3)
ds_read_b128 v[224:227], v4 offset:26624
v_mfma_f32_32x32x16_bf16 v[192:207], v[228:231], v[144:147], v[192:207]
s_waitcnt vmcnt(12) lgkmcnt(3)
ds_read_b128 v[228:231], v4 offset:27648
v_mfma_f32_32x32x16_bf16 v[160:175], v[232:235], v[148:151], v[160:175]
s_waitcnt lgkmcnt(3)
ds_read_b128 v[232:235], v4 offset:28672
v_mfma_f32_32x32x16_bf16 v[176:191], v[236:239], v[148:151], v[176:191]
s_waitcnt lgkmcnt(3)
ds_read_b128 v[236:239], v4 offset:29696
buffer_load_dwordx4 v2, s[8:11], s62 offen offset:1024  lds
v_mfma_f32_32x32x16_bf16 v[192:207], v[252:255], v[148:151], v[192:207]
s_waitcnt vmcnt(12) lgkmcnt(3)
ds_read_b128 v[252:255], v4 offset:30720
v_mfma_f32_32x32x16_bf16 v[160:175], v[224:227], v[152:155], v[160:175]
s_waitcnt lgkmcnt(3)
ds_read_b128 v[224:227], v4 offset:31744
v_mfma_f32_32x32x16_bf16 v[176:191], v[228:231], v[152:155], v[176:191]
s_waitcnt lgkmcnt(3)
s_barrier
ds_read_b128 v[228:231], v4 offset:32768
buffer_load_dwordx4 v2, s[8:11], s62 offen offset:2048  lds
v_mfma_f32_32x32x16_bf16 v[192:207], v[232:235], v[152:155], v[192:207]
s_waitcnt vmcnt(11) lgkmcnt(3)
ds_read_b128 v[232:235], v4 offset:33792
v_mfma_f32_32x32x16_bf16 v[160:175], v[236:239], v[156:159], v[160:175]
s_waitcnt lgkmcnt(3)
ds_read_b128 v[236:239], v4 offset:34816
v_mfma_f32_32x32x16_bf16 v[176:191], v[252:255], v[156:159], v[176:191]
s_waitcnt lgkmcnt(3)
ds_read_b128 v[252:255], v4 offset:35840
v_mfma_f32_32x32x16_bf16 v[192:207], v[224:227], v[156:159], v[192:207]
s_waitcnt lgkmcnt(3)
ds_read_b128 v[224:227], v4 offset:36864
buffer_load_dwordx4 v2, s[8:11], s62 offen offset:3072  lds
v_mfma_f32_32x32x16_bf16 v[160:175], v[228:231], v[28:31], v[160:175]
s_waitcnt lgkmcnt(3)
ds_read_b128 v[228:231], v4 offset:37888
v_mfma_f32_32x32x16_bf16 v[176:191], v[232:235], v[28:31], v[176:191]
s_waitcnt lgkmcnt(3)
ds_read_b128 v[232:235], v4 offset:38912
v_mfma_f32_32x32x16_bf16 v[192:207], v[236:239], v[28:31], v[192:207]
s_waitcnt lgkmcnt(3)
ds_read_b128 v[236:239], v4 offset:39936
s_add_u32 m0, s60, 16384
s_add_u32 s62, s61, 180224
buffer_load_dwordx4 v2, s[8:11], s62 offen offset:0  lds
v_mfma_f32_32x32x16_bf16 v[208:223], v[252:255], v[32:35], 0
s_waitcnt lgkmcnt(3)
ds_read_b128 v[252:255], v4 offset:40960
v_mul_f32 v244, v6, v160
v_mul_f32 v245, v6, v161
v_exp_f32 v244, v244
v_mfma_f32_32x32x16_bf16 v[208:223], v[224:227], v[36:39], v[208:223]
s_waitcnt lgkmcnt(3)
ds_read_b128 v[224:227], v4 offset:41984
v_exp_f32 v245, v245
v_mul_f32 v246, v160, v168
v_mul_f32 v247, v161, v169
v_mfma_f32_32x32x16_bf16 v[208:223], v[228:231], v[40:43], v[208:223]
s_waitcnt lgkmcnt(3)
ds_read_b128 v[228:231], v4 offset:43008
v_fma_f32 v244, v244, v7, v7
v_fma_f32 v245, v245, v7, v7
v_rcp_f32 v244, v244
v_mfma_f32_32x32x16_bf16 v[208:223], v[232:235], v[44:47], v[208:223]
s_waitcnt lgkmcnt(3)
ds_read_b128 v[232:235], v4 offset:44032
buffer_load_dwordx4 v2, s[8:11], s62 offen offset:1024  lds
v_rcp_f32 v245, v245
v_mfma_f32_32x32x16_bf16 v[208:223], v[236:239], v[48:51], v[208:223]
s_waitcnt lgkmcnt(3)
ds_read_b128 v[236:239], v4 offset:45056
v_mul_f32 v246, v246, v244
v_mul_f32 v247, v247, v245
v_cvt_pk_bf16_f32 v248, v246, v247
v_mul_f32 v244, v6, v162
v_mfma_f32_32x32x16_bf16 v[208:223], v[252:255], v[52:55], v[208:223]
s_waitcnt lgkmcnt(3)
ds_read_b128 v[252:255], v4 offset:46080
v_mul_f32_e64 v245, v6, v163
v_exp_f32 v244, v244
v_mfma_f32_32x32x16_bf16 v[208:223], v[224:227], v[56:59], v[208:223]
s_waitcnt lgkmcnt(3)
ds_read_b128 v[224:227], v4 offset:47104
buffer_load_dwordx4 v2, s[8:11], s62 offen offset:2048  lds
v_exp_f32 v245, v245
v_mul_f32 v246, v162, v170
v_mfma_f32_32x32x16_bf16 v[208:223], v[228:231], v[60:63], v[208:223]
s_waitcnt lgkmcnt(3)
ds_read_b128 v[228:231], v4 offset:48128
v_mul_f32 v247, v163, v171
v_fma_f32 v244, v244, v7, v7
v_fma_f32 v245, v245, v7, v7
v_mfma_f32_32x32x16_bf16 v[208:223], v[232:235], v[64:67], v[208:223]
s_waitcnt lgkmcnt(3)
s_barrier
ds_read_b128 v[232:235], v4 offset:49152
v_rcp_f32 v244, v244
v_mfma_f32_32x32x16_bf16 v[208:223], v[236:239], v[68:71], v[208:223]
s_waitcnt lgkmcnt(3)
ds_read_b128 v[236:239], v4 offset:50176
buffer_load_dwordx4 v2, s[8:11], s62 offen offset:3072  lds
v_rcp_f32 v245, v245
v_mfma_f32_32x32x16_bf16 v[208:223], v[252:255], v[72:75], v[208:223]
s_waitcnt lgkmcnt(3)
ds_read_b128 v[252:255], v4 offset:51200
v_mul_f32 v246, v246, v244
v_mul_f32 v247, v247, v245
v_cvt_pk_bf16_f32 v249, v246, v247
v_mul_f32 v244, v6, v164
v_mfma_f32_32x32x16_bf16 v[208:223], v[224:227], v[76:79], v[208:223]
s_waitcnt lgkmcnt(3)
ds_read_b128 v[224:227], v4 offset:52224
v_mul_f32_e64 v245, v6, v165
v_exp_f32 v244, v244
v_mfma_f32_32x32x16_bf16 v[208:223], v[228:231], v[80:83], v[208:223]
s_waitcnt lgkmcnt(3)
ds_read_b128 v[228:231], v4 offset:53248
s_add_u32 m0, s60, 32768
s_add_u32 s62, s61, 196608
buffer_load_dwordx4 v2, s[8:11], s62 offen offset:0  lds
v_exp_f32 v245, v245
v_mul_f32 v246, v164, v172
v_mfma_f32_32x32x16_bf16 v[208:223], v[232:235], v[84:87], v[208:223]
s_waitcnt lgkmcnt(3)
ds_read_b128 v[232:235], v4 offset:54272
v_mul_f32 v247, v165, v173
v_fma_f32 v244, v244, v7, v7
v_fma_f32 v245, v245, v7, v7
v_mfma_f32_32x32x16_bf16 v[208:223], v[236:239], v[88:91], v[208:223]
s_waitcnt lgkmcnt(3)
ds_read_b128 v[236:239], v4 offset:55296
v_rcp_f32 v244, v244
v_rcp_f32 v245, v245
v_mfma_f32_32x32x16_bf16 v[208:223], v[252:255], v[92:95], v[208:223]
s_waitcnt lgkmcnt(3)
ds_read_b128 v[252:255], v4 offset:56320
v_mul_f32 v246, v246, v244
v_mul_f32 v247, v247, v245
v_cvt_pk_bf16_f32 v250, v246, v247
v_mul_f32_e64 v244, v6, v166
v_mfma_f32_32x32x16_bf16 v[208:223], v[224:227], v[96:99], v[208:223]
s_waitcnt lgkmcnt(3)
ds_read_b128 v[224:227], v4 offset:57344
s_add_u32 s63, s85, 0
buffer_load_dwordx4 a[200:203], v2, s[8:11], s63 offen offset:2048
v_mul_f32 v245, v6, v167
v_exp_f32 v244, v244
v_mfma_f32_32x32x16_bf16 v[208:223], v[228:231], v[100:103], v[208:223]
s_waitcnt lgkmcnt(3)
ds_read_b128 v[228:231], v4 offset:58368
v_exp_f32 v245, v245
v_mul_f32_e64 v246, v166, v174
v_mul_f32 v247, v167, v175
v_mfma_f32_32x32x16_bf16 v[208:223], v[232:235], v[104:107], v[208:223]
s_waitcnt lgkmcnt(3)
ds_read_b128 v[232:235], v4 offset:59392
buffer_load_dwordx4 v2, s[8:11], s62 offen offset:1024  lds
v_fma_f32 v244, v244, v7, v7
v_fma_f32 v245, v245, v7, v7
v_mfma_f32_32x32x16_bf16 v[208:223], v[236:239], v[108:111], v[208:223]
s_waitcnt lgkmcnt(3)
ds_read_b128 v[236:239], v4 offset:60416
v_rcp_f32 v244, v244
v_rcp_f32 v245, v245
v_mfma_f32_32x32x16_bf16 v[208:223], v[252:255], v[112:115], v[208:223]
s_waitcnt lgkmcnt(3)
ds_read_b128 v[252:255], v4 offset:61440
v_mul_f32_e64 v246, v246, v244
v_mul_f32 v247, v247, v245
v_cvt_pk_bf16_f32 v251, v246, v247
v_mfma_f32_32x32x16_bf16 v[208:223], v[224:227], v[116:119], v[208:223]
s_waitcnt lgkmcnt(3)
ds_read_b128 v[224:227], v4 offset:62464
buffer_load_dwordx4 a[204:207], v2, s[8:11], s63 offen offset:3072
buffer_store_dwordx4 v[248:251], v2, s[8:11], s54 offen offset:0 sc1
v_mul_f32 v244, v6, v176
v_mfma_f32_32x32x16_bf16 v[208:223], v[228:231], v[120:123], v[208:223]
s_waitcnt lgkmcnt(3)
ds_read_b128 v[228:231], v4 offset:63488
v_mul_f32_e64 v245, v6, v177
v_exp_f32 v244, v244
v_mfma_f32_32x32x16_bf16 v[208:223], v[232:235], v[124:127], v[208:223]
s_waitcnt lgkmcnt(3)
ds_read_b128 v[232:235], v4 offset:64512
buffer_load_dwordx4 v2, s[8:11], s62 offen offset:2048  lds
v_exp_f32_e64 v245, v245
v_mul_f32 v246, v176, v184
v_mfma_f32_32x32x16_bf16 v[208:223], v[236:239], v[128:131], v[208:223]
s_waitcnt lgkmcnt(3)
s_waitcnt vmcnt(18)
s_barrier
ds_read_b128 v[236:239], v5 offset:0
v_mul_f32 v247, v177, v185
v_fma_f32 v244, v244, v7, v7
v_mfma_f32_32x32x16_bf16 v[208:223], v[252:255], v[132:135], v[208:223]
s_waitcnt lgkmcnt(3)
ds_read_b128 v[252:255], v5 offset:1024
v_fma_f32 v245, v245, v7, v7
v_rcp_f32 v244, v244
v_mfma_f32_32x32x16_bf16 v[208:223], v[224:227], v[136:139], v[208:223]
s_waitcnt lgkmcnt(3)
ds_read_b128 v[224:227], v5 offset:2048
s_add_u32 s63, s85, 4096
buffer_load_dwordx4 a[208:211], v2, s[8:11], s63 offen offset:0
v_rcp_f32 v245, v245
v_mfma_f32_32x32x16_bf16 v[208:223], v[228:231], v[140:143], v[208:223]
s_waitcnt lgkmcnt(3)
ds_read_b128 v[228:231], v5 offset:3072
v_mul_f32 v246, v246, v244
v_mul_f32 v247, v247, v245
v_cvt_pk_bf16_f32 v24, v246, v247
v_mul_f32 v244, v6, v178
v_mfma_f32_32x32x16_bf16 v[208:223], v[232:235], v[144:147], v[208:223]
s_waitcnt lgkmcnt(3)
ds_read_b128 v[232:235], v5 offset:4096
buffer_load_dwordx4 v2, s[8:11], s62 offen offset:3072  lds
v_mul_f32 v245, v6, v179
v_exp_f32 v244, v244
v_mfma_f32_32x32x16_bf16 v[208:223], v[236:239], v[148:151], v[208:223]
s_waitcnt lgkmcnt(3)
ds_read_b128 v[236:239], v5 offset:5120
v_exp_f32 v245, v245
v_mul_f32_e64 v246, v178, v186
v_mul_f32 v247, v179, v187
v_mfma_f32_32x32x16_bf16 v[208:223], v[252:255], v[152:155], v[208:223]
s_waitcnt lgkmcnt(3)
ds_read_b128 v[252:255], v5 offset:6144
v_fma_f32 v244, v244, v7, v7
v_fma_f32 v245, v245, v7, v7
v_rcp_f32 v244, v244
v_mfma_f32_32x32x16_bf16 v[208:223], v[224:227], v[156:159], v[208:223]
s_waitcnt lgkmcnt(3)
ds_read_b128 v[224:227], v5 offset:7168
buffer_load_dwordx4 a[212:215], v2, s[8:11], s63 offen offset:1024
v_rcp_f32 v245, v245
v_mfma_f32_32x32x16_bf16 v[208:223], v[228:231], v[28:31], v[208:223]
s_waitcnt lgkmcnt(3)
ds_read_b128 v[228:231], v5 offset:8192
v_mul_f32 v246, v246, v244
v_mul_f32 v247, v247, v245
v_cvt_pk_bf16_f32 v25, v246, v247
v_mul_f32 v244, v6, v180
v_mfma_f32_32x32x16_bf16 v[160:175], v[232:235], v[32:35], 0
s_waitcnt lgkmcnt(3)
ds_read_b128 v[232:235], v5 offset:9216
s_add_u32 m0, s60, 49152
s_add_u32 s62, s61, 212992
buffer_load_dwordx4 v2, s[8:11], s62 offen offset:0  lds
v_mul_f32 v245, v6, v181
v_exp_f32 v244, v244
v_mfma_f32_32x32x16_bf16 v[160:175], v[236:239], v[36:39], v[160:175]
s_waitcnt lgkmcnt(3)
ds_read_b128 v[236:239], v5 offset:10240
v_exp_f32 v245, v245
v_mul_f32_e64 v246, v180, v188
v_mul_f32 v247, v181, v189
v_mfma_f32_32x32x16_bf16 v[160:175], v[252:255], v[40:43], v[160:175]
s_waitcnt lgkmcnt(3)
ds_read_b128 v[252:255], v5 offset:11264
v_fma_f32 v244, v244, v7, v7
v_fma_f32 v245, v245, v7, v7
v_rcp_f32 v244, v244
v_mfma_f32_32x32x16_bf16 v[160:175], v[224:227], v[44:47], v[160:175]
s_waitcnt lgkmcnt(3)
ds_read_b128 v[224:227], v5 offset:12288
v_rcp_f32 v245, v245
v_mfma_f32_32x32x16_bf16 v[160:175], v[228:231], v[48:51], v[160:175]
s_waitcnt lgkmcnt(3)
ds_read_b128 v[228:231], v5 offset:13312
buffer_load_dwordx4 a[216:219], v2, s[8:11], s63 offen offset:2048
v_mul_f32 v246, v246, v244
v_mul_f32 v247, v247, v245
v_cvt_pk_bf16_f32 v26, v246, v247
v_mfma_f32_32x32x16_bf16 v[160:175], v[232:235], v[52:55], v[160:175]
s_waitcnt lgkmcnt(3)
ds_read_b128 v[232:235], v5 offset:14336
v_mul_f32 v244, v6, v182
v_mul_f32_e64 v245, v6, v183
v_exp_f32 v244, v244
v_mfma_f32_32x32x16_bf16 v[160:175], v[236:239], v[56:59], v[160:175]
s_waitcnt lgkmcnt(3)
ds_read_b128 v[236:239], v5 offset:15360
buffer_load_dwordx4 v2, s[8:11], s62 offen offset:1024  lds
v_exp_f32_e64 v245, v245
v_mul_f32 v246, v182, v190
v_mfma_f32_32x32x16_bf16 v[160:175], v[252:255], v[60:63], v[160:175]
s_waitcnt lgkmcnt(3)
s_waitcnt vmcnt(20)
s_barrier
ds_read_b128 v[252:255], v5 offset:16384
v_mul_f32 v247, v183, v191
v_fma_f32 v244, v244, v7, v7
v_mfma_f32_32x32x16_bf16 v[160:175], v[224:227], v[64:67], v[160:175]
s_waitcnt lgkmcnt(3)
ds_read_b128 v[224:227], v5 offset:17408
v_fma_f32 v245, v245, v7, v7
v_rcp_f32 v244, v244
v_mfma_f32_32x32x16_bf16 v[160:175], v[228:231], v[68:71], v[160:175]
s_waitcnt lgkmcnt(3)
ds_read_b128 v[228:231], v5 offset:18432
buffer_load_dwordx4 a[220:223], v2, s[8:11], s63 offen offset:3072
v_rcp_f32 v245, v245
v_mfma_f32_32x32x16_bf16 v[160:175], v[232:235], v[72:75], v[160:175]
s_waitcnt lgkmcnt(3)
ds_read_b128 v[232:235], v5 offset:19456
v_mul_f32_e64 v246, v246, v244
v_mul_f32 v247, v247, v245
v_cvt_pk_bf16_f32 v27, v246, v247
v_mfma_f32_32x32x16_bf16 v[160:175], v[236:239], v[76:79], v[160:175]
s_waitcnt lgkmcnt(3)
ds_read_b128 v[236:239], v5 offset:20480
buffer_load_dwordx4 v2, s[8:11], s62 offen offset:2048  lds
buffer_store_dwordx4 v[24:27], v2, s[8:11], s54 offen offset:1024 sc1
v_mul_f32 v244, v6, v192
v_mfma_f32_32x32x16_bf16 v[160:175], v[252:255], v[80:83], v[160:175]
s_waitcnt lgkmcnt(3)
ds_read_b128 v[252:255], v5 offset:21504
v_mul_f32 v245, v6, v193
v_exp_f32 v244, v244
v_mfma_f32_32x32x16_bf16 v[160:175], v[224:227], v[84:87], v[160:175]
s_waitcnt lgkmcnt(3)
ds_read_b128 v[224:227], v5 offset:22528
v_exp_f32 v245, v245
v_mul_f32_e64 v246, v192, v200
v_mul_f32 v247, v193, v201
v_mfma_f32_32x32x16_bf16 v[160:175], v[228:231], v[88:91], v[160:175]
s_waitcnt lgkmcnt(3)
ds_read_b128 v[228:231], v5 offset:23552
s_add_u32 s63, s85, 8192
buffer_load_dwordx4 a[224:227], v2, s[8:11], s63 offen offset:0
v_fma_f32 v244, v244, v7, v7
v_fma_f32 v245, v245, v7, v7
v_mfma_f32_32x32x16_bf16 v[160:175], v[232:235], v[92:95], v[160:175]
s_waitcnt lgkmcnt(3)
ds_read_b128 v[232:235], v5 offset:24576
v_rcp_f32 v244, v244
v_rcp_f32 v245, v245
v_mfma_f32_32x32x16_bf16 v[160:175], v[236:239], v[96:99], v[160:175]
s_waitcnt lgkmcnt(3)
ds_read_b128 v[236:239], v5 offset:25600
buffer_load_dwordx4 v2, s[8:11], s62 offen offset:3072  lds
v_mul_f32 v246, v246, v244
v_mul_f32 v247, v247, v245
v_cvt_pk_bf16_f32 v248, v246, v247
v_mfma_f32_32x32x16_bf16 v[160:175], v[252:255], v[100:103], v[160:175]
s_waitcnt lgkmcnt(3)
ds_read_b128 v[252:255], v5 offset:26624
v_mul_f32 v244, v6, v194
v_mul_f32 v245, v6, v195
v_exp_f32 v244, v244
v_mfma_f32_32x32x16_bf16 v[160:175], v[224:227], v[104:107], v[160:175]
s_waitcnt lgkmcnt(3)
ds_read_b128 v[224:227], v5 offset:27648
v_exp_f32 v245, v245
v_mul_f32_e64 v246, v194, v202
v_mul_f32 v247, v195, v203
v_mfma_f32_32x32x16_bf16 v[160:175], v[228:231], v[108:111], v[160:175]
s_waitcnt lgkmcnt(3)
ds_read_b128 v[228:231], v5 offset:28672
buffer_load_dwordx4 a[228:231], v2, s[8:11], s63 offen offset:1024
v_fma_f32 v244, v244, v7, v7
v_fma_f32 v245, v245, v7, v7
v_mfma_f32_32x32x16_bf16 v[160:175], v[232:235], v[112:115], v[160:175]
s_waitcnt lgkmcnt(3)
ds_read_b128 v[232:235], v5 offset:29696
v_rcp_f32 v244, v244
v_rcp_f32 v245, v245
v_mfma_f32_32x32x16_bf16 v[160:175], v[236:239], v[116:119], v[160:175]
s_waitcnt lgkmcnt(3)
ds_read_b128 v[236:239], v5 offset:30720
s_add_u32 m0, s60, 65536
s_add_u32 s62, s61, 229376
s_cmp_ge_u32 s3, 2
s_cselect_b32 s62, 0x40000000, s62
buffer_load_dwordx4 v2, s[8:11], s62 offen offset:0  lds
v_mul_f32 v246, v246, v244
v_mul_f32 v247, v247, v245
v_cvt_pk_bf16_f32 v249, v246, v247
v_mfma_f32_32x32x16_bf16 v[160:175], v[252:255], v[120:123], v[160:175]
s_waitcnt lgkmcnt(3)
ds_read_b128 v[252:255], v5 offset:31744
v_mul_f32 v244, v6, v196
v_mul_f32 v245, v6, v197
v_exp_f32 v244, v244
v_mfma_f32_32x32x16_bf16 v[160:175], v[224:227], v[124:127], v[160:175]
s_waitcnt lgkmcnt(3)
s_waitcnt vmcnt(23)
s_barrier
ds_read_b128 v[224:227], v3 offset:0
v_exp_f32 v245, v245
v_mfma_f32_32x32x16_bf16 v[160:175], v[228:231], v[128:131], v[160:175]
s_waitcnt lgkmcnt(3)
ds_read_b128 v[228:231], v3 offset:1024
v_mul_f32 v246, v196, v204
v_mul_f32 v247, v197, v205
v_fma_f32 v244, v244, v7, v7
v_fma_f32 v245, v245, v7, v7
v_mfma_f32_32x32x16_bf16 v[160:175], v[232:235], v[132:135], v[160:175]
s_waitcnt lgkmcnt(3)
ds_read_b128 v[232:235], v3 offset:2048
buffer_load_dwordx4 a[232:235], v2, s[8:11], s63 offen offset:2048
v_rcp_f32 v244, v244
v_mfma_f32_32x32x16_bf16 v[160:175], v[236:239], v[136:139], v[160:175]
s_waitcnt lgkmcnt(3)
ds_read_b128 v[236:239], v3 offset:3072
v_rcp_f32 v245, v245
v_mfma_f32_32x32x16_bf16 v[160:175], v[252:255], v[140:143], v[160:175]
s_waitcnt lgkmcnt(3)
ds_read_b128 v[252:255], v3 offset:4096
buffer_load_dwordx4 v2, s[8:11], s62 offen offset:1024  lds
v_mul_f32 v246, v246, v244
v_mul_f32 v247, v247, v245
v_cvt_pk_bf16_f32 v250, v246, v247
v_mfma_f32_32x32x16_bf16 v[160:175], v[224:227], v[144:147], v[160:175]
s_waitcnt lgkmcnt(3)
ds_read_b128 v[224:227], v3 offset:5120
v_mul_f32 v244, v6, v198
v_mul_f32 v245, v6, v199
v_exp_f32 v244, v244
v_mfma_f32_32x32x16_bf16 v[160:175], v[228:231], v[148:151], v[160:175]
s_waitcnt lgkmcnt(3)
ds_read_b128 v[228:231], v3 offset:6144
v_exp_f32 v245, v245
v_mul_f32_e64 v246, v198, v206
v_mul_f32 v247, v199, v207
v_mfma_f32_32x32x16_bf16 v[160:175], v[232:235], v[152:155], v[160:175]
s_waitcnt lgkmcnt(3)
ds_read_b128 v[232:235], v3 offset:7168
buffer_load_dwordx4 a[236:239], v2, s[8:11], s63 offen offset:3072
v_fma_f32 v244, v244, v7, v7
v_fma_f32 v245, v245, v7, v7
v_mfma_f32_32x32x16_bf16 v[160:175], v[236:239], v[156:159], v[160:175]
s_waitcnt lgkmcnt(3)
ds_read_b128 v[236:239], v3 offset:8192
v_rcp_f32 v244, v244
v_rcp_f32 v245, v245
v_mfma_f32_32x32x16_bf16 v[160:175], v[252:255], v[28:31], v[160:175]
s_waitcnt lgkmcnt(3)
ds_read_b128 v[252:255], v3 offset:9216
buffer_load_dwordx4 v2, s[8:11], s62 offen offset:2048  lds
v_mul_f32 v246, v246, v244
v_mul_f32 v247, v247, v245
v_cvt_pk_bf16_f32 v251, v246, v247
v_mfma_f32_32x32x16_bf16 v[176:191], v[224:227], v[32:35], 0
s_waitcnt lgkmcnt(3)
ds_read_b128 v[224:227], v3 offset:10240
buffer_store_dwordx4 v[248:251], v2, s[8:11], s54 offen offset:2048 sc1
v_mul_f32 v244, v6, v208
v_mul_f32 v245, v6, v209
v_mfma_f32_32x32x16_bf16 v[176:191], v[228:231], v[36:39], v[176:191]
s_waitcnt lgkmcnt(3)
ds_read_b128 v[228:231], v3 offset:11264
v_exp_f32_e64 v244, v244
v_exp_f32 v245, v245
v_mfma_f32_32x32x16_bf16 v[176:191], v[232:235], v[40:43], v[176:191]
s_waitcnt lgkmcnt(3)
ds_read_b128 v[232:235], v3 offset:12288
s_add_u32 s63, s85, 12288
buffer_load_dwordx4 a[240:243], v2, s[8:11], s63 offen offset:0
v_mul_f32_e64 v246, v208, v216
v_mul_f32 v247, v209, v217
v_fma_f32 v244, v244, v7, v7
v_mfma_f32_32x32x16_bf16 v[176:191], v[236:239], v[44:47], v[176:191]
s_waitcnt lgkmcnt(3)
ds_read_b128 v[236:239], v3 offset:13312
v_fma_f32 v245, v245, v7, v7
v_rcp_f32 v244, v244
v_mfma_f32_32x32x16_bf16 v[176:191], v[252:255], v[48:51], v[176:191]
s_waitcnt lgkmcnt(3)
ds_read_b128 v[252:255], v3 offset:14336
buffer_load_dwordx4 v2, s[8:11], s62 offen offset:3072  lds
v_rcp_f32 v245, v245
v_mfma_f32_32x32x16_bf16 v[176:191], v[224:227], v[52:55], v[176:191]
s_waitcnt lgkmcnt(3)
ds_read_b128 v[224:227], v3 offset:15360
v_mul_f32 v246, v246, v244
v_mul_f32 v247, v247, v245
v_cvt_pk_bf16_f32 v24, v246, v247
v_mul_f32 v244, v6, v210
v_mfma_f32_32x32x16_bf16 v[176:191], v[228:231], v[56:59], v[176:191]
s_waitcnt lgkmcnt(3)
s_waitcnt vmcnt(26)
s_barrier
ds_read_b128 v[228:231], v3 offset:16384
v_mul_f32 v245, v6, v211
v_mfma_f32_32x32x16_bf16 v[176:191], v[232:235], v[60:63], v[176:191]
s_waitcnt lgkmcnt(3)
ds_read_b128 v[232:235], v3 offset:17408
buffer_load_dwordx4 a[244:247], v2, s[8:11], s63 offen offset:1024
v_exp_f32 v244, v244
v_mfma_f32_32x32x16_bf16 v[176:191], v[236:239], v[64:67], v[176:191]
s_waitcnt lgkmcnt(3)
ds_read_b128 v[236:239], v3 offset:18432
v_exp_f32 v245, v245
v_mul_f32 v246, v210, v218
v_mul_f32 v247, v211, v219
v_mfma_f32_32x32x16_bf16 v[176:191], v[252:255], v[68:71], v[176:191]
s_waitcnt lgkmcnt(3)
ds_read_b128 v[252:255], v3 offset:19456
buffer_load_dwordx4 a[248:251], v2, s[8:11], s63 offen offset:2048
v_fma_f32 v244, v244, v7, v7
v_fma_f32 v245, v245, v7, v7
v_mfma_f32_32x32x16_bf16 v[176:191], v[224:227], v[72:75], v[176:191]
s_waitcnt lgkmcnt(3)
ds_read_b128 v[224:227], v3 offset:20480
v_rcp_f32 v244, v244
v_rcp_f32 v245, v245
v_mfma_f32_32x32x16_bf16 v[176:191], v[228:231], v[76:79], v[176:191]
s_waitcnt lgkmcnt(3)
ds_read_b128 v[228:231], v3 offset:21504
buffer_load_dwordx4 a[252:255], v2, s[8:11], s63 offen offset:3072
v_mul_f32 v246, v246, v244
v_mul_f32 v247, v247, v245
v_cvt_pk_bf16_f32 v25, v246, v247
v_mfma_f32_32x32x16_bf16 v[176:191], v[232:235], v[80:83], v[176:191]
s_waitcnt lgkmcnt(3)
ds_read_b128 v[232:235], v3 offset:22528
v_mul_f32 v244, v6, v212
v_mul_f32_e64 v245, v6, v213
v_exp_f32 v244, v244
v_mfma_f32_32x32x16_bf16 v[176:191], v[236:239], v[84:87], v[176:191]
s_waitcnt lgkmcnt(3)
ds_read_b128 v[236:239], v3 offset:23552
s_add_u32 m0, s60, 81920
s_add_u32 s62, s85, 16384
buffer_load_dwordx4 v2, s[8:11], s62 offen offset:0  lds
v_exp_f32 v245, v245
v_mul_f32 v246, v212, v220
v_mfma_f32_32x32x16_bf16 v[176:191], v[252:255], v[88:91], v[176:191]
s_waitcnt lgkmcnt(3)
ds_read_b128 v[252:255], v3 offset:24576
v_mul_f32 v247, v213, v221
v_fma_f32 v244, v244, v7, v7
v_fma_f32 v245, v245, v7, v7
v_mfma_f32_32x32x16_bf16 v[176:191], v[224:227], v[92:95], v[176:191]
s_waitcnt lgkmcnt(3)
ds_read_b128 v[224:227], v3 offset:25600
buffer_load_dwordx4 v2, s[8:11], s62 offen offset:1024  lds
v_rcp_f32 v244, v244
v_mfma_f32_32x32x16_bf16 v[176:191], v[228:231], v[96:99], v[176:191]
s_waitcnt lgkmcnt(3)
ds_read_b128 v[228:231], v3 offset:26624
v_rcp_f32 v245, v245
v_mfma_f32_32x32x16_bf16 v[176:191], v[232:235], v[100:103], v[176:191]
s_waitcnt lgkmcnt(3)
ds_read_b128 v[232:235], v3 offset:27648
buffer_load_dwordx4 v2, s[8:11], s62 offen offset:2048  lds
v_mul_f32 v246, v246, v244
v_mul_f32_e64 v247, v247, v245
v_cvt_pk_bf16_f32 v26, v246, v247
v_mfma_f32_32x32x16_bf16 v[176:191], v[236:239], v[104:107], v[176:191]
s_waitcnt lgkmcnt(3)
ds_read_b128 v[236:239], v3 offset:28672
v_mul_f32 v244, v6, v214
v_mul_f32_e64 v245, v6, v215
v_exp_f32 v244, v244
v_mfma_f32_32x32x16_bf16 v[176:191], v[252:255], v[108:111], v[176:191]
s_waitcnt lgkmcnt(3)
ds_read_b128 v[252:255], v3 offset:29696
buffer_load_dwordx4 v2, s[8:11], s62 offen offset:3072  lds
v_exp_f32_e64 v245, v245
v_mul_f32 v246, v214, v222
v_mfma_f32_32x32x16_bf16 v[176:191], v[224:227], v[112:115], v[176:191]
s_waitcnt lgkmcnt(3)
ds_read_b128 v[224:227], v3 offset:30720
v_mul_f32 v247, v215, v223
v_fma_f32 v244, v244, v7, v7
v_fma_f32 v245, v245, v7, v7
v_mfma_f32_32x32x16_bf16 v[176:191], v[228:231], v[116:119], v[176:191]
s_waitcnt lgkmcnt(3)
ds_read_b128 v[228:231], v3 offset:31744
s_add_u32 m0, s60, 98304
s_add_u32 s62, s85, 20480
buffer_load_dwordx4 v2, s[8:11], s62 offen offset:0  lds
v_rcp_f32 v244, v244
v_mfma_f32_32x32x16_bf16 v[176:191], v[232:235], v[120:123], v[176:191]
s_waitcnt lgkmcnt(3)
s_waitcnt vmcnt(26)
s_barrier
ds_read_b128 v[232:235], v3 offset:32768
v_rcp_f32 v245, v245
v_mfma_f32_32x32x16_bf16 v[176:191], v[236:239], v[124:127], v[176:191]
s_waitcnt lgkmcnt(3)
ds_read_b128 v[236:239], v3 offset:33792
v_mul_f32_e64 v246, v246, v244
v_mul_f32 v247, v247, v245
v_cvt_pk_bf16_f32 v27, v246, v247
v_mfma_f32_32x32x16_bf16 v[176:191], v[252:255], v[128:131], v[176:191]
s_waitcnt lgkmcnt(3)
ds_read_b128 v[252:255], v3 offset:34816
buffer_load_dwordx4 v2, s[8:11], s62 offen offset:1024  lds
buffer_store_dwordx4 v[24:27], v2, s[8:11], s54 offen offset:3072 sc1
v_mul_f32 v244, v6, v160
v_mfma_f32_32x32x16_bf16 v[176:191], v[224:227], v[132:135], v[176:191]
s_waitcnt lgkmcnt(3)
ds_read_b128 v[224:227], v3 offset:35840
v_mul_f32_e64 v245, v6, v161
v_exp_f32 v244, v244
v_mfma_f32_32x32x16_bf16 v[176:191], v[228:231], v[136:139], v[176:191]
s_waitcnt lgkmcnt(3)
ds_read_b128 v[228:231], v3 offset:36864
buffer_load_dwordx4 v2, s[8:11], s62 offen offset:2048  lds
v_exp_f32_e64 v245, v245
v_mul_f32 v246, v160, v168
v_mfma_f32_32x32x16_bf16 v[176:191], v[232:235], v[140:143], v[176:191]
s_waitcnt lgkmcnt(3)
ds_read_b128 v[232:235], v3 offset:37888
v_mul_f32 v247, v161, v169
v_fma_f32 v244, v244, v7, v7
v_fma_f32 v245, v245, v7, v7
v_mfma_f32_32x32x16_bf16 v[176:191], v[236:239], v[144:147], v[176:191]
s_waitcnt lgkmcnt(3)
ds_read_b128 v[236:239], v3 offset:38912
buffer_load_dwordx4 v2, s[8:11], s62 offen offset:3072  lds
v_rcp_f32 v244, v244
v_mfma_f32_32x32x16_bf16 v[176:191], v[252:255], v[148:151], v[176:191]
s_waitcnt lgkmcnt(3)
ds_read_b128 v[252:255], v3 offset:39936
v_rcp_f32 v245, v245
v_mfma_f32_32x32x16_bf16 v[176:191], v[224:227], v[152:155], v[176:191]
s_waitcnt lgkmcnt(3)
ds_read_b128 v[224:227], v3 offset:40960
s_add_u32 m0, s60, 114688
s_add_u32 s62, s85, 24576
buffer_load_dwordx4 v2, s[8:11], s62 offen offset:0  lds
v_mul_f32 v246, v246, v244
v_mul_f32 v247, v247, v245
v_cvt_pk_bf16_f32 v248, v246, v247
v_mfma_f32_32x32x16_bf16 v[176:191], v[228:231], v[156:159], v[176:191]
s_waitcnt lgkmcnt(3)
ds_read_b128 v[228:231], v3 offset:41984
v_mul_f32 v244, v6, v162
v_mul_f32_e64 v245, v6, v163
v_exp_f32 v244, v244
v_mfma_f32_32x32x16_bf16 v[176:191], v[232:235], v[28:31], v[176:191]
s_waitcnt lgkmcnt(3)
ds_read_b128 v[232:235], v3 offset:43008
buffer_load_dwordx4 v2, s[8:11], s62 offen offset:1024  lds
v_exp_f32 v245, v245
v_mul_f32 v246, v162, v170
v_mfma_f32_32x32x16_bf16 v[192:207], v[236:239], v[32:35], 0
s_waitcnt lgkmcnt(3)
ds_read_b128 v[236:239], v3 offset:44032
v_mul_f32 v247, v163, v171
v_fma_f32 v244, v244, v7, v7
v_fma_f32 v245, v245, v7, v7
v_mfma_f32_32x32x16_bf16 v[192:207], v[252:255], v[36:39], v[192:207]
s_waitcnt lgkmcnt(3)
ds_read_b128 v[252:255], v3 offset:45056
buffer_load_dwordx4 v2, s[8:11], s62 offen offset:2048  lds
s_waitcnt vmcnt(5)
v_mov_b32 v8, 1
s_or_b32 s99, s87, s68
buffer_store_dword v8, v9, s[8:11], s99 offen
s_or_b32 s99, s87, s69
buffer_store_dword v8, v9, s[8:11], s99 offen sc1
v_mfma_f32_32x32x16_bf16 v[192:207], v[224:227], v[40:43], v[192:207]
s_waitcnt lgkmcnt(3)
ds_read_b128 v[224:227], v3 offset:46080
s_add_u32 s63, s85, 49152
buffer_load_dwordx4 v[32:35], v2, s[8:11], s63 offen offset:0
v_rcp_f32 v244, v244
v_mfma_f32_32x32x16_bf16 v[192:207], v[228:231], v[44:47], v[192:207]
s_waitcnt lgkmcnt(3)
ds_read_b128 v[228:231], v3 offset:47104
buffer_load_dwordx4 v2, s[8:11], s62 offen offset:3072  lds
v_rcp_f32 v245, v245
v_mfma_f32_32x32x16_bf16 v[192:207], v[232:235], v[48:51], v[192:207]
s_waitcnt lgkmcnt(3)
ds_read_b128 v[232:235], v3 offset:48128
v_mul_f32 v246, v246, v244
v_mul_f32 v247, v247, v245
v_cvt_pk_bf16_f32 v249, v246, v247
v_mul_f32_e64 v244, v6, v164
v_mfma_f32_32x32x16_bf16 v[192:207], v[236:239], v[52:55], v[192:207]
s_waitcnt lgkmcnt(3)
s_barrier
ds_read_b128 v[236:239], v3 offset:49152
s_add_u32 m0, s60, 131072
s_add_u32 s62, s85, 28672
buffer_load_dwordx4 v2, s[8:11], s62 offen offset:0  lds
buffer_load_dwordx4 v[36:39], v2, s[8:11], s63 offen offset:1024
v_mfma_f32_32x32x16_bf16 v[192:207], v[252:255], v[56:59], v[192:207]
s_waitcnt lgkmcnt(3)
ds_read_b128 v[252:255], v3 offset:50176
v_mul_f32 v245, v6, v165
v_exp_f32 v244, v244
v_mfma_f32_32x32x16_bf16 v[192:207], v[224:227], v[60:63], v[192:207]
s_waitcnt lgkmcnt(3)
ds_read_b128 v[224:227], v3 offset:51200
v_exp_f32 v245, v245
v_mul_f32 v246, v164, v172
v_mul_f32 v247, v165, v173
v_mfma_f32_32x32x16_bf16 v[192:207], v[228:231], v[64:67], v[192:207]
s_waitcnt lgkmcnt(3)
ds_read_b128 v[228:231], v3 offset:52224
buffer_load_dwordx4 v2, s[8:11], s62 offen offset:1024  lds
buffer_load_dwordx4 v[40:43], v2, s[8:11], s63 offen offset:2048
v_fma_f32 v244, v244, v7, v7
v_fma_f32 v245, v245, v7, v7
v_mfma_f32_32x32x16_bf16 v[192:207], v[232:235], v[68:71], v[192:207]
s_waitcnt lgkmcnt(3)
ds_read_b128 v[232:235], v3 offset:53248
v_rcp_f32 v244, v244
v_rcp_f32 v245, v245
v_mfma_f32_32x32x16_bf16 v[192:207], v[236:239], v[72:75], v[192:207]
s_waitcnt lgkmcnt(3)
ds_read_b128 v[236:239], v3 offset:54272
buffer_load_dwordx4 v2, s[8:11], s62 offen offset:2048  lds
v_mul_f32 v246, v246, v244
v_mul_f32 v247, v247, v245
v_cvt_pk_bf16_f32 v250, v246, v247
v_mfma_f32_32x32x16_bf16 v[192:207], v[252:255], v[76:79], v[192:207]
s_waitcnt lgkmcnt(3)
ds_read_b128 v[252:255], v3 offset:55296
buffer_load_dwordx4 v[44:47], v2, s[8:11], s63 offen offset:3072
v_mul_f32 v244, v6, v166
v_mul_f32 v245, v6, v167
v_mfma_f32_32x32x16_bf16 v[192:207], v[224:227], v[80:83], v[192:207]
s_waitcnt lgkmcnt(3)
ds_read_b128 v[224:227], v3 offset:56320
buffer_load_dwordx4 v2, s[8:11], s62 offen offset:3072  lds
v_exp_f32 v244, v244
v_mfma_f32_32x32x16_bf16 v[192:207], v[228:231], v[84:87], v[192:207]
s_waitcnt lgkmcnt(3)
ds_read_b128 v[228:231], v3 offset:57344
v_exp_f32 v245, v245
v_mul_f32 v246, v166, v174
v_mul_f32 v247, v167, v175
v_mfma_f32_32x32x16_bf16 v[192:207], v[232:235], v[88:91], v[192:207]
s_waitcnt lgkmcnt(3)
ds_read_b128 v[232:235], v3 offset:58368
s_add_u32 m0, s60, 147456
s_add_u32 s62, s85, 32768
buffer_load_dwordx4 v2, s[8:11], s62 offen offset:0  lds
s_add_u32 s63, s85, 53248
buffer_load_dwordx4 v[48:51], v2, s[8:11], s63 offen offset:0
v_fma_f32 v244, v244, v7, v7
v_fma_f32 v245, v245, v7, v7
v_mfma_f32_32x32x16_bf16 v[192:207], v[236:239], v[92:95], v[192:207]
s_waitcnt lgkmcnt(3)
ds_read_b128 v[236:239], v3 offset:59392
v_rcp_f32 v244, v244
v_rcp_f32 v245, v245
v_mfma_f32_32x32x16_bf16 v[192:207], v[252:255], v[96:99], v[192:207]
s_waitcnt lgkmcnt(3)
ds_read_b128 v[252:255], v3 offset:60416
buffer_load_dwordx4 v2, s[8:11], s62 offen offset:1024  lds
v_mul_f32_e64 v246, v246, v244
v_mul_f32 v247, v247, v245
v_cvt_pk_bf16_f32 v251, v246, v247
v_mfma_f32_32x32x16_bf16 v[192:207], v[224:227], v[100:103], v[192:207]
s_waitcnt lgkmcnt(3)
ds_read_b128 v[224:227], v3 offset:61440
buffer_load_dwordx4 v[52:55], v2, s[8:11], s63 offen offset:1024
buffer_store_dwordx4 v[248:251], v2, s[8:11], s82 offen offset:0 sc1
v_mul_f32 v244, v6, v176
v_mfma_f32_32x32x16_bf16 v[192:207], v[228:231], v[104:107], v[192:207]
s_waitcnt lgkmcnt(3)
ds_read_b128 v[228:231], v3 offset:62464
buffer_load_dwordx4 v2, s[8:11], s62 offen offset:2048  lds
v_mul_f32 v245, v6, v177
v_exp_f32 v244, v244
v_mfma_f32_32x32x16_bf16 v[192:207], v[232:235], v[108:111], v[192:207]
s_waitcnt lgkmcnt(3)
ds_read_b128 v[232:235], v3 offset:63488
v_exp_f32 v245, v245
v_mul_f32_e64 v246, v176, v184
v_mul_f32 v247, v177, v185
v_mfma_f32_32x32x16_bf16 v[192:207], v[236:239], v[112:115], v[192:207]
s_waitcnt lgkmcnt(3)
ds_read_b128 v[236:239], v3 offset:64512
buffer_load_dwordx4 v2, s[8:11], s62 offen offset:3072  lds
buffer_load_dwordx4 v[56:59], v2, s[8:11], s63 offen offset:2048
v_fma_f32 v244, v244, v7, v7
v_fma_f32 v245, v245, v7, v7
v_mfma_f32_32x32x16_bf16 v[192:207], v[252:255], v[116:119], v[192:207]
s_waitcnt lgkmcnt(3)
s_barrier
ds_read_b128 v[252:255], v4 offset:0
v_rcp_f32_e64 v244, v244
v_mfma_f32_32x32x16_bf16 v[192:207], v[224:227], v[120:123], v[192:207]
s_waitcnt lgkmcnt(3)
ds_read_b128 v[224:227], v4 offset:1024
s_add_u32 m0, s60, 0
s_add_u32 s62, s85, 36864
buffer_load_dwordx4 v2, s[8:11], s62 offen offset:0  lds
v_rcp_f32 v245, v245
v_mfma_f32_32x32x16_bf16 v[192:207], v[228:231], v[124:127], v[192:207]
s_waitcnt lgkmcnt(3)
ds_read_b128 v[228:231], v4 offset:2048
buffer_load_dwordx4 v[60:63], v2, s[8:11], s63 offen offset:3072
v_mul_f32 v246, v246, v244
v_mul_f32 v247, v247, v245
v_cvt_pk_bf16_f32 v24, v246, v247
v_mfma_f32_32x32x16_bf16 v[192:207], v[232:235], v[128:131], v[192:207]
s_waitcnt lgkmcnt(3)
ds_read_b128 v[232:235], v4 offset:3072
v_mul_f32 v244, v6, v178
v_mul_f32_e64 v245, v6, v179
v_exp_f32 v244, v244
v_mfma_f32_32x32x16_bf16 v[192:207], v[236:239], v[132:135], v[192:207]
s_waitcnt lgkmcnt(3)
ds_read_b128 v[236:239], v4 offset:4096
buffer_load_dwordx4 v2, s[8:11], s62 offen offset:1024  lds
v_exp_f32 v245, v245
v_mul_f32 v246, v178, v186
v_mfma_f32_32x32x16_bf16 v[192:207], v[252:255], v[136:139], v[192:207]
s_waitcnt lgkmcnt(3)
ds_read_b128 v[252:255], v4 offset:5120
v_mul_f32 v247, v179, v187
v_fma_f32 v244, v244, v7, v7
v_fma_f32 v245, v245, v7, v7
v_mfma_f32_32x32x16_bf16 v[192:207], v[224:227], v[140:143], v[192:207]
s_waitcnt lgkmcnt(3)
ds_read_b128 v[224:227], v4 offset:6144
buffer_load_dwordx4 v2, s[8:11], s62 offen offset:2048  lds
v_rcp_f32 v244, v244
v_mfma_f32_32x32x16_bf16 v[192:207], v[228:231], v[144:147], v[192:207]
s_waitcnt lgkmcnt(3)
v_rcp_f32 v245, v245
v_mfma_f32_32x32x16_bf16 v[192:207], v[232:235], v[148:151], v[192:207]
s_waitcnt lgkmcnt(2)
buffer_load_dwordx4 v2, s[8:11], s62 offen offset:3072  lds
v_mul_f32 v246, v246, v244
v_mul_f32_e64 v247, v247, v245
v_cvt_pk_bf16_f32 v25, v246, v247
v_mul_f32_e64 v244, v6, v180
v_mfma_f32_32x32x16_bf16 v[192:207], v[236:239], v[152:155], v[192:207]
s_waitcnt lgkmcnt(1)
v_cmp_gt_u32 vcc, 8, v1
v_lshlrev_b32_e64 v240, 2, v1
v_mov_b32 v10, 0x80000000
v_cndmask_b32 v240, v10, v240, vcc
s_lshl_b32 s32, s6, 7
s_lshl_b32 s33, s3, 5
s_add_u32 s32, s32, s33
s_add_u32 s86, s32, 8192
buffer_load_dword v10, v240, s[8:11], s86 offen sc1
v_mul_f32 v245, v6, v181
v_mfma_f32_32x32x16_bf16 v[192:207], v[252:255], v[156:159], v[192:207]
s_waitcnt lgkmcnt(0)
s_add_u32 m0, s60, 16384
s_add_u32 s62, s85, 40960
buffer_load_dwordx4 v2, s[8:11], s62 offen offset:0  lds
v_exp_f32 v244, v244
v_exp_f32 v245, v245
v_mfma_f32_32x32x16_bf16 v[192:207], v[224:227], v[28:31], v[192:207]
v_mul_f32 v246, v180, v188
v_mul_f32 v247, v181, v189
v_fma_f32 v244, v244, v7, v7
v_fma_f32 v245, v245, v7, v7
v_rcp_f32 v244, v244
v_rcp_f32 v245, v245
buffer_load_dwordx4 v2, s[8:11], s62 offen offset:1024  lds
v_mul_f32 v246, v246, v244
v_mul_f32 v247, v247, v245
v_cvt_pk_bf16_f32 v26, v246, v247
v_mul_f32 v244, v6, v182
v_mul_f32 v245, v6, v183
v_exp_f32 v244, v244
v_exp_f32 v245, v245
v_mul_f32 v246, v182, v190
v_mul_f32 v247, v183, v191
v_fma_f32 v244, v244, v7, v7
v_fma_f32 v245, v245, v7, v7
v_rcp_f32_e64 v244, v244
buffer_load_dwordx4 v2, s[8:11], s62 offen offset:2048  lds
v_rcp_f32 v245, v245
v_mul_f32 v246, v246, v244
v_mul_f32_e64 v247, v247, v245
v_cvt_pk_bf16_f32 v27, v246, v247
buffer_store_dwordx4 v[24:27], v2, s[8:11], s82 offen offset:1024 sc1
v_mul_f32 v244, v6, v192
v_mul_f32 v245, v6, v193
v_exp_f32 v244, v244
v_exp_f32 v245, v245
v_mul_f32 v246, v192, v200
v_mul_f32 v247, v193, v201
buffer_load_dwordx4 v2, s[8:11], s62 offen offset:3072  lds
v_fma_f32 v244, v244, v7, v7
v_fma_f32 v245, v245, v7, v7
v_rcp_f32 v244, v244
v_rcp_f32 v245, v245
v_mul_f32 v246, v246, v244
v_mul_f32 v247, v247, v245
v_cvt_pk_bf16_f32 v248, v246, v247
v_mul_f32 v244, v6, v194
v_mul_f32 v245, v6, v195
v_exp_f32 v244, v244
v_exp_f32 v245, v245
s_add_u32 m0, s60, 32768
s_add_u32 s62, s85, 45056
buffer_load_dwordx4 v2, s[8:11], s62 offen offset:0  lds
v_mul_f32 v246, v194, v202
v_mul_f32 v247, v195, v203
v_fma_f32 v244, v244, v7, v7
v_fma_f32 v245, v245, v7, v7
v_rcp_f32 v244, v244
v_rcp_f32 v245, v245
v_mul_f32 v246, v246, v244
v_mul_f32 v247, v247, v245
v_cvt_pk_bf16_f32 v249, v246, v247
v_mul_f32 v244, v6, v196
v_mul_f32 v245, v6, v197
v_exp_f32_e64 v244, v244
buffer_load_dwordx4 v2, s[8:11], s62 offen offset:1024  lds
v_exp_f32 v245, v245
v_mul_f32 v246, v196, v204
v_mul_f32_e64 v247, v197, v205
v_fma_f32 v244, v244, v7, v7
v_fma_f32 v245, v245, v7, v7
v_rcp_f32 v244, v244
v_rcp_f32 v245, v245
v_mul_f32 v246, v246, v244
v_mul_f32 v247, v247, v245
v_cvt_pk_bf16_f32 v250, v246, v247
v_mul_f32_e64 v244, v6, v198
buffer_load_dwordx4 v2, s[8:11], s62 offen offset:2048  lds
v_mul_f32 v245, v6, v199
v_exp_f32 v244, v244
v_exp_f32 v245, v245
v_mul_f32 v246, v198, v206
v_mul_f32_e64 v247, v199, v207
v_fma_f32 v244, v244, v7, v7
v_fma_f32 v245, v245, v7, v7
v_rcp_f32 v244, v244
v_rcp_f32 v245, v245
v_mul_f32_e64 v246, v246, v244
buffer_load_dwordx4 v2, s[8:11], s62 offen offset:3072  lds
v_mul_f32_e64 v247, v247, v245
v_cvt_pk_bf16_f32 v251, v246, v247
buffer_store_dwordx4 v[248:251], v2, s[8:11], s82 offen offset:2048 sc1
v_mov_b32_e64 v115, v240
s_waitcnt vmcnt(10)
v_cmp_gt_u32 vcc, 1, v10
s_nop 0
s_and_b32 s99, vcc_lo, 0xff
s_cbranch_scc1 L_spin8
L_back8:
s_mul_i32 s32, s6, 229376
s_mul_i32 s33, s3, 28672
s_add_u32 s32, s32, s33
s_add_u32 s59, s32, 17694720
s_add_u32 s32, s7, 0
s_and_b32 s32, s32, 0
s_mul_i32 s32, s32, 7168
s_add_u32 s34, s59, s32
s_add_u32 s34, s34, 0
s_add_u32 s32, s7, 1
s_and_b32 s32, s32, 0
s_mul_i32 s32, s32, 7168
s_add_u32 s35, s59, s32
s_add_u32 s35, s35, 7168
s_add_u32 s32, s7, 2
s_and_b32 s32, s32, 0
s_mul_i32 s32, s32, 7168
s_add_u32 s36, s59, s32
s_add_u32 s36, s36, 14336
s_add_u32 s32, s7, 3
s_and_b32 s32, s32, 0
s_mul_i32 s32, s32, 7168
s_add_u32 s37, s59, s32
s_add_u32 s37, s37, 21504
s_add_u32 s58, s34, 114688
buffer_load_dwordx4 v[64:67], v2, s[8:11], s58 offen offset:0 sc1
buffer_load_dwordx4 v[68:71], v2, s[8:11], s58 offen offset:1024 sc1
buffer_load_dwordx4 v[72:75], v2, s[8:11], s58 offen offset:2048 sc1
buffer_load_dwordx4 v[76:79], v2, s[8:11], s58 offen offset:3072 sc1
s_add_u32 s58, s35, 114688
buffer_load_dwordx4 v[80:83], v2, s[8:11], s58 offen offset:0 sc1
buffer_load_dwordx4 v[84:87], v2, s[8:11], s58 offen offset:1024 sc1
s_add_u32 s32, s60, 49152
v_add_u32_e64 v3, s32, v2
v_xor_b32 v4, 128, v3
v_and_b32_e64 v28, 7, v1
v_lshrrev_b32 v29, 3, v1
s_lshl_b32 s32, s3, 7
v_lshl_add_u32 v30, v28, 4, s32
v_bfe_u32 v31, v1, 4, 1
v_lshlrev_b32 v5, 7, v31
v_xor_b32 v30, v30, v5
v_bfe_u32 v5, v1, 3, 2
v_lshl_add_u32 v30, v5, 10, v30
v_lshrrev_b32_e64 v5, 5, v1
v_mul_u32_u24 v5, 16384, v5
v_add_u32_e64 v30, v30, v5
v_add_u32 v5, 49152, v30
v_lshlrev_b32_e64 v30, 4, v28
v_lshl_add_u32 v30, v31, 2, v30
v_and_b32 v31, 0x28, v1
v_cmp_eq_u32 vcc, 0, v31
v_mov_b32 v31, 0x80000000
s_nop 0
v_cndmask_b32 v6, v31, v30, vcc
v_add_u32_e64 v112, s60, v2
v_add_u32 v113, 0x10000, v112
v_add_u32 v114, 0x20000, v112
s_waitcnt vmcnt(6)
v_mov_b32 v8, 2
s_or_b32 s99, s87, s68
buffer_store_dword v8, v9, s[8:11], s99 offen
s_or_b32 s99, s87, s69
buffer_store_dword v8, v9, s[8:11], s99 offen sc1
buffer_load_dwordx4 v[88:91], v2, s[8:11], s58 offen offset:2048 sc1
buffer_load_dwordx4 v[92:95], v2, s[8:11], s58 offen offset:3072 sc1
s_add_u32 s58, s36, 114688
buffer_load_dwordx4 v[96:99], v2, s[8:11], s58 offen offset:0 sc1
buffer_load_dwordx4 v[100:103], v2, s[8:11], s58 offen offset:1024 sc1
buffer_load_dwordx4 v[104:107], v2, s[8:11], s58 offen offset:2048 sc1
buffer_load_dwordx4 v[108:111], v2, s[8:11], s58 offen offset:3072 sc1
s_add_u32 s87, s89, 12288
s_waitcnt vmcnt(13)
v_mfma_f32_32x32x16_bf16 v[128:143], a[192:195], v[64:67], 0
v_mfma_f32_32x32x16_bf16 v[144:159], a[196:199], v[64:67], 0
s_waitcnt vmcnt(12)
s_add_u32 s58, s37, 114688
buffer_load_dwordx4 v[64:67], v2, s[8:11], s58 offen offset:0 sc1
buffer_load_dword v10, v115, s[8:11], s86 offen sc1
v_mfma_f32_32x32x16_bf16 v[128:143], a[200:203], v[68:71], v[128:143]
v_mfma_f32_32x32x16_bf16 v[144:159], a[204:207], v[68:71], v[144:159]
s_waitcnt vmcnt(13)
buffer_load_dwordx4 v[68:71], v2, s[8:11], s58 offen offset:1024 sc1
v_mfma_f32_32x32x16_bf16 v[128:143], a[208:211], v[72:75], v[128:143]
v_mfma_f32_32x32x16_bf16 v[144:159], a[212:215], v[72:75], v[144:159]
s_waitcnt vmcnt(13)
buffer_load_dwordx4 v[72:75], v2, s[8:11], s58 offen offset:2048 sc1
v_mfma_f32_32x32x16_bf16 v[128:143], a[216:219], v[76:79], v[128:143]
v_mfma_f32_32x32x16_bf16 v[144:159], a[220:223], v[76:79], v[144:159]
s_waitcnt vmcnt(13)
buffer_load_dwordx4 v[76:79], v2, s[8:11], s58 offen offset:3072 sc1
v_mfma_f32_32x32x16_bf16 v[128:143], a[224:227], v[80:83], v[128:143]
v_mfma_f32_32x32x16_bf16 v[144:159], a[228:231], v[80:83], v[144:159]
s_waitcnt vmcnt(13)
v_mfma_f32_32x32x16_bf16 v[128:143], a[232:235], v[84:87], v[128:143]
v_mfma_f32_32x32x16_bf16 v[144:159], a[236:239], v[84:87], v[144:159]
s_waitcnt vmcnt(10)
v_mfma_f32_32x32x16_bf16 v[128:143], a[240:243], v[88:91], v[128:143]
ds_read_b128 v[228:231], v113 offset:16384
v_mfma_f32_32x32x16_bf16 v[144:159], a[244:247], v[88:91], v[144:159]
s_waitcnt vmcnt(9)
ds_read_b128 v[232:235], v113 offset:17408
v_mfma_f32_32x32x16_bf16 v[128:143], a[248:251], v[92:95], v[128:143]
ds_read_b128 v[236:239], v113 offset:18432
v_mfma_f32_32x32x16_bf16 v[144:159], a[252:255], v[92:95], v[144:159]
s_waitcnt vmcnt(8) lgkmcnt(2)
ds_read_b128 v[240:243], v113 offset:19456
v_mfma_f32_32x32x16_bf16 v[128:143], v[228:231], v[96:99], v[128:143]
s_waitcnt lgkmcnt(2)
ds_read_b128 v[244:247], v113 offset:32768
v_mfma_f32_32x32x16_bf16 v[144:159], v[232:235], v[96:99], v[144:159]
s_waitcnt vmcnt(7) lgkmcnt(2)
ds_read_b128 v[248:251], v113 offset:33792
v_mfma_f32_32x32x16_bf16 v[128:143], v[236:239], v[100:103], v[128:143]
s_waitcnt lgkmcnt(2)
ds_read_b128 v[228:231], v113 offset:34816
v_mfma_f32_32x32x16_bf16 v[144:159], v[240:243], v[100:103], v[144:159]
s_waitcnt vmcnt(6) lgkmcnt(2)
ds_read_b128 v[232:235], v113 offset:35840
s_waitcnt vmcnt(3)
v_cmp_gt_u32 vcc, 2, v10
s_nop 0
s_and_b32 s99, vcc_lo, 0xff
s_cbranch_scc1 L_spin9
L_back9:
s_add_u32 s58, s34, 118784
buffer_load_dwordx4 v[80:83], v2, s[8:11], s58 offen offset:0 sc1
buffer_load_dwordx4 v[84:87], v2, s[8:11], s58 offen offset:1024 sc1
s_lshr_b32 s70, s3, 1
v_mfma_f32_32x32x16_bf16 v[128:143], v[244:247], v[104:107], v[128:143]
s_waitcnt lgkmcnt(2)
ds_read_b128 v[236:239], v113 offset:49152
s_barrier
s_lshl_b32 s49, s70, 13
s_and_b32 s71, s3, 1
s_lshl_b32 s71, s71, 2
s_add_u32 s50, s71, s84
v_mfma_f32_32x32x16_bf16 v[144:159], v[248:251], v[104:107], v[144:159]
s_waitcnt lgkmcnt(2)
ds_read_b128 v[240:243], v113 offset:50176
buffer_load_dwordx4 v[88:91], v2, s[8:11], s58 offen offset:2048 sc1
s_add_u32 s58, s35, 118784
buffer_load_dwordx4 v[92:95], v2, s[8:11], s58 offen offset:0 sc1
s_lshl_b32 s71, s71, 10
s_add_u32 s70, s50, 0
s_and_b32 s70, s70, 7
v_mfma_f32_32x32x16_bf16 v[128:143], v[228:231], v[108:111], v[128:143]
s_waitcnt lgkmcnt(2)
ds_read_b128 v[244:247], v113 offset:51200
v_mfma_f32_32x32x16_bf16 v[144:159], v[232:235], v[108:111], v[144:159]
s_waitcnt lgkmcnt(2)
ds_read_b128 v[248:251], v113 offset:52224
buffer_load_dwordx4 v[96:99], v2, s[8:11], s58 offen offset:1024 sc1
buffer_load_dwordx4 v[100:103], v2, s[8:11], s58 offen offset:2048 sc1
s_lshl_b32 s70, s70, 10
s_add_u32 s70, s70, s49
s_sub_u32 s92, s70, 0
v_mfma_f32_32x32x16_bf16 v[128:143], v[236:239], v[64:67], v[128:143]
s_waitcnt lgkmcnt(2)
ds_read_b128 v[228:231], v114 offset:0
s_add_u32 s70, s50, 1
s_and_b32 s70, s70, 7
s_lshl_b32 s70, s70, 10
s_add_u32 s70, s70, s49
s_sub_u32 s93, s70, 1024
v_mfma_f32_32x32x16_bf16 v[144:159], v[240:243], v[64:67], v[144:159]
s_waitcnt vmcnt(8) lgkmcnt(2)
ds_read_b128 v[232:235], v114 offset:1024
s_add_u32 s58, s36, 118784
buffer_load_dwordx4 v[104:107], v2, s[8:11], s58 offen offset:0 sc1
buffer_load_dwordx4 v[108:111], v2, s[8:11], s58 offen offset:1024 sc1
s_add_u32 s70, s50, 2
s_and_b32 s70, s70, 7
s_lshl_b32 s70, s70, 10
v_mfma_f32_32x32x16_bf16 v[128:143], v[244:247], v[68:71], v[128:143]
s_waitcnt lgkmcnt(2)
ds_read_b128 v[236:239], v114 offset:2048
s_add_u32 s70, s70, s49
s_sub_u32 s94, s70, 2048
s_add_u32 s70, s50, 3
s_and_b32 s70, s70, 7
s_lshl_b32 s70, s70, 10
v_mfma_f32_32x32x16_bf16 v[144:159], v[248:251], v[68:71], v[144:159]
s_waitcnt vmcnt(9) lgkmcnt(2)
ds_read_b128 v[240:243], v114 offset:3072
buffer_load_dwordx4 v[64:67], v2, s[8:11], s58 offen offset:2048 sc1
s_add_u32 s58, s37, 118784
buffer_load_dwordx4 v[68:71], v2, s[8:11], s58 offen offset:0 sc1
s_add_u32 s70, s70, s49
s_sub_u32 s95, s70, 3072
s_add_u32 s49, s49, s71
v_mfma_f32_32x32x16_bf16 v[128:143], v[228:231], v[72:75], v[128:143]
s_waitcnt lgkmcnt(2)
ds_read_b128 v[244:247], v114 offset:16384
s_lshl_b32 s47, s6, 16
s_add_u32 s47, s47, 11403264
s_sub_u32 s48, s6, 1
s_max_i32 s48, s48, 0
s_lshl_b32 s51, s48, 10
v_mfma_f32_32x32x16_bf16 v[144:159], v[232:235], v[72:75], v[144:159]
s_waitcnt vmcnt(10) lgkmcnt(2)
ds_read_b128 v[248:251], v114 offset:17408
buffer_load_dwordx4 v[72:75], v2, s[8:11], s58 offen offset:1024 sc1
s_add_u32 s51, s51, 7127040
s_lshl_b32 s52, s48, 11
s_add_u32 s52, s52, 32374784
s_lshl_b32 s48, s48, 14
v_mfma_f32_32x32x16_bf16 v[128:143], v[236:239], v[76:79], v[128:143]
s_waitcnt lgkmcnt(2)
ds_read_b128 v[228:231], v114 offset:18432
s_add_u32 s48, s48, 6602752
v_lshrrev_b32 v28, 4, v1
v_and_b32 v29, 15, v1
v_lshlrev_b32 v29, 4, v29
v_lshl_add_u32 v226, v28, 9, v29
v_mfma_f32_32x32x16_bf16 v[144:159], v[240:243], v[76:79], v[144:159]
s_waitcnt vmcnt(10) lgkmcnt(2)
ds_read_b128 v[232:235], v114 offset:19456
buffer_load_dwordx4 v[76:79], v2, s[8:11], s58 offen offset:2048 sc1
v_lshl_add_u32 v227, v28, 8, v29
s_lshl_b32 s70, s6, 12
s_and_b32 s71, s3, 1
s_lshl_b32 s71, s71, 8
v_mfma_f32_32x32x16_bf16 v[128:143], v[244:247], v[80:83], v[128:143]
s_waitcnt lgkmcnt(2)
ds_read_b128 v[236:239], v112 offset:0
s_add_u32 s70, s70, s71
s_add_u32 s90, s70, 6209536
s_lshl_b32 s70, s6, 1
s_add_u32 s70, s70, s3
s_lshl_b32 s72, s70, 13
s_lshl_b32 s71, s7, 10
s_add_u32 s72, s72, s71
s_add_u32 s72, s72, 6586368
s_cmp_ge_u32 s3, 2
s_cselect_b32 s72, s72, 0x40000000
s_lshl_b32 s73, s6, 10
s_lshr_b32 s71, s7, 1
s_lshl_b32 s71, s71, 8
s_add_u32 s73, s73, s71
s_and_b32 s71, s7, 1
s_lshl_b32 s71, s71, 3
s_add_u32 s73, s73, s71
s_lshl_b32 s71, s3, 7
s_add_u32 s73, s73, s71
s_add_u32 s73, s73, 7126784
s_cmp_ge_u32 s3, 2
s_cselect_b32 s73, s73, 0x40000000
v_mfma_f32_32x32x16_bf16 v[144:159], v[248:251], v[80:83], v[144:159]
s_waitcnt vmcnt(10) lgkmcnt(2)
ds_read_b128 v[240:243], v112 offset:1024
s_add_u32 s58, s34, 0
buffer_load_dwordx4 v[80:83], v2, s[8:11], s58 offen offset:0 sc1
s_lshl_b32 s70, s6, 3
s_add_u32 s70, s70, s7
s_lshl_b32 s70, s70, 1
s_add_u32 s70, s70, s3
s_lshl_b32 s70, s70, 7
s_add_u32 s70, s70, 32374528
s_cmp_ge_u32 s3, 2
s_cselect_b32 s91, s70, 0x40000000
v_and_b32 v28, 15, v1
v_lshrrev_b32_e64 v29, 4, v1
v_and_b32 v30, 7, v1
v_mfma_f32_32x32x16_bf16 v[128:143], v[228:231], v[84:87], v[128:143]
s_waitcnt lgkmcnt(2)
ds_read_b128 v[244:247], v112 offset:2048
v_bfe_u32 v31, v1, 3, 1
v_lshlrev_b32_e64 v31, 13, v31
v_lshl_add_u32 v124, v29, 7, v31
v_lshl_add_u32 v116, v30, 4, v124
v_add_u32 v117, 512, v116
v_mfma_f32_32x32x16_bf16 v[144:159], v[232:235], v[84:87], v[144:159]
s_waitcnt vmcnt(10) lgkmcnt(2)
ds_read_b128 v[248:251], v112 offset:3072
buffer_load_dwordx4 v[84:87], v2, s[8:11], s58 offen offset:1024 sc1
v_lshlrev_b32 v118, 3, v28
v_add_u32 v118, 97280, v118
v_lshlrev_b32_e64 v119, 5, v29
v_add_u32 v119, 97280, v119
v_mfma_f32_32x32x16_bf16 v[128:143], v[236:239], v[88:91], v[128:143]
s_waitcnt lgkmcnt(2)
ds_read_b128 v[228:231], v112 offset:16384
v_and_b32 v124, 1, v1
v_cmp_eq_u32 s[40:41], 1, v124
v_lshl_add_u32 v125, v29, 2, v124
v_cmp_le_u32 s[42:43], v125, v28
v_add_u32 v125, 2, v125
v_mfma_f32_32x32x16_bf16 v[144:159], v[240:243], v[88:91], v[144:159]
s_waitcnt vmcnt(10) lgkmcnt(2)
ds_read_b128 v[232:235], v112 offset:17408
buffer_load_dwordx4 v[88:91], v2, s[8:11], s58 offen offset:2048 sc1
v_cmp_le_u32 s[44:45], v125, v28
v_mov_b32 v125, 0xffff
v_mov_b32 v126, 0xffff0000
v_cndmask_b32 v125, v125, v126, s[40:41]
v_mfma_f32_32x32x16_bf16 v[128:143], v[244:247], v[92:95], v[128:143]
s_waitcnt lgkmcnt(2)
ds_read_b128 v[236:239], v112 offset:18432
v_mov_b32 v126, 0
v_cndmask_b32 v122, v126, v125, s[42:43]
v_cndmask_b32 v120, v125, v126, s[42:43]
v_cndmask_b32 v123, v126, v125, s[44:45]
v_cndmask_b32 v121, v125, v126, s[44:45]
v_mfma_f32_32x32x16_bf16 v[144:159], v[248:251], v[92:95], v[144:159]
s_waitcnt vmcnt(10) lgkmcnt(2)
ds_read_b128 v[240:243], v112 offset:19456
buffer_load_dwordx4 v[92:95], v2, s[8:11], s58 offen offset:3072 sc1
s_cmp_eq_u32 s6, 0
s_cselect_b32 s70, 0xfe967699, 0
s_mov_b32 s46, 0x3eb8aa3b
v_mov_b32_e64 v252, s70
v_mov_b32 v124, 0x3f803f80
v_mov_b32 v253, s70
v_mfma_f32_32x32x16_bf16 v[128:143], v[228:231], v[96:99], v[128:143]
s_waitcnt lgkmcnt(2)
ds_read_b128 v[244:247], v112 offset:32768
s_add_u32 s32, s55, 11403264
buffer_load_dwordx4 v[20:23], v2, s[8:11], s32 offen sc1
v_mov_b32 v125, 0x3f803f80
v_mov_b32_e64 v254, s70
v_mov_b32 v126, 0x3f803f80
v_mfma_f32_32x32x16_bf16 v[144:159], v[232:235], v[96:99], v[144:159]
s_waitcnt vmcnt(11) lgkmcnt(2)
ds_read_b128 v[248:251], v112 offset:33792
s_add_u32 s58, s35, 0
buffer_load_dwordx4 v[96:99], v2, s[8:11], s58 offen offset:0 sc1
v_mov_b32_e64 v255, s70
v_mov_b32 v127, 0x3f803f80
v_mfma_f32_32x32x16_bf16 v[128:143], v[236:239], v[100:103], v[128:143]
s_waitcnt lgkmcnt(2)
ds_read_b128 v[228:231], v112 offset:34816
v_cmp_gt_u32 vcc, 32, v1
v_lshlrev_b32 v115, 2, v1
v_mov_b32 v10, 0x80000000
v_cndmask_b32 v115, v10, v115, vcc
s_lshl_b32 s32, s6, 7
s_add_u32 s86, s32, 12288
v_mfma_f32_32x32x16_bf16 v[144:159], v[240:243], v[100:103], v[144:159]
s_waitcnt vmcnt(11) lgkmcnt(2)
ds_read_b128 v[232:235], v112 offset:35840
buffer_load_dwordx4 v[100:103], v2, s[8:11], s58 offen offset:1024 sc1
v_mfma_f32_32x32x16_bf16 v[128:143], v[244:247], v[104:107], v[128:143]
s_waitcnt lgkmcnt(2)
s_add_u32 s32, s55, 11436032
buffer_load_dwordx4 v[24:27], v2, s[8:11], s32 offen sc1
v_mfma_f32_32x32x16_bf16 v[144:159], v[248:251], v[104:107], v[144:159]
s_waitcnt vmcnt(12) lgkmcnt(1)
buffer_load_dwordx4 v[104:107], v2, s[8:11], s58 offen offset:2048 sc1
v_mfma_f32_32x32x16_bf16 v[128:143], v[228:231], v[108:111], v[128:143]
s_waitcnt lgkmcnt(0)
v_mfma_f32_32x32x16_bf16 v[144:159], v[232:235], v[108:111], v[144:159]
s_waitcnt vmcnt(12)
buffer_load_dwordx4 v[108:111], v2, s[8:11], s58 offen offset:3072 sc1
v_mfma_f32_32x32x16_bf16 v[128:143], v[32:35], v[64:67], v[128:143]
v_mfma_f32_32x32x16_bf16 v[144:159], v[36:39], v[64:67], v[144:159]
s_waitcnt vmcnt(12)
s_add_u32 s58, s36, 0
buffer_load_dwordx4 v[64:67], v2, s[8:11], s58 offen offset:0 sc1
v_mfma_f32_32x32x16_bf16 v[128:143], v[40:43], v[68:71], v[128:143]
v_mfma_f32_32x32x16_bf16 v[144:159], v[44:47], v[68:71], v[144:159]
s_waitcnt vmcnt(12)
buffer_load_dwordx4 v[68:71], v2, s[8:11], s58 offen offset:1024 sc1
v_mfma_f32_32x32x16_bf16 v[128:143], v[48:51], v[72:75], v[128:143]
v_mfma_f32_32x32x16_bf16 v[144:159], v[52:55], v[72:75], v[144:159]
s_waitcnt vmcnt(12)
buffer_load_dwordx4 v[72:75], v2, s[8:11], s58 offen offset:2048 sc1
v_mfma_f32_32x32x16_bf16 v[128:143], v[56:59], v[76:79], v[128:143]
v_mfma_f32_32x32x16_bf16 v[144:159], v[60:63], v[76:79], v[144:159]
s_waitcnt vmcnt(12)
buffer_load_dwordx4 v[76:79], v2, s[8:11], s58 offen offset:3072 sc1
v_mfma_f32_32x32x16_bf16 v[160:175], a[192:195], v[80:83], 0
v_mfma_f32_32x32x16_bf16 v[176:191], a[196:199], v[80:83], 0
s_waitcnt vmcnt(12)
s_add_u32 s58, s37, 0
buffer_load_dwordx4 v[80:83], v2, s[8:11], s58 offen offset:0 sc1
v_mfma_f32_32x32x16_bf16 v[160:175], a[200:203], v[84:87], v[160:175]
s_nop 2
ds_write_b128 v3, v[128:131] offset:0
v_mfma_f32_32x32x16_bf16 v[176:191], a[204:207], v[84:87], v[176:191]
s_waitcnt vmcnt(12)
buffer_load_dwordx4 v[84:87], v2, s[8:11], s58 offen offset:1024 sc1
v_mfma_f32_32x32x16_bf16 v[160:175], a[208:211], v[88:91], v[160:175]
ds_write_b128 v3, v[132:135] offset:1024
v_mfma_f32_32x32x16_bf16 v[176:191], a[212:215], v[88:91], v[176:191]
s_waitcnt vmcnt(12)
buffer_load_dwordx4 v[88:91], v2, s[8:11], s58 offen offset:2048 sc1
v_mfma_f32_32x32x16_bf16 v[160:175], a[216:219], v[92:95], v[160:175]
ds_write_b128 v4, v[136:139] offset:2048
v_mfma_f32_32x32x16_bf16 v[176:191], a[220:223], v[92:95], v[176:191]
s_waitcnt vmcnt(11)
buffer_load_dwordx4 v[92:95], v2, s[8:11], s58 offen offset:3072 sc1
v_mfma_f32_32x32x16_bf16 v[160:175], a[224:227], v[96:99], v[160:175]
ds_write_b128 v4, v[140:143] offset:3072
v_mfma_f32_32x32x16_bf16 v[176:191], a[228:231], v[96:99], v[176:191]
s_waitcnt vmcnt(11)
s_add_u32 s58, s34, 4096
buffer_load_dwordx4 v[96:99], v2, s[8:11], s58 offen offset:0 sc1
v_mfma_f32_32x32x16_bf16 v[160:175], a[232:235], v[100:103], v[160:175]
ds_write_b128 v3, v[144:147] offset:16384
v_mfma_f32_32x32x16_bf16 v[176:191], a[236:239], v[100:103], v[176:191]
s_waitcnt vmcnt(10)
buffer_load_dwordx4 v[100:103], v2, s[8:11], s58 offen offset:1024 sc1
v_mfma_f32_32x32x16_bf16 v[160:175], a[240:243], v[104:107], v[160:175]
ds_read_b128 v[236:239], v113 offset:16384
ds_write_b128 v3, v[148:151] offset:17408
v_mfma_f32_32x32x16_bf16 v[176:191], a[244:247], v[104:107], v[176:191]
s_waitcnt vmcnt(10)
ds_read_b128 v[240:243], v113 offset:17408
buffer_load_dwordx4 v[104:107], v2, s[8:11], s58 offen offset:2048 sc1
v_mfma_f32_32x32x16_bf16 v[160:175], a[248:251], v[108:111], v[160:175]
ds_read_b128 v[244:247], v113 offset:18432
ds_write_b128 v4, v[152:155] offset:18432
v_mfma_f32_32x32x16_bf16 v[176:191], a[252:255], v[108:111], v[176:191]
s_waitcnt vmcnt(10) lgkmcnt(4)
ds_read_b128 v[248:251], v113 offset:19456
s_add_u32 s58, s35, 4096
buffer_load_dwordx4 v[108:111], v2, s[8:11], s58 offen offset:0 sc1
v_mfma_f32_32x32x16_bf16 v[160:175], v[236:239], v[64:67], v[160:175]
s_waitcnt lgkmcnt(3)
ds_read_b128 v[228:231], v113 offset:32768
ds_write_b128 v4, v[156:159] offset:19456
v_mfma_f32_32x32x16_bf16 v[176:191], v[240:243], v[64:67], v[176:191]
s_waitcnt vmcnt(10) lgkmcnt(4)
ds_read_b128 v[232:235], v113 offset:33792
buffer_load_dwordx4 v[64:67], v2, s[8:11], s58 offen offset:1024 sc1
v_mfma_f32_32x32x16_bf16 v[160:175], v[244:247], v[68:71], v[160:175]
s_waitcnt lgkmcnt(3)
ds_read_b128 v[236:239], v113 offset:34816
v_mfma_f32_32x32x16_bf16 v[176:191], v[248:251], v[68:71], v[176:191]
s_waitcnt vmcnt(10) lgkmcnt(3)
ds_read_b128 v[240:243], v113 offset:35840
buffer_load_dwordx4 v[68:71], v2, s[8:11], s58 offen offset:2048 sc1
v_mfma_f32_32x32x16_bf16 v[160:175], v[228:231], v[72:75], v[160:175]
s_waitcnt lgkmcnt(2)
ds_read_b128 v[244:247], v113 offset:49152
s_barrier
ds_read_b128 v[192:195], v5 offset:0
v_mfma_f32_32x32x16_bf16 v[176:191], v[232:235], v[72:75], v[176:191]
s_waitcnt vmcnt(10) lgkmcnt(3)
ds_read_b128 v[248:251], v113 offset:50176
s_add_u32 s58, s36, 4096
buffer_load_dwordx4 v[72:75], v2, s[8:11], s58 offen offset:0 sc1
ds_read_b128 v[196:199], v5 offset:512
ds_read_b128 v[200:203], v5 offset:4096
v_mfma_f32_32x32x16_bf16 v[160:175], v[236:239], v[76:79], v[160:175]
s_waitcnt lgkmcnt(5)
ds_read_b128 v[228:231], v113 offset:51200
ds_read_b128 v[204:207], v5 offset:4608
ds_read_b128 v[208:211], v5 offset:8192
v_mfma_f32_32x32x16_bf16 v[176:191], v[240:243], v[76:79], v[176:191]
s_waitcnt vmcnt(10) lgkmcnt(7)
ds_read_b128 v[232:235], v113 offset:52224
buffer_load_dwordx4 v[76:79], v2, s[8:11], s58 offen offset:1024 sc1
ds_read_b128 v[212:215], v5 offset:8704
ds_read_b128 v[216:219], v5 offset:12288
v_mfma_f32_32x32x16_bf16 v[160:175], v[244:247], v[80:83], v[160:175]
s_waitcnt lgkmcnt(8)
ds_read_b128 v[236:239], v114 offset:0
ds_read_b128 v[220:223], v5 offset:12800
s_waitcnt lgkmcnt(6)
v_add_f32 v192, v192, v200
v_mfma_f32_32x32x16_bf16 v[176:191], v[248:251], v[80:83], v[176:191]
s_waitcnt vmcnt(10)
ds_read_b128 v[240:243], v114 offset:1024
buffer_load_dwordx4 v[80:83], v2, s[8:11], s58 offen offset:2048 sc1
v_add_f32 v193, v193, v201
v_add_f32 v194, v194, v202
v_add_f32 v195, v195, v203
v_add_f32 v196, v196, v204
v_mfma_f32_32x32x16_bf16 v[160:175], v[228:231], v[84:87], v[160:175]
s_waitcnt lgkmcnt(5)
ds_read_b128 v[244:247], v114 offset:2048
v_add_f32 v197, v197, v205
v_add_f32 v198, v198, v206
v_add_f32 v199, v199, v207
v_lshlrev_b32 v200, 16, v24
v_and_b32 v201, 0xffff0000, v24
v_mfma_f32_32x32x16_bf16 v[176:191], v[232:235], v[84:87], v[176:191]
s_waitcnt vmcnt(10) lgkmcnt(3)
ds_read_b128 v[248:251], v114 offset:3072
s_add_u32 s58, s37, 4096
buffer_load_dwordx4 v[84:87], v2, s[8:11], s58 offen offset:0 sc1
v_lshlrev_b32_e64 v202, 16, v25
v_and_b32 v203, 0xffff0000, v25
v_lshlrev_b32_e64 v204, 16, v26
v_and_b32 v205, 0xffff0000, v26
v_mfma_f32_32x32x16_bf16 v[160:175], v[236:239], v[88:91], v[160:175]
s_waitcnt lgkmcnt(2)
ds_read_b128 v[228:231], v114 offset:16384
v_lshlrev_b32 v206, 16, v27
v_and_b32 v207, 0xffff0000, v27
v_add_f32 v192, v192, v200
v_add_f32 v193, v193, v201
v_add_f32 v194, v194, v202
v_mfma_f32_32x32x16_bf16 v[176:191], v[240:243], v[88:91], v[176:191]
s_waitcnt vmcnt(10) lgkmcnt(2)
ds_read_b128 v[232:235], v114 offset:17408
buffer_load_dwordx4 v[88:91], v2, s[8:11], s58 offen offset:1024 sc1
v_add_f32 v195, v195, v203
v_add_f32 v196, v196, v204
v_add_f32 v197, v197, v205
v_add_f32 v198, v198, v206
v_mfma_f32_32x32x16_bf16 v[160:175], v[244:247], v[92:95], v[160:175]
s_waitcnt lgkmcnt(2)
ds_read_b128 v[236:239], v114 offset:18432
v_add_f32 v199, v199, v207
v_add_f32 v208, v208, v216
v_add_f32 v209, v209, v217
v_add_f32 v210, v210, v218
v_mfma_f32_32x32x16_bf16 v[176:191], v[248:251], v[92:95], v[176:191]
s_waitcnt vmcnt(10) lgkmcnt(2)
ds_read_b128 v[240:243], v114 offset:19456
buffer_load_dwordx4 v[92:95], v2, s[8:11], s58 offen offset:2048 sc1
v_add_f32 v211, v211, v219
v_add_f32 v212, v212, v220
v_add_f32 v213, v213, v221
v_add_f32 v214, v214, v222
v_mfma_f32_32x32x16_bf16 v[160:175], v[228:231], v[96:99], v[160:175]
s_waitcnt lgkmcnt(2)
ds_read_b128 v[244:247], v112 offset:0
v_add_f32 v215, v215, v223
v_add_f32 v192, v192, v208
v_add_f32 v193, v193, v209
v_add_f32 v194, v194, v210
v_add_f32 v195, v195, v211
v_mfma_f32_32x32x16_bf16 v[176:191], v[232:235], v[96:99], v[176:191]
s_waitcnt vmcnt(10) lgkmcnt(2)
ds_read_b128 v[248:251], v112 offset:1024
v_add_f32 v196, v196, v212
v_add_f32 v197, v197, v213
v_add_f32 v198, v198, v214
v_add_f32 v199, v199, v215
v_cvt_pk_bf16_f32 v24, v192, v193
v_mfma_f32_32x32x16_bf16 v[160:175], v[236:239], v[100:103], v[160:175]
s_waitcnt lgkmcnt(2)
ds_read_b128 v[228:231], v112 offset:2048
v_cvt_pk_bf16_f32 v25, v194, v195
v_cvt_pk_bf16_f32 v26, v196, v197
v_cvt_pk_bf16_f32 v27, v198, v199
s_add_u32 s32, s55, 11436032
s_cmp_lg_u32 s68, 0
s_cbranch_scc1 L_alt10
buffer_store_dwordx4 v[24:27], v2, s[8:11], s32 offen
L_back10:
v_mfma_f32_32x32x16_bf16 v[176:191], v[240:243], v[100:103], v[176:191]
s_waitcnt vmcnt(10) lgkmcnt(2)
ds_read_b128 v[232:235], v112 offset:3072
v_add_f32 v224, v192, v193
v_mul_f32 v225, v192, v192
v_fmac_f32 v225, v193, v193
v_add_f32 v224, v224, v194
v_fmac_f32 v225, v194, v194
v_mfma_f32_32x32x16_bf16 v[160:175], v[244:247], v[104:107], v[160:175]
s_waitcnt lgkmcnt(2)
ds_read_b128 v[236:239], v112 offset:16384
v_add_f32 v224, v224, v195
v_fmac_f32 v225, v195, v195
v_add_f32 v224, v224, v196
v_fmac_f32 v225, v196, v196
v_add_f32 v224, v224, v197
v_mfma_f32_32x32x16_bf16 v[176:191], v[248:251], v[104:107], v[176:191]
s_waitcnt vmcnt(9) lgkmcnt(2)
ds_read_b128 v[240:243], v112 offset:17408
v_fmac_f32 v225, v197, v197
v_add_f32 v224, v224, v198
v_fmac_f32 v225, v198, v198
v_add_f32_e64 v224, v224, v199
v_fmac_f32 v225, v199, v199
v_mfma_f32_32x32x16_bf16 v[160:175], v[228:231], v[108:111], v[160:175]
s_waitcnt lgkmcnt(2)
ds_read_b128 v[244:247], v112 offset:18432
v_add_f32_dpp v224, v224, v224 row_ror:8 row_mask:0xf bank_mask:0xf
v_add_f32_dpp v225, v225, v225 row_ror:8 row_mask:0xf bank_mask:0xf
v_mfma_f32_32x32x16_bf16 v[176:191], v[232:235], v[108:111], v[176:191]
s_waitcnt vmcnt(8) lgkmcnt(2)
ds_read_b128 v[248:251], v112 offset:19456
v_permlane16_swap_b32 v224, v225
v_add_f32 v224, v224, v225
v_mov_b32 v225, v224
v_mfma_f32_32x32x16_bf16 v[160:175], v[236:239], v[64:67], v[160:175]
s_waitcnt lgkmcnt(2)
ds_read_b128 v[228:231], v112 offset:32768
v_permlane32_swap_b32 v224, v225
v_add_f32 v224, v224, v225
s_add_u32 s32, s56, 6211584
s_cmp_lg_u32 s68, 0
s_cbranch_scc1 L_alt11
buffer_store_dword v224, v6, s[8:11], s32 offen
L_back11:
v_mfma_f32_32x32x16_bf16 v[176:191], v[240:243], v[64:67], v[176:191]
s_waitcnt vmcnt(8) lgkmcnt(2)
ds_read_b128 v[232:235], v112 offset:33792
buffer_store_dwordx4 v[24:27], v2, s[8:11], s72 offen sc1
buffer_store_dword v224, v6, s[8:11], s73 offen sc1
v_mfma_f32_32x32x16_bf16 v[160:175], v[244:247], v[68:71], v[160:175]
s_waitcnt lgkmcnt(2)
ds_read_b128 v[236:239], v112 offset:34816
v_mfma_f32_32x32x16_bf16 v[176:191], v[248:251], v[68:71], v[176:191]
s_waitcnt vmcnt(9) lgkmcnt(2)
ds_read_b128 v[240:243], v112 offset:35840
v_mfma_f32_32x32x16_bf16 v[160:175], v[228:231], v[72:75], v[160:175]
s_waitcnt lgkmcnt(2)
v_mfma_f32_32x32x16_bf16 v[176:191], v[232:235], v[72:75], v[176:191]
s_waitcnt vmcnt(8) lgkmcnt(1)
s_waitcnt vmcnt(2)
v_mov_b32 v8, 1
s_or_b32 s99, s87, s68
buffer_store_dword v8, v9, s[8:11], s99 offen
s_or_b32 s99, s87, s69
buffer_store_dword v8, v9, s[8:11], s99 offen sc1
v_mfma_f32_32x32x16_bf16 v[160:175], v[236:239], v[76:79], v[160:175]
s_waitcnt lgkmcnt(0)
v_mfma_f32_32x32x16_bf16 v[176:191], v[240:243], v[76:79], v[176:191]
v_mfma_f32_32x32x16_bf16 v[160:175], v[32:35], v[80:83], v[160:175]
v_mfma_f32_32x32x16_bf16 v[176:191], v[36:39], v[80:83], v[176:191]
v_mfma_f32_32x32x16_bf16 v[160:175], v[40:43], v[84:87], v[160:175]
v_mfma_f32_32x32x16_bf16 v[176:191], v[44:47], v[84:87], v[176:191]
v_mfma_f32_32x32x16_bf16 v[160:175], v[48:51], v[88:91], v[160:175]
v_mfma_f32_32x32x16_bf16 v[176:191], v[52:55], v[88:91], v[176:191]
v_mfma_f32_32x32x16_bf16 v[160:175], v[56:59], v[92:95], v[160:175]
v_mfma_f32_32x32x16_bf16 v[176:191], v[60:63], v[92:95], v[176:191]
s_nop 10
ds_write_b128 v3, v[160:163] offset:32768
ds_write_b128 v3, v[164:167] offset:33792
ds_write_b128 v4, v[168:171] offset:34816
ds_write_b128 v4, v[172:175] offset:35840
ds_write_b128 v3, v[176:179] offset:49152
ds_write_b128 v3, v[180:183] offset:50176
ds_write_b128 v4, v[184:187] offset:51200
ds_write_b128 v4, v[188:191] offset:52224
buffer_load_dword v10, v115, s[8:11], s86 offen sc1
s_waitcnt lgkmcnt(0)
s_barrier
ds_read_b128 v[192:195], v5 offset:32768
ds_read_b128 v[196:199], v5 offset:33280
ds_read_b128 v[200:203], v5 offset:36864
ds_read_b128 v[204:207], v5 offset:37376
ds_read_b128 v[208:211], v5 offset:40960
ds_read_b128 v[212:215], v5 offset:41472
ds_read_b128 v[216:219], v5 offset:45056
ds_read_b128 v[220:223], v5 offset:45568
s_waitcnt lgkmcnt(4)
v_pk_add_f32 v[192:193], v[192:193], v[200:201]
v_pk_add_f32 v[194:195], v[194:195], v[202:203]
v_pk_add_f32 v[196:197], v[196:197], v[204:205]
v_pk_add_f32 v[198:199], v[198:199], v[206:207]
v_lshlrev_b32 v200, 16, v20
v_and_b32 v201, 0xffff0000, v20
v_lshlrev_b32 v202, 16, v21
s_waitcnt vmcnt(0)
v_cmp_gt_u32 vcc, 1, v10
s_nop 0
s_and_b32 s99, vcc_lo, 0xffffffff
s_cbranch_scc1 L_spin12
L_back12:
v_and_b32 v203, 0xffff0000, v21
v_lshlrev_b32_e64 v204, 16, v22
v_and_b32 v205, 0xffff0000, v22
v_lshlrev_b32 v206, 16, v23
s_add_u32 m0, s49, 49152
s_add_u32 s32, s47, s92
s_add_u32 s32, s32, 32768
buffer_load_dwordx4 v2, s[8:11], s32 offen offset:0 sc1 lds
v_and_b32 v207, 0xffff0000, v23
v_pk_add_f32 v[192:193], v[192:193], v[200:201]
v_pk_add_f32 v[194:195], v[194:195], v[202:203]
v_pk_add_f32 v[196:197], v[196:197], v[204:205]
s_add_u32 s32, s47, s93
s_add_u32 s32, s32, 32768
buffer_load_dwordx4 v2, s[8:11], s32 offen offset:1024 sc1 lds
v_pk_add_f32 v[198:199], v[198:199], v[206:207]
s_waitcnt lgkmcnt(0)
v_pk_add_f32 v[208:209], v[208:209], v[216:217]
v_pk_add_f32 v[210:211], v[210:211], v[218:219]
s_add_u32 s32, s47, s94
s_add_u32 s32, s32, 32768
buffer_load_dwordx4 v2, s[8:11], s32 offen offset:2048 sc1 lds
v_pk_add_f32 v[212:213], v[212:213], v[220:221]
v_pk_add_f32 v[214:215], v[214:215], v[222:223]
v_pk_add_f32 v[192:193], v[192:193], v[208:209]
v_pk_add_f32 v[194:195], v[194:195], v[210:211]
s_add_u32 s32, s47, s95
s_add_u32 s32, s32, 32768
buffer_load_dwordx4 v2, s[8:11], s32 offen offset:3072 sc1 lds
v_pk_add_f32 v[196:197], v[196:197], v[212:213]
v_pk_add_f32 v[198:199], v[198:199], v[214:215]
v_cvt_pk_bf16_f32 v20, v192, v193
v_cvt_pk_bf16_f32 v21, v194, v195
buffer_load_dwordx4 v[140:143], v226, s[8:11], s90 offen offset:2048 sc1
v_cvt_pk_bf16_f32 v22, v196, v197
v_cvt_pk_bf16_f32 v23, v198, v199
s_add_u32 s32, s55, 11403264
s_cmp_lg_u32 s68, 0
s_cbranch_scc1 L_alt13
buffer_store_dwordx4 v[20:23], v2, s[8:11], s32 offen
L_back13:
v_add_f32_e64 v224, v192, v193
s_add_u32 m0, s49, 0
s_add_u32 s32, s47, s92
s_add_u32 s32, s32, 49152
buffer_load_dwordx4 v2, s[8:11], s32 offen offset:0 sc1 lds
v_mul_f32 v225, v192, v192
v_fmac_f32 v225, v193, v193
v_add_f32_e64 v224, v224, v194
v_fmac_f32 v225, v194, v194
s_add_u32 s32, s47, s93
s_add_u32 s32, s32, 49152
buffer_load_dwordx4 v2, s[8:11], s32 offen offset:1024 sc1 lds
v_add_f32 v224, v224, v195
v_fmac_f32 v225, v195, v195
v_add_f32_e64 v224, v224, v196
v_fmac_f32 v225, v196, v196
s_add_u32 s32, s47, s94
s_add_u32 s32, s32, 49152
buffer_load_dwordx4 v2, s[8:11], s32 offen offset:2048 sc1 lds
v_add_f32 v224, v224, v197
v_fmac_f32 v225, v197, v197
v_add_f32_e64 v224, v224, v198
v_fmac_f32 v225, v198, v198
s_add_u32 s32, s47, s95
s_add_u32 s32, s32, 49152
buffer_load_dwordx4 v2, s[8:11], s32 offen offset:3072 sc1 lds
v_add_f32_e64 v224, v224, v199
v_fmac_f32 v225, v199, v199
s_nop 0
v_add_f32_dpp v224, v224, v224 row_ror:8 row_mask:0xf bank_mask:0xf
v_add_f32_dpp v225, v225, v225 row_ror:8 row_mask:0xf bank_mask:0xf
v_mov_b32_e64 v8, 1
buffer_store_dword v8, v9, s[8:11], s91 offen sc1
v_permlane16_swap_b32 v224, v225
v_add_f32 v224, v224, v225
v_mov_b32 v225, v224
s_nop 1
v_permlane32_swap_b32 v224, v225
v_add_f32 v224, v224, v225
s_add_u32 s32, s56, 6209536
s_cmp_lg_u32 s68, 0
s_cbranch_scc1 L_alt14
buffer_store_dword v224, v6, s[8:11], s32 offen
L_back14:
s_and_b32 s32, s3, 1
s_lshl_b32 s32, s32, 7
v_add_u32 v6, s32, v118
s_mul_i32 s32, s6, 229376
s_add_u32 s32, s32, 17694720
s_lshl_b32 s33, s7, 2
s_add_u32 s33, s33, s3
s_lshl_b32 s53, s33, 10
s_add_u32 s53, s53, s32
s_add_u32 s54, s53, 32768
s_lshl_b32 s32, s6, 5
s_add_u32 s32, s32, s33
s_lshl_b32 s32, s32, 2
s_add_u32 s89, s32, 16384
s_waitcnt vmcnt(8)
s_barrier
ds_read_b128 v[36:39], v116 offset:49152
ds_read_b128 v[40:43], v117 offset:49152
ds_read_b128 v[44:47], v116 offset:50176
ds_read_b128 v[48:51], v117 offset:50176
s_waitcnt lgkmcnt(3)
v_mfma_f32_16x16x32_bf16 v[184:187], a[0:3], v[36:39], 0
s_waitcnt vmcnt(7)
v_add_f32_e64 v140, v140, v142
v_mfma_f32_16x16x32_bf16 v[188:191], a[4:7], v[36:39], 0
v_add_f32 v141, v141, v143
v_mfma_f32_16x16x32_bf16 v[192:195], v[36:39], a[8:11], 0
s_waitcnt lgkmcnt(2)
ds_read_b128 v[36:39], v116 offset:51200
v_mfma_f32_16x16x32_bf16 v[184:187], a[12:15], v[40:43], v[184:187]
v_permlane16_swap_b32 v140, v141
v_mfma_f32_16x16x32_bf16 v[188:191], a[16:19], v[40:43], v[188:191]
v_add_f32 v140, v140, v141
v_mov_b32 v141, v140
v_mfma_f32_16x16x32_bf16 v[192:195], v[40:43], a[20:23], v[192:195]
s_waitcnt lgkmcnt(2)
ds_read_b128 v[40:43], v117 offset:51200
v_mfma_f32_16x16x32_bf16 v[184:187], a[24:27], v[44:47], v[184:187]
v_permlane32_swap_b32 v140, v141
v_mfma_f32_16x16x32_bf16 v[188:191], a[28:31], v[44:47], v[188:191]
v_add_f32 v140, v140, v141
v_mov_b32 v141, v140
v_mfma_f32_16x16x32_bf16 v[192:195], v[44:47], a[32:35], v[192:195]
s_waitcnt lgkmcnt(2)
ds_read_b128 v[44:47], v116 offset:52224
s_waitcnt vmcnt(0)
v_mov_b32 v8, 2
s_or_b32 s99, s87, s68
buffer_store_dword v8, v9, s[8:11], s99 offen
s_or_b32 s99, s87, s69
buffer_store_dword v8, v9, s[8:11], s99 offen sc1
v_mfma_f32_16x16x32_bf16 v[184:187], a[36:39], v[48:51], v[184:187]
v_permlane16_swap_b32 v140, v141
v_mfma_f32_16x16x32_bf16 v[188:191], a[40:43], v[48:51], v[188:191]
v_mul_f32 v140, 0xbb000000, v140
v_mul_f32 v141, 0x3b000000, v141
v_mfma_f32_16x16x32_bf16 v[192:195], v[48:51], a[44:47], v[192:195]
s_waitcnt lgkmcnt(2)
ds_read_b128 v[48:51], v117 offset:52224
v_fma_f32 v141, -v140, v140, v141
v_mfma_f32_16x16x32_bf16 v[184:187], a[48:51], v[36:39], v[184:187]
v_max_f32_e64 v141, 0, v141
v_add_f32 v141, 0x3727c5ac, v141
v_mfma_f32_16x16x32_bf16 v[188:191], a[52:55], v[36:39], v[188:191]
v_rsq_f32 v141, v141
v_mfma_f32_16x16x32_bf16 v[192:195], v[36:39], a[56:59], v[192:195]
s_waitcnt lgkmcnt(2)
ds_read_b128 v[36:39], v116 offset:53248
ds_write_b64 v6, v[140:141] offset:384
v_mfma_f32_16x16x32_bf16 v[184:187], a[60:63], v[40:43], v[184:187]
v_and_b32 v66, 15, v1
v_lshrrev_b32 v67, 4, v1
v_mfma_f32_16x16x32_bf16 v[188:191], a[64:67], v[40:43], v[188:191]
v_lshlrev_b32 v152, 4, v66
v_lshl_add_u32 v155, v67, 2, v152
v_mfma_f32_16x16x32_bf16 v[192:195], v[40:43], a[68:71], v[192:195]
s_waitcnt lgkmcnt(3)
ds_read_b128 v[40:43], v117 offset:53248
v_lshl_add_u32 v152, v67, 9, v152
v_mfma_f32_16x16x32_bf16 v[184:187], a[72:75], v[44:47], v[184:187]
buffer_load_dword v10, v115, s[8:11], s86 offen sc1
v_and_b32_e64 v154, 7, v1
v_mfma_f32_16x16x32_bf16 v[188:191], a[76:79], v[44:47], v[188:191]
v_lshlrev_b32_e64 v154, 4, v154
v_lshl_add_u32 v154, v67, 7, v154
v_mfma_f32_16x16x32_bf16 v[192:195], v[44:47], a[80:83], v[192:195]
s_waitcnt lgkmcnt(3)
ds_read_b128 v[44:47], v116 offset:54272
v_lshrrev_b32 v66, 3, v66
v_mfma_f32_16x16x32_bf16 v[184:187], a[84:87], v[48:51], v[184:187]
v_lshl_add_u32 v154, v66, 13, v154
v_add_u32 v156, 98304, v2
v_mfma_f32_16x16x32_bf16 v[188:191], a[88:91], v[48:51], v[188:191]
v_cmp_gt_u32 vcc, 32, v1
v_mov_b32 v67, 0x80000000
s_nop 0
v_cndmask_b32 v155, v67, v155, vcc
v_mfma_f32_16x16x32_bf16 v[192:195], v[48:51], a[92:95], v[192:195]
s_waitcnt lgkmcnt(3)
ds_read_b128 v[48:51], v117 offset:54272
v_mfma_f32_16x16x32_bf16 v[184:187], a[96:99], v[36:39], v[184:187]
v_mfma_f32_16x16x32_bf16 v[188:191], a[100:103], v[36:39], v[188:191]
v_mfma_f32_16x16x32_bf16 v[192:195], v[36:39], a[104:107], v[192:195]
s_waitcnt lgkmcnt(2)
ds_read_b128 v[36:39], v116 offset:55296
v_mfma_f32_16x16x32_bf16 v[184:187], a[108:111], v[40:43], v[184:187]
v_mfma_f32_16x16x32_bf16 v[188:191], a[112:115], v[40:43], v[188:191]
v_mfma_f32_16x16x32_bf16 v[192:195], v[40:43], a[116:119], v[192:195]
s_waitcnt lgkmcnt(2)
ds_read_b128 v[40:43], v117 offset:55296
v_mfma_f32_16x16x32_bf16 v[184:187], a[120:123], v[44:47], v[184:187]
v_mfma_f32_16x16x32_bf16 v[188:191], a[124:127], v[44:47], v[188:191]
v_mfma_f32_16x16x32_bf16 v[192:195], v[44:47], a[128:131], v[192:195]
s_waitcnt lgkmcnt(2)
ds_read_b128 v[44:47], v116 offset:56320
v_mfma_f32_16x16x32_bf16 v[184:187], a[132:135], v[48:51], v[184:187]
v_mfma_f32_16x16x32_bf16 v[188:191], a[136:139], v[48:51], v[188:191]
v_mfma_f32_16x16x32_bf16 v[192:195], v[48:51], a[140:143], v[192:195]
s_waitcnt lgkmcnt(2)
ds_read_b128 v[48:51], v117 offset:56320
v_mfma_f32_16x16x32_bf16 v[184:187], a[144:147], v[36:39], v[184:187]
s_barrier
s_waitcnt vmcnt(0)
v_cmp_gt_u32 vcc, 2, v10
s_nop 0
s_and_b32 s99, vcc_lo, 0xffffffff
s_cbranch_scc1 L_spin15
L_back15:
v_mfma_f32_16x16x32_bf16 v[188:191], a[148:151], v[36:39], v[188:191]
buffer_load_dwordx4 v[56:59], v226, s[8:11], s90 offen sc1
s_add_u32 m0, s49, 16384
s_add_u32 s32, s47, s92
s_add_u32 s32, s32, 16384
buffer_load_dwordx4 v2, s[8:11], s32 offen offset:0 sc1 lds
v_mfma_f32_16x16x32_bf16 v[192:195], v[36:39], a[152:155], v[192:195]
s_waitcnt lgkmcnt(2)
ds_read_b128 v[36:39], v116 offset:0
v_mfma_f32_16x16x32_bf16 v[184:187], a[156:159], v[40:43], v[184:187]
ds_read_b64 v[104:105], v118 offset:384
ds_read_b128 v[106:109], v119 offset:384
v_mfma_f32_16x16x32_bf16 v[188:191], a[160:163], v[40:43], v[188:191]
s_add_u32 s32, s47, s93
s_add_u32 s32, s32, 16384
buffer_load_dwordx4 v2, s[8:11], s32 offen offset:1024 sc1 lds
v_mfma_f32_16x16x32_bf16 v[192:195], v[40:43], a[164:167], v[192:195]
s_waitcnt lgkmcnt(4)
ds_read_b128 v[40:43], v117 offset:0
ds_read_b128 v[110:113], v119 offset:400
v_mfma_f32_16x16x32_bf16 v[184:187], a[168:171], v[44:47], v[184:187]
v_mfma_f32_16x16x32_bf16 v[188:191], a[172:175], v[44:47], v[188:191]
s_add_u32 s32, s47, s94
s_add_u32 s32, s32, 16384
buffer_load_dwordx4 v2, s[8:11], s32 offen offset:2048 sc1 lds
v_mfma_f32_16x16x32_bf16 v[192:195], v[44:47], a[176:179], v[192:195]
s_waitcnt lgkmcnt(5)
ds_read_b128 v[44:47], v116 offset:1024
v_mfma_f32_16x16x32_bf16 v[184:187], a[180:183], v[48:51], v[184:187]
v_mfma_f32_16x16x32_bf16 v[188:191], a[184:187], v[48:51], v[188:191]
s_add_u32 s32, s47, s95
s_add_u32 s32, s32, 16384
buffer_load_dwordx4 v2, s[8:11], s32 offen offset:3072 sc1 lds
v_mfma_f32_16x16x32_bf16 v[192:195], v[48:51], a[188:191], v[192:195]
s_waitcnt lgkmcnt(5)
ds_read_b128 v[48:51], v117 offset:1024
v_mfma_f32_16x16x32_bf16 v[196:199], a[0:3], v[36:39], 0
v_mfma_f32_16x16x32_bf16 v[200:203], a[4:7], v[36:39], 0
s_add_u32 m0, s49, 32768
s_add_u32 s32, s47, s92
buffer_load_dwordx4 v2, s[8:11], s32 offen offset:0 sc1 lds
v_mfma_f32_16x16x32_bf16 v[204:207], v[36:39], a[8:11], 0
s_waitcnt lgkmcnt(3)
ds_read_b128 v[36:39], v116 offset:2048
v_mfma_f32_16x16x32_bf16 v[196:199], a[12:15], v[40:43], v[196:199]
s_waitcnt lgkmcnt(3)
v_fmac_f32 v184, v104, v12
v_mfma_f32_16x16x32_bf16 v[200:203], a[16:19], v[40:43], v[200:203]
s_add_u32 s32, s47, s93
buffer_load_dwordx4 v2, s[8:11], s32 offen offset:1024 sc1 lds
v_mfma_f32_16x16x32_bf16 v[204:207], v[40:43], a[20:23], v[204:207]
s_waitcnt lgkmcnt(2)
ds_read_b128 v[40:43], v117 offset:2048
v_fmac_f32_e64 v185, v104, v13
v_mfma_f32_16x16x32_bf16 v[196:199], a[24:27], v[44:47], v[196:199]
v_fmac_f32 v186, v104, v14
v_fmac_f32 v187, v104, v15
v_mfma_f32_16x16x32_bf16 v[200:203], a[28:31], v[44:47], v[200:203]
s_add_u32 s32, s47, s94
buffer_load_dwordx4 v2, s[8:11], s32 offen offset:2048 sc1 lds
v_mfma_f32_16x16x32_bf16 v[204:207], v[44:47], a[32:35], v[204:207]
s_waitcnt lgkmcnt(2)
ds_read_b128 v[44:47], v116 offset:3072
v_mul_f32_e64 v70, s46, v105
v_mfma_f32_16x16x32_bf16 v[196:199], a[36:39], v[48:51], v[196:199]
v_cvt_pk_bf16_f32 v100, v184, v185
v_cvt_pk_bf16_f32 v101, v186, v187
v_mfma_f32_16x16x32_bf16 v[200:203], a[40:43], v[48:51], v[200:203]
s_add_u32 s32, s47, s95
buffer_load_dwordx4 v2, s[8:11], s32 offen offset:3072 sc1 lds
v_mfma_f32_16x16x32_bf16 v[204:207], v[48:51], a[44:47], v[204:207]
s_waitcnt lgkmcnt(2)
ds_read_b128 v[48:51], v117 offset:3072
v_fmac_f32_e64 v188, v104, v16
v_mfma_f32_16x16x32_bf16 v[196:199], a[48:51], v[36:39], v[196:199]
v_fmac_f32 v189, v104, v17
v_fmac_f32 v190, v104, v18
v_mfma_f32_16x16x32_bf16 v[200:203], a[52:55], v[36:39], v[200:203]
s_add_u32 s58, s64, 11403264
buffer_load_dwordx4 v[20:23], v154, s[8:11], s58 offen sc1
v_mfma_f32_16x16x32_bf16 v[204:207], v[36:39], a[56:59], v[204:207]
s_waitcnt lgkmcnt(2)
ds_read_b128 v[36:39], v116 offset:4096
s_waitcnt vmcnt(9)
v_mfma_f32_16x16x32_bf16 v[196:199], a[60:63], v[40:43], v[196:199]
v_add_f32 v56, v56, v58
v_add_f32 v57, v57, v59
v_mfma_f32_16x16x32_bf16 v[200:203], a[64:67], v[40:43], v[200:203]
s_add_u32 s58, s64, 11403776
buffer_load_dwordx4 v[24:27], v154, s[8:11], s58 offen sc1
v_mfma_f32_16x16x32_bf16 v[204:207], v[40:43], a[68:71], v[204:207]
s_waitcnt lgkmcnt(2)
ds_read_b128 v[40:43], v117 offset:4096
v_permlane16_swap_b32 v56, v57
v_mfma_f32_16x16x32_bf16 v[196:199], a[72:75], v[44:47], v[196:199]
v_add_f32 v56, v56, v57
v_mov_b32 v57, v56
v_mfma_f32_16x16x32_bf16 v[200:203], a[76:79], v[44:47], v[200:203]
v_cmp_gt_u32 vcc, 16, v1
v_lshlrev_b32 v115, 7, v1
v_mov_b32 v10, 0x80000000
v_cndmask_b32 v115, v10, v115, vcc
s_mov_b32 s86, s52
s_min_u32 s50, s6, 1
buffer_load_dword v10, v115, s[8:11], s86 offen sc1
v_mfma_f32_16x16x32_bf16 v[204:207], v[44:47], a[80:83], v[204:207]
s_waitcnt lgkmcnt(2)
ds_read_b128 v[44:47], v116 offset:5120
s_add_u32 m0, s60, 98304
s_add_u32 s63, s88, 0
buffer_load_dwordx4 v2, s[8:11], s63 offen offset:0 lds
v_mfma_f32_16x16x32_bf16 v[196:199], a[84:87], v[48:51], v[196:199]
v_permlane32_swap_b32 v56, v57
v_mfma_f32_16x16x32_bf16 v[200:203], a[88:91], v[48:51], v[200:203]
v_mfma_f32_16x16x32_bf16 v[204:207], v[48:51], a[92:95], v[204:207]
s_waitcnt lgkmcnt(2)
ds_read_b128 v[48:51], v117 offset:5120
v_add_f32 v56, v56, v57
v_mfma_f32_16x16x32_bf16 v[196:199], a[96:99], v[36:39], v[196:199]
buffer_load_dwordx4 v2, s[8:11], s63 offen offset:1024 lds
v_mov_b32 v57, v56
v_mfma_f32_16x16x32_bf16 v[200:203], a[100:103], v[36:39], v[200:203]
s_nop 0
v_permlane16_swap_b32 v56, v57
v_mfma_f32_16x16x32_bf16 v[204:207], v[36:39], a[104:107], v[204:207]
s_waitcnt lgkmcnt(2)
ds_read_b128 v[36:39], v116 offset:6144
v_mul_f32 v56, 0xbb000000, v56
v_mfma_f32_16x16x32_bf16 v[196:199], a[108:111], v[40:43], v[196:199]
v_mul_f32 v57, 0x3b000000, v57
v_fma_f32 v57, -v56, v56, v57
v_mfma_f32_16x16x32_bf16 v[200:203], a[112:115], v[40:43], v[200:203]
s_add_u32 m0, s60, 65536
s_add_u32 s62, s61, 65536
buffer_load_dwordx4 v2, s[8:11], s62 offen offset:0  lds
v_max_f32 v57, 0, v57
v_mfma_f32_16x16x32_bf16 v[204:207], v[40:43], a[116:119], v[204:207]
s_waitcnt lgkmcnt(2)
ds_read_b128 v[40:43], v117 offset:6144
v_add_f32 v57, 0x3727c5ac, v57
v_mfma_f32_16x16x32_bf16 v[196:199], a[120:123], v[44:47], v[196:199]
v_rsq_f32_e64 v57, v57
v_mfma_f32_16x16x32_bf16 v[200:203], a[124:127], v[44:47], v[200:203]
ds_write_b64 v6, v[56:57] offset:128
v_fmac_f32 v191, v104, v19
v_mfma_f32_16x16x32_bf16 v[204:207], v[44:47], a[128:131], v[204:207]
s_waitcnt lgkmcnt(3)
ds_read_b128 v[44:47], v116 offset:7168
v_mul_f32_e64 v188, v105, v188
v_mfma_f32_16x16x32_bf16 v[196:199], a[132:135], v[48:51], v[196:199]
v_mul_f32_e64 v189, v105, v189
v_mul_f32 v190, v105, v190
v_mfma_f32_16x16x32_bf16 v[200:203], a[136:139], v[48:51], v[200:203]
s_add_u32 m0, s60, 98304
s_nop 0
buffer_load_dwordx4 v2, s[8:11], s63 offen offset:2048 lds
v_mul_f32 v191, v105, v191
v_mfma_f32_16x16x32_bf16 v[204:207], v[48:51], a[140:143], v[204:207]
s_waitcnt lgkmcnt(3)
ds_read_b128 v[48:51], v117 offset:7168
v_cvt_pk_bf16_f32 v82, v188, v189
v_mfma_f32_16x16x32_bf16 v[196:199], a[144:147], v[36:39], v[196:199]
s_waitcnt vmcnt(11) lgkmcnt(2)
s_barrier
s_waitcnt vmcnt(4)
v_cmp_gt_u32 vcc, s50, v10
s_nop 0
s_and_b32 s99, vcc_lo, 0xffff
s_cbranch_scc1 L_spin16
L_back16:
v_mfma_f32_16x16x32_bf16 v[200:203], a[148:151], v[36:39], v[200:203]
buffer_load_dwordx4 v2, s[8:11], s63 offen offset:3072 lds
buffer_load_dwordx4 v[140:143], v227, s[8:11], s51 offen sc1
v_mfma_f32_16x16x32_bf16 v[204:207], v[36:39], a[152:155], v[204:207]
ds_read_b128 v[36:39], v116 offset:16384
s_add_u32 m0, s49, 49152
s_add_u32 s32, s48, s92
buffer_load_dwordx4 v2, s[8:11], s32 offen offset:0 sc1 lds
v_mfma_f32_16x16x32_bf16 v[196:199], a[156:159], v[40:43], v[196:199]
v_cvt_pk_bf16_f32 v83, v190, v191
v_fmac_f32 v192, v106, v11
v_mfma_f32_16x16x32_bf16 v[200:203], a[160:163], v[40:43], v[200:203]
v_fmac_f32 v193, v108, v11
v_fmac_f32 v194, v110, v11
v_mfma_f32_16x16x32_bf16 v[204:207], v[40:43], a[164:167], v[204:207]
s_waitcnt lgkmcnt(2)
ds_read_b128 v[40:43], v117 offset:16384
s_add_u32 m0, s60, 65536
s_nop 0
buffer_load_dwordx4 v2, s[8:11], s62 offen offset:1024  lds
v_mfma_f32_16x16x32_bf16 v[196:199], a[168:171], v[44:47], v[196:199]
s_add_u32 m0, s49, 49152
s_add_u32 s32, s48, s93
buffer_load_dwordx4 v2, s[8:11], s32 offen offset:1024 sc1 lds
v_mfma_f32_16x16x32_bf16 v[200:203], a[172:175], v[44:47], v[200:203]
v_fmac_f32 v195, v112, v11
v_mul_f32 v192, v107, v192
v_mfma_f32_16x16x32_bf16 v[204:207], v[44:47], a[176:179], v[204:207]
s_waitcnt lgkmcnt(2)
ds_read_b128 v[44:47], v116 offset:17408
v_mul_f32 v193, v109, v193
v_mfma_f32_16x16x32_bf16 v[196:199], a[180:183], v[48:51], v[196:199]
s_add_u32 s32, s48, s94
buffer_load_dwordx4 v2, s[8:11], s32 offen offset:2048 sc1 lds
v_mfma_f32_16x16x32_bf16 v[200:203], a[184:187], v[48:51], v[200:203]
v_mul_f32_e64 v194, v111, v194
v_mul_f32 v195, v113, v195
v_mfma_f32_16x16x32_bf16 v[204:207], v[48:51], a[188:191], v[204:207]
s_waitcnt lgkmcnt(2)
ds_read_b128 v[48:51], v117 offset:17408
s_add_u32 m0, s60, 114688
s_add_u32 s63, s88, 16384
buffer_load_dwordx4 v2, s[8:11], s63 offen offset:0 lds
v_mfma_f32_16x16x32_bf16 v[208:211], a[0:3], v[36:39], 0
s_add_u32 m0, s49, 49152
s_add_u32 s32, s48, s95
buffer_load_dwordx4 v2, s[8:11], s32 offen offset:3072 sc1 lds
v_mfma_f32_16x16x32_bf16 v[212:215], a[4:7], v[36:39], 0
v_cvt_pk_bf16_f32 v92, v192, v193
v_cvt_pk_bf16_f32 v93, v194, v195
v_mfma_f32_16x16x32_bf16 v[216:219], v[36:39], a[8:11], 0
s_waitcnt lgkmcnt(2)
ds_read_b128 v[36:39], v116 offset:18432
ds_read_b64 v[104:105], v118 offset:512
v_mfma_f32_16x16x32_bf16 v[208:211], a[12:15], v[40:43], v[208:211]
s_add_u32 m0, s60, 114688
s_nop 0
buffer_load_dwordx4 v2, s[8:11], s63 offen offset:1024 lds
ds_read_b128 v[106:109], v119 offset:512
v_mfma_f32_16x16x32_bf16 v[212:215], a[16:19], v[40:43], v[212:215]
ds_read_b128 v[110:113], v119 offset:528
s_waitcnt lgkmcnt(0)
v_mfma_f32_16x16x32_bf16 v[216:219], v[40:43], a[20:23], v[216:219]
ds_read_b128 v[40:43], v117 offset:18432
v_fmac_f32_e64 v196, v104, v12
v_mfma_f32_16x16x32_bf16 v[208:211], a[24:27], v[44:47], v[208:211]
v_fmac_f32 v197, v104, v13
v_fmac_f32 v198, v104, v14
v_mfma_f32_16x16x32_bf16 v[212:215], a[28:31], v[44:47], v[212:215]
s_add_u32 m0, s60, 65536
s_nop 0
buffer_load_dwordx4 v2, s[8:11], s62 offen offset:2048  lds
v_fmac_f32 v199, v104, v15
v_mfma_f32_16x16x32_bf16 v[216:219], v[44:47], a[32:35], v[216:219]
ds_read_b128 v[44:47], v116 offset:19456
v_mul_f32_e64 v71, s46, v105
v_mfma_f32_16x16x32_bf16 v[208:211], a[36:39], v[48:51], v[208:211]
v_cvt_pk_bf16_f32 v102, v196, v197
v_cvt_pk_bf16_f32 v103, v198, v199
v_mfma_f32_16x16x32_bf16 v[212:215], a[40:43], v[48:51], v[212:215]
v_fmac_f32 v200, v104, v16
v_fmac_f32 v201, v104, v17
v_mfma_f32_16x16x32_bf16 v[216:219], v[48:51], a[44:47], v[216:219]
ds_read_b128 v[48:51], v117 offset:19456
v_fmac_f32_e64 v202, v104, v18
v_mfma_f32_16x16x32_bf16 v[208:211], a[48:51], v[36:39], v[208:211]
v_fmac_f32 v203, v104, v19
v_mul_f32 v200, v105, v200
v_mfma_f32_16x16x32_bf16 v[212:215], a[52:55], v[36:39], v[212:215]
s_add_u32 m0, s60, 114688
s_nop 0
buffer_load_dwordx4 v2, s[8:11], s63 offen offset:2048 lds
v_mul_f32 v201, v105, v201
v_mfma_f32_16x16x32_bf16 v[216:219], v[36:39], a[56:59], v[216:219]
s_waitcnt lgkmcnt(2)
ds_read_b128 v[36:39], v116 offset:20480
v_mul_f32 v202, v105, v202
v_mfma_f32_16x16x32_bf16 v[208:211], a[60:63], v[40:43], v[208:211]
v_mul_f32_e64 v203, v105, v203
v_cvt_pk_bf16_f32 v84, v200, v201
v_mfma_f32_16x16x32_bf16 v[212:215], a[64:67], v[40:43], v[212:215]
v_cvt_pk_bf16_f32 v85, v202, v203
v_fmac_f32 v204, v106, v11
v_mfma_f32_16x16x32_bf16 v[216:219], v[40:43], a[68:71], v[216:219]
s_waitcnt lgkmcnt(2)
ds_read_b128 v[40:43], v117 offset:20480
buffer_load_dwordx4 v2, s[8:11], s63 offen offset:3072 lds
v_mfma_f32_16x16x32_bf16 v[208:211], a[72:75], v[44:47], v[208:211]
v_fmac_f32 v205, v108, v11
v_fmac_f32 v206, v110, v11
v_mfma_f32_16x16x32_bf16 v[212:215], a[76:79], v[44:47], v[212:215]
v_fmac_f32 v207, v112, v11
v_mul_f32 v204, v107, v204
v_mfma_f32_16x16x32_bf16 v[216:219], v[44:47], a[80:83], v[216:219]
s_waitcnt lgkmcnt(2)
ds_read_b128 v[44:47], v116 offset:21504
v_mul_f32 v205, v109, v205
v_mfma_f32_16x16x32_bf16 v[208:211], a[84:87], v[48:51], v[208:211]
s_add_u32 m0, s60, 65536
s_nop 0
buffer_load_dwordx4 v2, s[8:11], s62 offen offset:3072  lds
v_mul_f32 v206, v111, v206
v_mfma_f32_16x16x32_bf16 v[212:215], a[88:91], v[48:51], v[212:215]
v_mul_f32 v207, v113, v207
v_cvt_pk_bf16_f32 v94, v204, v205
v_mfma_f32_16x16x32_bf16 v[216:219], v[48:51], a[92:95], v[216:219]
s_waitcnt lgkmcnt(2)
ds_read_b128 v[48:51], v117 offset:21504
v_cvt_pk_bf16_f32 v95, v206, v207
v_mfma_f32_16x16x32_bf16 v[208:211], a[96:99], v[36:39], v[208:211]
v_mfma_f32_16x16x16_bf16 v[228:231], v[84:85], v[102:103], 0
v_mfma_f32_16x16x32_bf16 v[212:215], a[100:103], v[36:39], v[212:215]
v_mfma_f32_16x16x16_bf16 v[232:235], v[82:83], v[102:103], 0
v_mfma_f32_16x16x32_bf16 v[216:219], v[36:39], a[104:107], v[216:219]
s_waitcnt lgkmcnt(2)
ds_read_b128 v[36:39], v116 offset:22528
s_add_u32 m0, s60, 131072
s_add_u32 s63, s88, 32768
buffer_load_dwordx4 v2, s[8:11], s63 offen offset:0 lds
v_mfma_f32_16x16x32_bf16 v[208:211], a[108:111], v[40:43], v[208:211]
v_mfma_f32_16x16x32_bf16 v[212:215], a[112:115], v[40:43], v[212:215]
v_cndmask_b32 v250, v228, v229, s[40:41]
v_cndmask_b32 v251, v232, v233, s[40:41]
v_mfma_f32_16x16x32_bf16 v[216:219], v[40:43], a[116:119], v[216:219]
s_waitcnt lgkmcnt(2)
ds_read_b128 v[40:43], v117 offset:22528
v_cndmask_b32 v248, v251, v250, s[42:43]
v_mfma_f32_16x16x32_bf16 v[208:211], a[120:123], v[44:47], v[208:211]
buffer_load_dwordx4 v2, s[8:11], s63 offen offset:1024 lds
v_cndmask_b32 v250, v230, v231, s[40:41]
v_mfma_f32_16x16x32_bf16 v[212:215], a[124:127], v[44:47], v[212:215]
v_cndmask_b32 v251, v234, v235, s[40:41]
v_cndmask_b32 v249, v251, v250, s[44:45]
v_mfma_f32_16x16x32_bf16 v[216:219], v[44:47], a[128:131], v[216:219]
s_waitcnt lgkmcnt(2)
ds_read_b128 v[44:47], v116 offset:23552
v_max_f32 v250, v248, v249
v_mfma_f32_16x16x32_bf16 v[208:211], a[132:135], v[48:51], v[208:211]
v_mov_b32_e64 v251, v250
v_mfma_f32_16x16x32_bf16 v[212:215], a[136:139], v[48:51], v[212:215]
s_add_u32 m0, s60, 81920
s_add_u32 s62, s61, 81920
buffer_load_dwordx4 v2, s[8:11], s62 offen offset:0  lds
v_permlane16_swap_b32 v250, v251
v_mfma_f32_16x16x32_bf16 v[216:219], v[48:51], a[140:143], v[216:219]
s_waitcnt lgkmcnt(2)
ds_read_b128 v[48:51], v117 offset:23552
v_max_f32_e64 v250, v250, v251
v_mfma_f32_16x16x32_bf16 v[208:211], a[144:147], v[36:39], v[208:211]
s_barrier
v_mov_b32 v251, v250
v_mfma_f32_16x16x32_bf16 v[212:215], a[148:151], v[36:39], v[212:215]
s_nop 0
v_permlane32_swap_b32 v250, v251
v_mfma_f32_16x16x32_bf16 v[216:219], v[36:39], a[152:155], v[216:219]
s_waitcnt lgkmcnt(2)
ds_read_b128 v[36:39], v116 offset:32768
v_max_f32 v250, v250, v251
v_mfma_f32_16x16x32_bf16 v[208:211], a[156:159], v[40:43], v[208:211]
ds_read_b64 v[104:105], v118 offset:256
ds_read_b128 v[106:109], v119 offset:256
v_mfma_f32_16x16x32_bf16 v[212:215], a[160:163], v[40:43], v[212:215]
s_add_u32 m0, s60, 131072
s_nop 0
buffer_load_dwordx4 v2, s[8:11], s63 offen offset:2048 lds
ds_read_b128 v[110:113], v119 offset:272
v_mfma_f32_16x16x32_bf16 v[216:219], v[40:43], a[164:167], v[216:219]
s_waitcnt lgkmcnt(5)
ds_read_b128 v[40:43], v117 offset:32768
v_mul_f32_e64 v250, v71, v250
v_mfma_f32_16x16x32_bf16 v[208:211], a[168:171], v[44:47], v[208:211]
v_fma_f32 v248, v248, v71, -v250
v_fma_f32 v249, v249, v71, -v250
v_mfma_f32_16x16x32_bf16 v[212:215], a[172:175], v[44:47], v[212:215]
v_exp_f32 v248, v248
v_mfma_f32_16x16x32_bf16 v[216:219], v[44:47], a[176:179], v[216:219]
s_waitcnt lgkmcnt(5)
ds_read_b128 v[44:47], v116 offset:33792
buffer_load_dwordx4 v2, s[8:11], s63 offen offset:3072 lds
v_mfma_f32_16x16x32_bf16 v[208:211], a[180:183], v[48:51], v[208:211]
v_exp_f32_e64 v249, v249
v_mfma_f32_16x16x32_bf16 v[212:215], a[184:187], v[48:51], v[212:215]
v_cvt_pk_bf16_f32 v248, v248, v248
v_cvt_pk_bf16_f32 v249, v249, v249
v_mfma_f32_16x16x32_bf16 v[216:219], v[48:51], a[188:191], v[216:219]
s_waitcnt lgkmcnt(5)
ds_read_b128 v[48:51], v117 offset:33792
v_and_b32 v236, v248, v120
v_mfma_f32_16x16x32_bf16 v[184:187], a[0:3], v[36:39], 0
s_add_u32 m0, s60, 81920
s_nop 0
buffer_load_dwordx4 v2, s[8:11], s62 offen offset:1024  lds
s_waitcnt vmcnt(17)
v_mfma_f32_16x16x32_bf16 v[188:191], a[4:7], v[36:39], 0
v_add_f32 v140, v140, v142
v_add_f32 v141, v141, v143
v_mfma_f32_16x16x32_bf16 v[192:195], v[36:39], a[8:11], 0
s_waitcnt lgkmcnt(2)
ds_read_b128 v[36:39], v116 offset:34816
v_permlane16_swap_b32 v140, v141
v_mfma_f32_16x16x32_bf16 v[184:187], a[12:15], v[40:43], v[184:187]
v_add_f32_e64 v140, v140, v141
v_mov_b32 v141, v140
v_mfma_f32_16x16x32_bf16 v[188:191], a[16:19], v[40:43], v[188:191]
s_nop 0
v_permlane32_swap_b32 v140, v141
v_mfma_f32_16x16x32_bf16 v[192:195], v[40:43], a[20:23], v[192:195]
s_waitcnt lgkmcnt(2)
ds_read_b128 v[40:43], v117 offset:34816
s_add_u32 m0, s60, 147456
s_add_u32 s63, s88, 49152
buffer_load_dwordx4 v2, s[8:11], s63 offen offset:0 lds
v_mfma_f32_16x16x32_bf16 v[184:187], a[24:27], v[44:47], v[184:187]
v_add_f32_e64 v140, v140, v141
v_mov_b32 v141, v140
v_mfma_f32_16x16x32_bf16 v[188:191], a[28:31], v[44:47], v[188:191]
s_nop 0
v_permlane16_swap_b32 v140, v141
v_mfma_f32_16x16x32_bf16 v[192:195], v[44:47], a[32:35], v[192:195]
s_waitcnt lgkmcnt(2)
ds_read_b128 v[44:47], v116 offset:35840
v_mul_f32 v140, 0xbb000000, v140
v_mfma_f32_16x16x32_bf16 v[184:187], a[36:39], v[48:51], v[184:187]
buffer_load_dwordx4 v2, s[8:11], s63 offen offset:1024 lds
v_mul_f32 v141, 0x3b000000, v141
v_mfma_f32_16x16x32_bf16 v[188:191], a[40:43], v[48:51], v[188:191]
v_fma_f32 v141, -v140, v140, v141
v_max_f32 v141, 0, v141
v_mfma_f32_16x16x32_bf16 v[192:195], v[48:51], a[44:47], v[192:195]
s_waitcnt lgkmcnt(2)
ds_read_b128 v[48:51], v117 offset:35840
v_add_f32 v141, 0x3727c5ac, v141
v_mfma_f32_16x16x32_bf16 v[184:187], a[48:51], v[36:39], v[184:187]
v_rsq_f32_e64 v141, v141
v_mfma_f32_16x16x32_bf16 v[188:191], a[52:55], v[36:39], v[188:191]
s_add_u32 m0, s60, 81920
s_nop 0
buffer_load_dwordx4 v2, s[8:11], s62 offen offset:2048  lds
ds_write_b64 v118, v[140:141] offset:0
v_mfma_f32_16x16x32_bf16 v[192:195], v[36:39], a[56:59], v[192:195]
s_waitcnt lgkmcnt(3)
ds_read_b128 v[36:39], v116 offset:36864
v_mfma_f32_16x16x32_bf16 v[184:187], a[60:63], v[40:43], v[184:187]
v_fmac_f32 v208, v104, v12
v_fmac_f32 v209, v104, v13
v_mfma_f32_16x16x32_bf16 v[188:191], a[64:67], v[40:43], v[188:191]
v_fmac_f32 v210, v104, v14
v_fmac_f32 v211, v104, v15
v_mfma_f32_16x16x32_bf16 v[192:195], v[40:43], a[68:71], v[192:195]
s_waitcnt lgkmcnt(3)
ds_read_b128 v[40:43], v117 offset:36864
v_mul_f32 v69, s46, v105
v_mfma_f32_16x16x32_bf16 v[184:187], a[72:75], v[44:47], v[184:187]
v_cvt_pk_bf16_f32 v98, v208, v209
v_cvt_pk_bf16_f32 v99, v210, v211
v_mfma_f32_16x16x32_bf16 v[188:191], a[76:79], v[44:47], v[188:191]
s_add_u32 m0, s60, 147456
s_nop 0
buffer_load_dwordx4 v2, s[8:11], s63 offen offset:2048 lds
v_fmac_f32 v212, v104, v16
v_mfma_f32_16x16x32_bf16 v[192:195], v[44:47], a[80:83], v[192:195]
s_waitcnt lgkmcnt(3)
ds_read_b128 v[44:47], v116 offset:37888
v_fmac_f32 v213, v104, v17
v_mfma_f32_16x16x32_bf16 v[184:187], a[84:87], v[48:51], v[184:187]
v_fmac_f32 v214, v104, v18
v_fmac_f32 v215, v104, v19
v_mfma_f32_16x16x32_bf16 v[188:191], a[88:91], v[48:51], v[188:191]
v_mul_f32_e64 v212, v105, v212
v_mul_f32 v213, v105, v213
v_mfma_f32_16x16x32_bf16 v[192:195], v[48:51], a[92:95], v[192:195]
s_waitcnt lgkmcnt(2)
ds_read_b128 v[48:51], v117 offset:37888
buffer_load_dwordx4 v2, s[8:11], s63 offen offset:3072 lds
v_mfma_f32_16x16x32_bf16 v[184:187], a[96:99], v[36:39], v[184:187]
v_mul_f32 v214, v105, v214
v_mul_f32 v215, v105, v215
v_mfma_f32_16x16x32_bf16 v[188:191], a[100:103], v[36:39], v[188:191]
v_cvt_pk_bf16_f32 v80, v212, v213
v_cvt_pk_bf16_f32 v81, v214, v215
v_mfma_f32_16x16x32_bf16 v[192:195], v[36:39], a[104:107], v[192:195]
s_waitcnt lgkmcnt(2)
ds_read_b128 v[36:39], v116 offset:38912
v_fmac_f32 v216, v106, v11
v_mfma_f32_16x16x32_bf16 v[184:187], a[108:111], v[40:43], v[184:187]
s_add_u32 m0, s60, 0
s_add_u32 s62, s61, 0
buffer_load_dwordx4 v2, s[8:11], s62 offen offset:0  lds
v_fmac_f32_e64 v217, v108, v11
v_mfma_f32_16x16x32_bf16 v[188:191], a[112:115], v[40:43], v[188:191]
v_fmac_f32 v218, v110, v11
v_fmac_f32 v219, v112, v11
v_mfma_f32_16x16x32_bf16 v[192:195], v[40:43], a[116:119], v[192:195]
s_waitcnt lgkmcnt(2)
ds_read_b128 v[40:43], v117 offset:38912
v_mul_f32 v216, v107, v216
v_mfma_f32_16x16x32_bf16 v[184:187], a[120:123], v[44:47], v[184:187]
v_mul_f32 v217, v109, v217
v_mul_f32 v218, v111, v218
v_mfma_f32_16x16x32_bf16 v[188:191], a[124:127], v[44:47], v[188:191]
v_mul_f32 v219, v113, v219
v_cvt_pk_bf16_f32 v90, v216, v217
v_mfma_f32_16x16x32_bf16 v[192:195], v[44:47], a[128:131], v[192:195]
s_waitcnt lgkmcnt(2)
ds_read_b128 v[44:47], v116 offset:39936
buffer_load_dwordx4 v2, s[8:11], s62 offen offset:1024  lds
v_mfma_f32_16x16x32_bf16 v[184:187], a[132:135], v[48:51], v[184:187]
v_cvt_pk_bf16_f32 v91, v218, v219
v_and_b32 v237, v249, v121
v_mfma_f32_16x16x32_bf16 v[188:191], a[136:139], v[48:51], v[188:191]
v_mfma_f32_16x16x16_bf16 v[160:163], v[82:83], v[100:101], 0
v_mfma_f32_16x16x32_bf16 v[192:195], v[48:51], a[140:143], v[192:195]
s_waitcnt lgkmcnt(2)
ds_read_b128 v[48:51], v117 offset:39936
v_mfma_f32_16x16x16_bf16 v[164:167], v[80:81], v[100:101], 0
v_mfma_f32_16x16x32_bf16 v[184:187], a[144:147], v[36:39], v[184:187]
s_waitcnt vmcnt(18)
s_barrier
buffer_load_dwordx4 v2, s[8:11], s62 offen offset:2048  lds
v_mfma_f32_16x16x32_bf16 v[188:191], a[148:151], v[36:39], v[188:191]
v_and_b32 v238, v248, v122
v_and_b32 v239, v249, v123
v_mfma_f32_16x16x32_bf16 v[192:195], v[36:39], a[152:155], v[192:195]
s_waitcnt lgkmcnt(2)
ds_read_b128 v[36:39], v116 offset:49152
v_cndmask_b32 v182, v160, v161, s[40:41]
v_mfma_f32_16x16x32_bf16 v[184:187], a[156:159], v[40:43], v[184:187]
v_cndmask_b32 v183, v164, v165, s[40:41]
v_cndmask_b32 v180, v183, v182, s[42:43]
v_mfma_f32_16x16x32_bf16 v[188:191], a[160:163], v[40:43], v[188:191]
ds_read_b64 v[104:105], v118 offset:128
ds_read_b128 v[106:109], v119 offset:128
v_mfma_f32_16x16x32_bf16 v[192:195], v[40:43], a[164:167], v[192:195]
s_waitcnt lgkmcnt(4)
ds_read_b128 v[40:43], v117 offset:49152
ds_read_b128 v[110:113], v119 offset:144
v_mfma_f32_16x16x32_bf16 v[184:187], a[168:171], v[44:47], v[184:187]
buffer_load_dwordx4 v2, s[8:11], s62 offen offset:3072  lds
v_cndmask_b32 v182, v162, v163, s[40:41]
v_mfma_f32_16x16x32_bf16 v[188:191], a[172:175], v[44:47], v[188:191]
v_cndmask_b32 v183, v166, v167, s[40:41]
v_cndmask_b32 v181, v183, v182, s[44:45]
v_mfma_f32_16x16x32_bf16 v[192:195], v[44:47], a[176:179], v[192:195]
s_waitcnt lgkmcnt(5)
ds_read_b128 v[44:47], v116 offset:50176
v_max_f32 v182, v180, v181
v_mfma_f32_16x16x32_bf16 v[184:187], a[180:183], v[48:51], v[184:187]
v_mov_b32_e64 v183, v182
v_mfma_f32_16x16x32_bf16 v[244:247], v[124:127], v[236:239], 0
v_mfma_f32_16x16x32_bf16 v[188:191], a[184:187], v[48:51], v[188:191]
v_permlane16_swap_b32 v182, v183
v_mfma_f32_16x16x32_bf16 v[192:195], v[48:51], a[188:191], v[192:195]
s_waitcnt lgkmcnt(5)
ds_read_b128 v[48:51], v117 offset:50176
s_add_u32 m0, s60, 16384
s_add_u32 s62, s61, 16384
buffer_load_dwordx4 v2, s[8:11], s62 offen offset:0  lds
v_mfma_f32_16x16x32_bf16 v[200:203], a[4:7], v[36:39], 0
v_max_f32 v182, v182, v183
v_mov_b32 v183, v182
v_mfma_f32_16x16x32_bf16 v[204:207], v[36:39], a[8:11], 0
s_waitcnt lgkmcnt(3)
ds_read_b128 v[36:39], v116 offset:51200
v_permlane32_swap_b32 v182, v183
v_mfma_f32_16x16x32_bf16 v[200:203], a[16:19], v[40:43], v[200:203]
v_max_f32_e64 v182, v182, v183
v_mul_f32 v182, v70, v182
v_mfma_f32_16x16x32_bf16 v[204:207], v[40:43], a[20:23], v[204:207]
s_waitcnt lgkmcnt(2)
ds_read_b128 v[40:43], v117 offset:51200
v_fma_f32 v180, v180, v70, -v182
v_mfma_f32_16x16x32_bf16 v[200:203], a[28:31], v[44:47], v[200:203]
v_fmac_f32 v184, v104, v12
v_mfma_f32_16x16x32_bf16 v[204:207], v[44:47], a[32:35], v[204:207]
s_waitcnt lgkmcnt(2)
ds_read_b128 v[44:47], v116 offset:52224
buffer_load_dwordx4 v2, s[8:11], s62 offen offset:1024  lds
v_mfma_f32_16x16x32_bf16 v[200:203], a[40:43], v[48:51], v[200:203]
v_fmac_f32 v185, v104, v13
v_fmac_f32 v186, v104, v14
v_mfma_f32_16x16x32_bf16 v[204:207], v[48:51], a[44:47], v[204:207]
s_waitcnt lgkmcnt(2)
ds_read_b128 v[48:51], v117 offset:52224
v_fmac_f32 v187, v104, v15
v_mfma_f32_16x16x32_bf16 v[200:203], a[52:55], v[36:39], v[200:203]
v_mul_f32 v68, s46, v105
v_cvt_pk_bf16_f32 v96, v184, v185
v_mfma_f32_16x16x32_bf16 v[204:207], v[36:39], a[56:59], v[204:207]
s_waitcnt lgkmcnt(2)
ds_read_b128 v[36:39], v116 offset:53248
v_cvt_pk_bf16_f32 v97, v186, v187
v_mfma_f32_16x16x32_bf16 v[200:203], a[64:67], v[40:43], v[200:203]
v_fmac_f32_e64 v188, v104, v16
v_fmac_f32 v189, v104, v17
v_mfma_f32_16x16x32_bf16 v[204:207], v[40:43], a[68:71], v[204:207]
s_waitcnt lgkmcnt(2)
ds_read_b128 v[40:43], v117 offset:53248
buffer_load_dwordx4 v2, s[8:11], s62 offen offset:2048  lds
v_mfma_f32_16x16x32_bf16 v[200:203], a[76:79], v[44:47], v[200:203]
v_fmac_f32 v190, v104, v18
v_fmac_f32 v191, v104, v19
v_mfma_f32_16x16x32_bf16 v[204:207], v[44:47], a[80:83], v[204:207]
s_waitcnt lgkmcnt(2)
ds_read_b128 v[44:47], v116 offset:54272
v_mul_f32 v188, v105, v188
v_mfma_f32_16x16x32_bf16 v[200:203], a[88:91], v[48:51], v[200:203]
v_mul_f32 v189, v105, v189
v_mul_f32 v190, v105, v190
v_mfma_f32_16x16x32_bf16 v[204:207], v[48:51], a[92:95], v[204:207]
s_waitcnt lgkmcnt(2)
ds_read_b128 v[48:51], v117 offset:54272
v_mul_f32 v191, v105, v191
v_mfma_f32_16x16x32_bf16 v[200:203], a[100:103], v[36:39], v[200:203]
v_cvt_pk_bf16_f32 v78, v188, v189
v_cvt_pk_bf16_f32 v79, v190, v191
v_mfma_f32_16x16x32_bf16 v[204:207], v[36:39], a[104:107], v[204:207]
s_waitcnt lgkmcnt(2)
ds_read_b128 v[36:39], v116 offset:55296
buffer_load_dwordx4 v2, s[8:11], s62 offen offset:3072  lds
v_mfma_f32_16x16x32_bf16 v[200:203], a[112:115], v[40:43], v[200:203]
v_fmac_f32 v192, v106, v11
v_fmac_f32 v193, v108, v11
v_mfma_f32_16x16x32_bf16 v[204:207], v[40:43], a[116:119], v[204:207]
s_waitcnt lgkmcnt(2)
ds_read_b128 v[40:43], v117 offset:55296
v_fmac_f32_e64 v194, v110, v11
v_mfma_f32_16x16x32_bf16 v[200:203], a[124:127], v[44:47], v[200:203]
v_fmac_f32 v195, v112, v11
v_mul_f32 v192, v107, v192
v_mfma_f32_16x16x32_bf16 v[204:207], v[44:47], a[128:131], v[204:207]
s_waitcnt lgkmcnt(2)
ds_read_b128 v[44:47], v116 offset:56320
v_mul_f32 v193, v109, v193
v_mfma_f32_16x16x32_bf16 v[200:203], a[136:139], v[48:51], v[200:203]
v_mul_f32_e64 v194, v111, v194
v_mul_f32 v195, v113, v195
v_mfma_f32_16x16x32_bf16 v[204:207], v[48:51], a[140:143], v[204:207]
s_waitcnt lgkmcnt(2)
ds_read_b128 v[48:51], v117 offset:56320
v_cvt_pk_bf16_f32 v88, v192, v193
v_mfma_f32_16x16x32_bf16 v[200:203], a[148:151], v[36:39], v[200:203]
v_cvt_pk_bf16_f32 v89, v194, v195
ds_read_b64 v[104:105], v118 offset:0
v_mfma_f32_16x16x32_bf16 v[204:207], v[36:39], a[152:155], v[204:207]
s_waitcnt lgkmcnt(3)
ds_read_b128 v[106:109], v119 offset:0
ds_read_b128 v[110:113], v119 offset:16
v_mfma_f32_16x16x32_bf16 v[200:203], a[160:163], v[40:43], v[200:203]
v_fma_f32 v181, v181, v70, -v182
v_exp_f32 v180, v180
v_mfma_f32_16x16x32_bf16 v[204:207], v[40:43], a[164:167], v[204:207]
s_waitcnt lgkmcnt(4)
v_exp_f32 v181, v181
v_mfma_f32_16x16x32_bf16 v[200:203], a[172:175], v[44:47], v[200:203]
v_cvt_pk_bf16_f32 v180, v180, v180
v_cvt_pk_bf16_f32 v181, v181, v181
v_mfma_f32_16x16x32_bf16 v[204:207], v[44:47], a[176:179], v[204:207]
s_waitcnt lgkmcnt(3)
v_and_b32 v168, v180, v120
v_and_b32_e64 v169, v181, v121
v_mfma_f32_16x16x32_bf16 v[200:203], a[184:187], v[48:51], v[200:203]
v_and_b32 v170, v180, v122
v_and_b32 v171, v181, v123
v_mfma_f32_16x16x32_bf16 v[204:207], v[48:51], a[188:191], v[204:207]
s_nop 0
v_mfma_f32_16x16x32_bf16 v[176:179], v[124:127], v[168:171], 0
s_waitcnt lgkmcnt(0)
s_nop 1
v_fmac_f32 v200, v104, v16
v_fmac_f32 v201, v104, v17
v_fmac_f32 v202, v104, v18
v_fmac_f32 v203, v104, v19
v_mul_f32 v200, v105, v200
v_mul_f32 v201, v105, v201
v_mul_f32 v202, v105, v202
v_mul_f32_e64 v203, v105, v203
v_cvt_pk_bf16_f32 v76, v200, v201
v_cvt_pk_bf16_f32 v77, v202, v203
v_fmac_f32 v204, v106, v11
v_fmac_f32 v205, v108, v11
v_fmac_f32 v206, v110, v11
v_fmac_f32 v207, v112, v11
v_mul_f32 v204, v107, v204
v_mul_f32 v205, v109, v205
v_mul_f32 v206, v111, v206
v_mul_f32 v207, v113, v207
v_cvt_pk_bf16_f32 v86, v204, v205
v_cvt_pk_bf16_f32 v87, v206, v207
v_mfma_f32_16x16x32_bf16 v[240:243], v[92:95], v[236:239], 0
v_mfma_f32_16x16x32_bf16 v[172:175], v[90:93], v[168:171], 0
v_rcp_f32 v248, v244
v_rcp_f32 v180, v176
s_nop 4
v_mul_f32 v240, v248, v240
v_mul_f32 v241, v248, v241
v_mul_f32 v242, v248, v242
v_mul_f32_e64 v243, v248, v243
v_cvt_pk_bf16_f32 v150, v240, v241
v_cvt_pk_bf16_f32 v151, v242, v243
v_mul_f32 v172, v180, v172
v_mul_f32 v173, v180, v173
v_mul_f32_e64 v174, v180, v174
v_mul_f32 v175, v180, v175
v_cvt_pk_bf16_f32 v148, v172, v173
v_cvt_pk_bf16_f32 v149, v174, v175
v_mfma_f32_16x16x16_bf16 v[228:231], v[80:81], v[98:99], 0
v_mfma_f32_16x16x16_bf16 v[232:235], v[78:79], v[98:99], 0
v_permlane16_swap_b32 v148, v150
v_permlane16_swap_b32 v149, v151
s_cmp_lg_u32 s68, 0
s_cbranch_scc1 L_alt17
buffer_store_dwordx4 v[148:151], v2, s[8:11], s54 offen
L_back17:
s_nop 1
v_cndmask_b32 v250, v228, v229, s[40:41]
v_cndmask_b32 v251, v232, v233, s[40:41]
v_cndmask_b32 v248, v251, v250, s[42:43]
v_cndmask_b32 v250, v230, v231, s[40:41]
v_cndmask_b32 v251, v234, v235, s[40:41]
v_cndmask_b32 v249, v251, v250, s[44:45]
v_max_f32 v250, v248, v249
v_mov_b32 v251, v250
v_mfma_f32_16x16x16_bf16 v[160:163], v[78:79], v[96:97], 0
v_mfma_f32_16x16x16_bf16 v[164:167], v[76:77], v[96:97], v[252:255]
s_waitcnt vmcnt(0)
v_mov_b32 v8, 1
s_or_b32 s99, s89, s68
buffer_store_dword v8, v9, s[8:11], s99 offen
s_or_b32 s99, s89, s69
buffer_store_dword v8, v9, s[8:11], s99 offen sc1
v_permlane16_swap_b32 v250, v251
v_max_f32 v250, v250, v251
v_mov_b32_e64 v251, v250
v_cndmask_b32 v182, v160, v161, s[40:41]
v_cndmask_b32 v183, v164, v165, s[40:41]
v_cndmask_b32 v180, v183, v182, s[42:43]
v_cndmask_b32 v182, v162, v163, s[40:41]
v_cndmask_b32 v183, v166, v167, s[40:41]
v_cndmask_b32 v181, v183, v182, s[44:45]
v_max_f32 v182, v180, v181
v_mov_b32 v183, v182
v_permlane32_swap_b32 v250, v251
v_max_f32 v250, v250, v251
v_mul_f32_e64 v250, v69, v250
v_fma_f32 v248, v248, v69, -v250
v_fma_f32 v249, v249, v69, -v250
v_exp_f32 v248, v248
v_exp_f32 v249, v249
v_cvt_pk_bf16_f32 v248, v248, v248
v_cvt_pk_bf16_f32 v249, v249, v249
v_and_b32 v236, v248, v120
v_and_b32 v237, v249, v121
v_and_b32 v238, v248, v122
v_and_b32 v239, v249, v123
v_permlane16_swap_b32 v182, v183
v_max_f32 v182, v182, v183
v_mov_b32_e64 v183, v182
v_mfma_f32_16x16x32_bf16 v[244:247], v[124:127], v[236:239], 0
v_mfma_f32_16x16x32_bf16 v[240:243], v[88:91], v[236:239], 0
v_permlane32_swap_b32 v182, v183
v_max_f32 v182, v182, v183
v_mul_f32_e64 v182, v68, v182
v_fma_f32 v180, v180, v68, -v182
v_fma_f32 v181, v181, v68, -v182
v_exp_f32 v180, v180
v_exp_f32 v181, v181
v_cvt_pk_bf16_f32 v180, v180, v180
v_cvt_pk_bf16_f32 v181, v181, v181
v_and_b32 v168, v180, v120
v_and_b32 v169, v181, v121
v_and_b32 v170, v180, v122
v_and_b32 v171, v181, v123
v_rcp_f32 v248, v244
s_nop 0
v_mfma_f32_16x16x32_bf16 v[176:179], v[124:127], v[168:171], 0
v_mfma_f32_16x16x32_bf16 v[172:175], v[86:89], v[168:171], 0
v_mul_f32 v240, v248, v240
v_mul_f32 v241, v248, v241
v_mul_f32 v242, v248, v242
v_mul_f32 v243, v248, v243
v_cvt_pk_bf16_f32 v146, v240, v241
v_cvt_pk_bf16_f32 v147, v242, v243
s_nop 0
v_rcp_f32 v180, v176
s_nop 0
v_mul_f32 v172, v180, v172
v_mul_f32 v173, v180, v173
v_mul_f32 v174, v180, v174
v_mul_f32_e64 v175, v180, v175
v_cvt_pk_bf16_f32 v144, v172, v173
v_cvt_pk_bf16_f32 v145, v174, v175
v_cmp_gt_u32 vcc, 32, v1
v_lshlrev_b32 v153, 2, v1
v_mov_b32 v10, 0x80000000
v_cndmask_b32 v153, v10, v153, vcc
s_lshl_b32 s32, s6, 7
s_add_u32 s86, s32, 16384
s_mul_i32 s59, s6, 229376
s_add_u32 s59, s59, 17694720
s_and_b32 s32, s80, 0xffff
s_add_u32 s59, s59, s32
buffer_load_dword v10, v153, s[8:11], s86 offen sc1
v_permlane16_swap_b32 v144, v146
v_permlane16_swap_b32 v145, v147
s_cmp_lg_u32 s68, 0
s_cbranch_scc1 L_alt18
buffer_store_dwordx4 v[144:147], v2, s[8:11], s53 offen
L_back18:
s_barrier
ds_read_b128 v[160:163], v156 offset:0
ds_read_b128 v[164:167], v156 offset:1024
ds_read_b128 v[168:171], v156 offset:2048
ds_read_b128 v[172:175], v156 offset:3072
ds_read_b128 v[176:179], v156 offset:4096
ds_read_b128 v[180:183], v156 offset:5120
ds_read_b128 v[184:187], v156 offset:6144
ds_read_b128 v[188:191], v156 offset:7168
s_add_u32 s87, s66, 20480
s_lshl_b32 s50, s4, 1
s_and_b32 s33, s3, 1
s_add_u32 s50, s50, s33
s_lshl_b32 s50, s50, 1
s_lshr_b32 s33, s3, 1
s_add_u32 s50, s50, s33
v_and_b32 v240, 31, v1
v_mov_b32 v3, v2
v_add_u32 v4, 0x10000, v2
v_add_u32 v5, 0x20000, v2
v_lshrrev_b32 v241, 5, v1
v_lshlrev_b32 v31, 4, v240
v_lshl_add_u32 v31, v241, 10, v31
v_lshrrev_b32 v243, 3, v240
v_lshlrev_b32 v243, 13, v243
v_lshl_add_u32 v243, v241, 7, v243
v_and_b32_e64 v240, 7, v1
v_lshl_add_u32 v243, v240, 4, v243
s_lshl_b32 s32, s50, 11
s_add_u32 s51, s32, 6209536
s_lshl_b32 s32, s50, 15
s_add_u32 s52, s32, 11403264
s_add_u32 s53, s52, 4096
s_lshl_b32 s54, s4, 1
s_and_b32 s33, s3, 1
s_add_u32 s54, s54, s33
s_lshl_b32 s54, s54, 1
s_lshr_b32 s33, s3, 1
s_add_u32 s54, s54, s33
s_mul_i32 s54, s54, 112
s_mul_i32 s33, s5, 7
s_add_u32 s54, s54, s33
s_lshl_b32 s54, s54, 10
s_add_u32 s54, s54, 17694720
s_lshr_b32 s32, s50, 1
s_lshl_b32 s32, s32, 4
s_add_u32 s32, s32, s5
s_lshl_b32 s32, s32, 1
s_and_b32 s33, s50, 1
s_add_u32 s32, s32, s33
s_lshl_b32 s32, s32, 2
s_add_u32 s81, s32, 24576
s_waitcnt vmcnt(0)
v_mov_b32_e64 v8, 2
s_or_b32 s99, s89, s68
buffer_store_dword v8, v9, s[8:11], s99 offen
s_or_b32 s99, s89, s69
buffer_store_dword v8, v9, s[8:11], s99 offen sc1
s_cmp_lt_u32 s3, 2
s_cbranch_scc1 L_wo_late1
v_cmp_gt_u32 vcc, 1, v10
s_nop 0
s_and_b32 s99, vcc_lo, 0xffffffff
s_cbranch_scc1 L_spin19
L_back19:
s_add_u32 s58, s59, 0
buffer_load_dwordx4 v[32:35], v152, s[8:11], s58 offen offset:0 sc1
buffer_load_dwordx4 v[36:39], v152, s[8:11], s58 offen offset:2048 sc1
s_add_u32 s58, s59, 4096
buffer_load_dwordx4 v[40:43], v152, s[8:11], s58 offen offset:0 sc1
buffer_load_dwordx4 v[44:47], v152, s[8:11], s58 offen offset:2048 sc1
s_add_u32 s58, s59, 8192
buffer_load_dwordx4 v[48:51], v152, s[8:11], s58 offen offset:0 sc1
buffer_load_dwordx4 v[52:55], v152, s[8:11], s58 offen offset:2048 sc1
s_branch L_wo_join1
L_wo_late1:
buffer_load_dword v10, v153, s[8:11], s86 offen sc1
s_sleep 2
buffer_load_dword v157, v153, s[8:11], s86 offen sc1
s_waitcnt vmcnt(1)
v_cmp_gt_u32 vcc, 2, v10
s_nop 0
s_and_b32 s99, vcc_lo, 0xffffffff
s_cbranch_scc1 L_spin20
L_back20:
s_add_u32 s58, s59, 0
buffer_load_dwordx4 v[32:35], v152, s[8:11], s58 offen offset:0 sc1
buffer_load_dwordx4 v[36:39], v152, s[8:11], s58 offen offset:2048 sc1
s_add_u32 s58, s59, 4096
buffer_load_dwordx4 v[40:43], v152, s[8:11], s58 offen offset:0 sc1
buffer_load_dwordx4 v[44:47], v152, s[8:11], s58 offen offset:2048 sc1
s_add_u32 s58, s59, 8192
buffer_load_dwordx4 v[48:51], v152, s[8:11], s58 offen offset:0 sc1
buffer_load_dwordx4 v[52:55], v152, s[8:11], s58 offen offset:2048 sc1
L_wo_join1:
s_waitcnt vmcnt(5) lgkmcnt(7)
v_mfma_f32_16x16x32_bf16 v[192:195], v[160:163], v[32:35], 0
s_waitcnt lgkmcnt(6)
ds_read_b128 v[160:163], v156 offset:8192
s_add_u32 s58, s59, 12288
buffer_load_dwordx4 v[56:59], v152, s[8:11], s58 offen offset:0 sc1
v_mfma_f32_16x16x32_bf16 v[196:199], v[164:167], v[32:35], 0
s_waitcnt lgkmcnt(6)
ds_read_b128 v[164:167], v156 offset:9216
v_mfma_f32_16x16x32_bf16 v[200:203], v[168:171], v[32:35], 0
s_waitcnt lgkmcnt(6)
ds_read_b128 v[168:171], v156 offset:10240
buffer_load_dwordx4 v[60:63], v152, s[8:11], s58 offen offset:2048 sc1
v_mfma_f32_16x16x32_bf16 v[204:207], v[172:175], v[32:35], 0
s_waitcnt vmcnt(6) lgkmcnt(6)
ds_read_b128 v[172:175], v156 offset:11264
v_mfma_f32_16x16x32_bf16 v[192:195], v[176:179], v[36:39], v[192:195]
s_waitcnt lgkmcnt(6)
ds_read_b128 v[176:179], v156 offset:12288
s_add_u32 s58, s59, 16384
buffer_load_dwordx4 v[64:67], v152, s[8:11], s58 offen offset:0 sc1
v_mfma_f32_16x16x32_bf16 v[196:199], v[180:183], v[36:39], v[196:199]
s_waitcnt lgkmcnt(6)
ds_read_b128 v[180:183], v156 offset:13312
v_mfma_f32_16x16x32_bf16 v[200:203], v[184:187], v[36:39], v[200:203]
s_waitcnt lgkmcnt(6)
ds_read_b128 v[184:187], v156 offset:14336
buffer_load_dwordx4 v[68:71], v152, s[8:11], s58 offen offset:2048 sc1
v_mfma_f32_16x16x32_bf16 v[204:207], v[188:191], v[36:39], v[204:207]
s_waitcnt vmcnt(7) lgkmcnt(6)
ds_read_b128 v[188:191], v156 offset:15360
v_mfma_f32_16x16x32_bf16 v[192:195], v[160:163], v[40:43], v[192:195]
s_waitcnt lgkmcnt(6)
ds_read_b128 v[160:163], v156 offset:16384
s_add_u32 s58, s59, 20480
buffer_load_dwordx4 v[72:75], v152, s[8:11], s58 offen offset:0 sc1
v_mfma_f32_16x16x32_bf16 v[196:199], v[164:167], v[40:43], v[196:199]
s_waitcnt lgkmcnt(6)
ds_read_b128 v[164:167], v156 offset:17408
v_mfma_f32_16x16x32_bf16 v[200:203], v[168:171], v[40:43], v[200:203]
s_waitcnt lgkmcnt(6)
ds_read_b128 v[168:171], v156 offset:18432
buffer_load_dwordx4 v[76:79], v152, s[8:11], s58 offen offset:2048 sc1
v_mfma_f32_16x16x32_bf16 v[204:207], v[172:175], v[40:43], v[204:207]
s_waitcnt vmcnt(8) lgkmcnt(6)
ds_read_b128 v[172:175], v156 offset:19456
v_lshlrev_b32 v208, 16, v20
v_mfma_f32_16x16x32_bf16 v[192:195], v[176:179], v[44:47], v[192:195]
s_waitcnt lgkmcnt(6)
ds_read_b128 v[176:179], v156 offset:20480
s_add_u32 s58, s59, 24576
buffer_load_dwordx4 v[80:83], v152, s[8:11], s58 offen offset:0 sc1
v_mfma_f32_16x16x32_bf16 v[196:199], v[180:183], v[44:47], v[196:199]
s_waitcnt lgkmcnt(6)
ds_read_b128 v[180:183], v156 offset:21504
v_and_b32 v209, 0xffff0000, v20
v_mfma_f32_16x16x32_bf16 v[200:203], v[184:187], v[44:47], v[200:203]
s_waitcnt lgkmcnt(6)
ds_read_b128 v[184:187], v156 offset:22528
buffer_load_dwordx4 v[84:87], v152, s[8:11], s58 offen offset:2048 sc1
v_mfma_f32_16x16x32_bf16 v[204:207], v[188:191], v[44:47], v[204:207]
s_waitcnt vmcnt(9) lgkmcnt(6)
ds_read_b128 v[188:191], v156 offset:23552
v_lshlrev_b32 v210, 16, v21
v_mfma_f32_16x16x32_bf16 v[192:195], v[160:163], v[48:51], v[192:195]
s_waitcnt lgkmcnt(6)
ds_read_b128 v[160:163], v156 offset:24576
s_add_u32 s58, s59, 28672
buffer_load_dwordx4 v[88:91], v152, s[8:11], s58 offen offset:0 sc1
v_mfma_f32_16x16x32_bf16 v[196:199], v[164:167], v[48:51], v[196:199]
s_waitcnt lgkmcnt(6)
ds_read_b128 v[164:167], v156 offset:25600
v_and_b32 v211, 0xffff0000, v21
v_mfma_f32_16x16x32_bf16 v[200:203], v[168:171], v[48:51], v[200:203]
s_waitcnt lgkmcnt(6)
ds_read_b128 v[168:171], v156 offset:26624
buffer_load_dwordx4 v[92:95], v152, s[8:11], s58 offen offset:2048 sc1
v_mfma_f32_16x16x32_bf16 v[204:207], v[172:175], v[48:51], v[204:207]
s_waitcnt vmcnt(10) lgkmcnt(6)
ds_read_b128 v[172:175], v156 offset:27648
v_lshlrev_b32 v212, 16, v22
v_mfma_f32_16x16x32_bf16 v[192:195], v[176:179], v[52:55], v[192:195]
s_waitcnt lgkmcnt(6)
ds_read_b128 v[176:179], v156 offset:28672
v_and_b32 v213, 0xffff0000, v22
v_mfma_f32_16x16x32_bf16 v[196:199], v[180:183], v[52:55], v[196:199]
s_waitcnt lgkmcnt(6)
ds_read_b128 v[180:183], v156 offset:29696
v_lshlrev_b32 v214, 16, v23
v_mfma_f32_16x16x32_bf16 v[200:203], v[184:187], v[52:55], v[200:203]
s_waitcnt lgkmcnt(6)
ds_read_b128 v[184:187], v156 offset:30720
v_and_b32 v215, 0xffff0000, v23
v_mfma_f32_16x16x32_bf16 v[204:207], v[188:191], v[52:55], v[204:207]
s_waitcnt vmcnt(9) lgkmcnt(6)
ds_read_b128 v[188:191], v156 offset:31744
v_lshlrev_b32 v216, 16, v24
v_mfma_f32_16x16x32_bf16 v[192:195], v[160:163], v[56:59], v[192:195]
s_waitcnt lgkmcnt(6)
ds_read_b128 v[160:163], v156 offset:32768
v_and_b32 v217, 0xffff0000, v24
v_mfma_f32_16x16x32_bf16 v[196:199], v[164:167], v[56:59], v[196:199]
s_waitcnt lgkmcnt(6)
ds_read_b128 v[164:167], v156 offset:33792
v_lshlrev_b32 v218, 16, v25
v_mfma_f32_16x16x32_bf16 v[200:203], v[168:171], v[56:59], v[200:203]
s_waitcnt lgkmcnt(6)
ds_read_b128 v[168:171], v156 offset:34816
v_and_b32 v219, 0xffff0000, v25
v_mfma_f32_16x16x32_bf16 v[204:207], v[172:175], v[56:59], v[204:207]
s_waitcnt vmcnt(8) lgkmcnt(6)
ds_read_b128 v[172:175], v156 offset:35840
v_lshlrev_b32 v220, 16, v26
v_mfma_f32_16x16x32_bf16 v[192:195], v[176:179], v[60:63], v[192:195]
s_waitcnt lgkmcnt(6)
ds_read_b128 v[176:179], v156 offset:36864
v_and_b32 v221, 0xffff0000, v26
v_mfma_f32_16x16x32_bf16 v[196:199], v[180:183], v[60:63], v[196:199]
s_waitcnt lgkmcnt(6)
ds_read_b128 v[180:183], v156 offset:37888
v_lshlrev_b32_e64 v222, 16, v27
v_mfma_f32_16x16x32_bf16 v[200:203], v[184:187], v[60:63], v[200:203]
s_waitcnt lgkmcnt(6)
ds_read_b128 v[184:187], v156 offset:38912
v_and_b32 v223, 0xffff0000, v27
v_mfma_f32_16x16x32_bf16 v[204:207], v[188:191], v[60:63], v[204:207]
s_waitcnt vmcnt(7) lgkmcnt(6)
ds_read_b128 v[188:191], v156 offset:39936
v_mfma_f32_16x16x32_bf16 v[192:195], v[160:163], v[64:67], v[192:195]
s_waitcnt lgkmcnt(6)
ds_read_b128 v[160:163], v156 offset:40960
v_mfma_f32_16x16x32_bf16 v[196:199], v[164:167], v[64:67], v[196:199]
s_waitcnt lgkmcnt(6)
ds_read_b128 v[164:167], v156 offset:41984
v_mfma_f32_16x16x32_bf16 v[200:203], v[168:171], v[64:67], v[200:203]
s_waitcnt lgkmcnt(6)
ds_read_b128 v[168:171], v156 offset:43008
v_mfma_f32_16x16x32_bf16 v[204:207], v[172:175], v[64:67], v[204:207]
s_waitcnt vmcnt(6) lgkmcnt(6)
ds_read_b128 v[172:175], v156 offset:44032
v_mfma_f32_16x16x32_bf16 v[192:195], v[176:179], v[68:71], v[192:195]
s_waitcnt lgkmcnt(6)
ds_read_b128 v[176:179], v156 offset:45056
v_mfma_f32_16x16x32_bf16 v[196:199], v[180:183], v[68:71], v[196:199]
s_waitcnt lgkmcnt(6)
ds_read_b128 v[180:183], v156 offset:46080
v_mfma_f32_16x16x32_bf16 v[200:203], v[184:187], v[68:71], v[200:203]
s_waitcnt lgkmcnt(6)
ds_read_b128 v[184:187], v156 offset:47104
v_mfma_f32_16x16x32_bf16 v[204:207], v[188:191], v[68:71], v[204:207]
s_waitcnt vmcnt(5) lgkmcnt(6)
ds_read_b128 v[188:191], v156 offset:48128
v_mfma_f32_16x16x32_bf16 v[192:195], v[160:163], v[72:75], v[192:195]
s_waitcnt lgkmcnt(6)
ds_read_b128 v[160:163], v156 offset:49152
v_mfma_f32_16x16x32_bf16 v[196:199], v[164:167], v[72:75], v[196:199]
s_waitcnt lgkmcnt(6)
ds_read_b128 v[164:167], v156 offset:50176
v_mfma_f32_16x16x32_bf16 v[200:203], v[168:171], v[72:75], v[200:203]
s_waitcnt lgkmcnt(6)
ds_read_b128 v[168:171], v156 offset:51200
v_mfma_f32_16x16x32_bf16 v[204:207], v[172:175], v[72:75], v[204:207]
s_waitcnt vmcnt(4) lgkmcnt(6)
ds_read_b128 v[172:175], v156 offset:52224
v_mfma_f32_16x16x32_bf16 v[192:195], v[176:179], v[76:79], v[192:195]
s_waitcnt lgkmcnt(6)
ds_read_b128 v[176:179], v156 offset:53248
v_mfma_f32_16x16x32_bf16 v[196:199], v[180:183], v[76:79], v[196:199]
s_waitcnt lgkmcnt(6)
ds_read_b128 v[180:183], v156 offset:54272
s_add_u32 m0, s60, 32768
s_add_u32 s62, s61, 32768
buffer_load_dwordx4 v2, s[8:11], s62 offen offset:0  lds
v_mfma_f32_16x16x32_bf16 v[200:203], v[184:187], v[76:79], v[200:203]
s_waitcnt lgkmcnt(6)
ds_read_b128 v[184:187], v156 offset:55296
v_mfma_f32_16x16x32_bf16 v[204:207], v[188:191], v[76:79], v[204:207]
s_waitcnt vmcnt(4) lgkmcnt(6)
ds_read_b128 v[188:191], v156 offset:56320
buffer_load_dwordx4 v2, s[8:11], s62 offen offset:1024  lds
v_mfma_f32_16x16x32_bf16 v[192:195], v[160:163], v[80:83], v[192:195]
s_waitcnt lgkmcnt(6)
ds_read_b128 v[160:163], v156 offset:57344
v_mfma_f32_16x16x32_bf16 v[196:199], v[164:167], v[80:83], v[196:199]
s_waitcnt lgkmcnt(6)
ds_read_b128 v[164:167], v156 offset:58368
buffer_load_dwordx4 v2, s[8:11], s62 offen offset:2048  lds
v_mfma_f32_16x16x32_bf16 v[200:203], v[168:171], v[80:83], v[200:203]
s_waitcnt lgkmcnt(6)
ds_read_b128 v[168:171], v156 offset:59392
v_mfma_f32_16x16x32_bf16 v[204:207], v[172:175], v[80:83], v[204:207]
s_waitcnt vmcnt(5) lgkmcnt(6)
ds_read_b128 v[172:175], v156 offset:60416
buffer_load_dwordx4 v2, s[8:11], s62 offen offset:3072  lds
v_mfma_f32_16x16x32_bf16 v[192:195], v[176:179], v[84:87], v[192:195]
s_waitcnt lgkmcnt(6)
ds_read_b128 v[176:179], v156 offset:61440
v_mfma_f32_16x16x32_bf16 v[196:199], v[180:183], v[84:87], v[196:199]
s_waitcnt lgkmcnt(6)
ds_read_b128 v[180:183], v156 offset:62464
s_add_u32 m0, s60, 49152
s_add_u32 s62, s61, 49152
buffer_load_dwordx4 v2, s[8:11], s62 offen offset:0  lds
v_mfma_f32_16x16x32_bf16 v[200:203], v[184:187], v[84:87], v[200:203]
s_waitcnt lgkmcnt(6)
ds_read_b128 v[184:187], v156 offset:63488
v_mfma_f32_16x16x32_bf16 v[204:207], v[188:191], v[84:87], v[204:207]
s_waitcnt vmcnt(6) lgkmcnt(6)
ds_read_b128 v[188:191], v156 offset:64512
buffer_load_dwordx4 v2, s[8:11], s62 offen offset:1024  lds
v_mfma_f32_16x16x32_bf16 v[192:195], v[160:163], v[88:91], v[192:195]
s_waitcnt lgkmcnt(6)
v_mfma_f32_16x16x32_bf16 v[196:199], v[164:167], v[88:91], v[196:199]
s_waitcnt lgkmcnt(5)
buffer_load_dwordx4 v2, s[8:11], s62 offen offset:2048  lds
v_mfma_f32_16x16x32_bf16 v[200:203], v[168:171], v[88:91], v[200:203]
s_waitcnt lgkmcnt(4)
v_mfma_f32_16x16x32_bf16 v[204:207], v[172:175], v[88:91], v[204:207]
s_waitcnt vmcnt(7) lgkmcnt(3)
buffer_load_dwordx4 v2, s[8:11], s62 offen offset:3072  lds
v_mfma_f32_16x16x32_bf16 v[192:195], v[176:179], v[92:95], v[192:195]
s_waitcnt lgkmcnt(2)
v_mfma_f32_16x16x32_bf16 v[196:199], v[180:183], v[92:95], v[196:199]
s_waitcnt lgkmcnt(1)
s_add_u32 m0, s60, 81920
s_add_u32 s62, s61, 81920
buffer_load_dwordx4 v2, s[8:11], s62 offen offset:3072  lds
v_mfma_f32_16x16x32_bf16 v[200:203], v[184:187], v[92:95], v[200:203]
s_waitcnt lgkmcnt(0)
v_mfma_f32_16x16x32_bf16 v[204:207], v[188:191], v[92:95], v[204:207]
v_pk_add_f32 v[208:209], v[208:209], v[192:193]
v_pk_add_f32 v[210:211], v[210:211], v[194:195]
v_pk_add_f32 v[212:213], v[212:213], v[196:197]
v_pk_add_f32 v[214:215], v[214:215], v[198:199]
s_nop 1
v_pk_add_f32 v[216:217], v[216:217], v[200:201]
v_pk_add_f32 v[218:219], v[218:219], v[202:203]
v_pk_add_f32 v[220:221], v[220:221], v[204:205]
v_pk_add_f32 v[222:223], v[222:223], v[206:207]
s_add_u32 s58, s64, 11403264
v_cvt_pk_bf16_f32 v20, v208, v209
v_cvt_pk_bf16_f32 v21, v210, v211
v_cvt_pk_bf16_f32 v22, v212, v213
v_cvt_pk_bf16_f32 v23, v214, v215
s_cmp_lg_u32 s68, 0
s_cbranch_scc1 L_alt21
buffer_store_dwordx4 v[20:23], v154, s[8:11], s58 offen
L_back21:
s_add_u32 s58, s64, 11403776
v_cvt_pk_bf16_f32 v24, v216, v217
v_cvt_pk_bf16_f32 v25, v218, v219
v_cvt_pk_bf16_f32 v26, v220, v221
v_cvt_pk_bf16_f32 v27, v222, v223
s_cmp_lg_u32 s68, 0
s_cbranch_scc1 L_alt22
buffer_store_dwordx4 v[24:27], v154, s[8:11], s58 offen
L_back22:
v_pk_add_f32 v[224:225], v[208:209], v[210:211]
v_pk_mul_f32 v[226:227], v[208:209], v[208:209]
v_pk_fma_f32 v[226:227], v[210:211], v[210:211], v[226:227]
v_pk_add_f32 v[224:225], v[224:225], v[212:213]
v_pk_fma_f32 v[226:227], v[212:213], v[212:213], v[226:227]
v_pk_add_f32 v[224:225], v[224:225], v[214:215]
v_pk_fma_f32 v[226:227], v[214:215], v[214:215], v[226:227]
v_pk_add_f32 v[224:225], v[224:225], v[216:217]
v_pk_fma_f32 v[226:227], v[216:217], v[216:217], v[226:227]
v_pk_add_f32 v[224:225], v[224:225], v[218:219]
v_pk_fma_f32 v[226:227], v[218:219], v[218:219], v[226:227]
v_pk_add_f32 v[224:225], v[224:225], v[220:221]
v_pk_fma_f32 v[226:227], v[220:221], v[220:221], v[226:227]
v_pk_add_f32 v[224:225], v[224:225], v[222:223]
v_pk_fma_f32 v[226:227], v[222:223], v[222:223], v[226:227]
v_add_f32 v224, v224, v225
v_add_f32 v226, v226, v227
s_add_u32 s58, s65, 6209536
s_nop 0
v_permlane16_swap_b32 v224, v226
v_add_f32 v224, v224, v226
v_mov_b32 v226, v224
s_nop 1
v_permlane32_swap_b32 v224, v226
v_add_f32_e64 v224, v224, v226
s_cmp_lg_u32 s68, 0
s_cbranch_scc1 L_alt23
buffer_store_dword v224, v155, s[8:11], s58 offen
L_back23:
v_cmp_gt_u32 vcc, 16, v1
v_lshlrev_b32 v242, 2, v1
v_mov_b32 v10, 0x80000000
v_cndmask_b32 v242, v10, v242, vcc
s_lshl_b32 s32, s50, 6
s_add_u32 s86, s32, 20480
s_waitcnt vmcnt(0)
v_mov_b32 v8, 1
s_or_b32 s99, s87, s68
buffer_store_dword v8, v9, s[8:11], s99 offen
s_or_b32 s99, s87, s69
buffer_store_dword v8, v9, s[8:11], s99 offen sc1
buffer_load_dword v10, v242, s[8:11], s86 offen sc1
s_mov_b32 s87, s81
s_sleep 2
buffer_load_dword v20, v242, s[8:11], s86 offen sc1
s_waitcnt vmcnt(1)
v_cmp_gt_u32 vcc, 1, v10
s_nop 0
s_and_b32 s99, vcc_lo, 0xffff
s_cbranch_scc1 L_spin24
L_back24:
buffer_load_dwordx4 v[32:35], v243, s[8:11], s52 offen offset:0 sc1
buffer_load_dwordx4 v[36:39], v243, s[8:11], s52 offen offset:256 sc1
buffer_load_dwordx4 v[40:43], v243, s[8:11], s52 offen offset:512 sc1
buffer_load_dwordx4 v[44:47], v243, s[8:11], s52 offen offset:768 sc1
buffer_load_dwordx4 v[48:51], v243, s[8:11], s52 offen offset:1024 sc1
buffer_load_dwordx4 v[52:55], v243, s[8:11], s52 offen offset:1280 sc1
buffer_load_dwordx4 v[56:59], v243, s[8:11], s52 offen offset:1536 sc1
buffer_load_dwordx4 v[60:63], v243, s[8:11], s52 offen offset:1792 sc1
buffer_load_dwordx4 v[64:67], v243, s[8:11], s52 offen offset:2048 sc1
buffer_load_dwordx4 v[244:247], v31, s[8:11], s51 offen offset:0 sc1
buffer_load_dwordx4 v[248:251], v31, s[8:11], s51 offen offset:512 sc1
s_barrier
ds_read_b128 v[224:227], v3 offset:0
ds_read_b128 v[228:231], v3 offset:1024
ds_read_b128 v[232:235], v3 offset:2048
ds_read_b128 v[236:239], v3 offset:3072
ds_read_b128 v[252:255], v3 offset:4096
s_add_u32 s82, s54, 4096
s_lshl_b32 s32, s3, 0
s_add_u32 s32, s32, s5
s_add_u32 s32, s32, s4
s_and_b32 s83, s32, 0
s_waitcnt vmcnt(10) lgkmcnt(4)
v_mfma_f32_32x32x16_bf16 v[160:175], v[224:227], v[32:35], 0
s_waitcnt lgkmcnt(3)
ds_read_b128 v[224:227], v3 offset:5120
buffer_load_dwordx4 v[68:71], v243, s[8:11], s52 offen offset:2304 sc1
v_mfma_f32_32x32x16_bf16 v[176:191], v[228:231], v[32:35], 0
s_waitcnt lgkmcnt(3)
ds_read_b128 v[228:231], v3 offset:6144
v_mfma_f32_32x32x16_bf16 v[192:207], v[232:235], v[32:35], 0
s_waitcnt vmcnt(10) lgkmcnt(3)
ds_read_b128 v[232:235], v3 offset:7168
buffer_load_dwordx4 v[72:75], v243, s[8:11], s52 offen offset:2560 sc1
v_mfma_f32_32x32x16_bf16 v[160:175], v[236:239], v[36:39], v[160:175]
s_waitcnt lgkmcnt(3)
ds_read_b128 v[236:239], v3 offset:8192
v_mfma_f32_32x32x16_bf16 v[176:191], v[252:255], v[36:39], v[176:191]
s_waitcnt lgkmcnt(3)
ds_read_b128 v[252:255], v3 offset:9216
v_mfma_f32_32x32x16_bf16 v[192:207], v[224:227], v[36:39], v[192:207]
s_waitcnt vmcnt(10) lgkmcnt(3)
ds_read_b128 v[224:227], v3 offset:10240
buffer_load_dwordx4 v[76:79], v243, s[8:11], s52 offen offset:2816 sc1
v_mfma_f32_32x32x16_bf16 v[160:175], v[228:231], v[40:43], v[160:175]
s_waitcnt lgkmcnt(3)
ds_read_b128 v[228:231], v3 offset:11264
v_mfma_f32_32x32x16_bf16 v[176:191], v[232:235], v[40:43], v[176:191]
s_waitcnt lgkmcnt(3)
ds_read_b128 v[232:235], v3 offset:12288
buffer_load_dwordx4 v[80:83], v243, s[8:11], s52 offen offset:3072 sc1
v_mfma_f32_32x32x16_bf16 v[192:207], v[236:239], v[40:43], v[192:207]
s_waitcnt vmcnt(11) lgkmcnt(3)
ds_read_b128 v[236:239], v3 offset:13312
v_mfma_f32_32x32x16_bf16 v[160:175], v[252:255], v[44:47], v[160:175]
s_waitcnt lgkmcnt(3)
ds_read_b128 v[252:255], v3 offset:14336
s_add_u32 m0, s60, 98304
s_add_u32 s62, s61, 98304
buffer_load_dwordx4 v2, s[8:11], s62 offen offset:0  lds
v_mfma_f32_32x32x16_bf16 v[176:191], v[224:227], v[44:47], v[176:191]
s_waitcnt lgkmcnt(3)
ds_read_b128 v[224:227], v3 offset:15360
buffer_load_dwordx4 v[84:87], v243, s[8:11], s52 offen offset:3328 sc1
v_mfma_f32_32x32x16_bf16 v[192:207], v[228:231], v[44:47], v[192:207]
s_waitcnt vmcnt(12) lgkmcnt(3)
ds_read_b128 v[228:231], v3 offset:16384
v_mfma_f32_32x32x16_bf16 v[160:175], v[232:235], v[48:51], v[160:175]
s_waitcnt lgkmcnt(3)
ds_read_b128 v[232:235], v3 offset:17408
v_mfma_f32_32x32x16_bf16 v[176:191], v[236:239], v[48:51], v[176:191]
s_waitcnt lgkmcnt(3)
ds_read_b128 v[236:239], v3 offset:18432
buffer_load_dwordx4 v[88:91], v243, s[8:11], s52 offen offset:3584 sc1
v_mfma_f32_32x32x16_bf16 v[192:207], v[252:255], v[48:51], v[192:207]
s_waitcnt vmcnt(12) lgkmcnt(3)
ds_read_b128 v[252:255], v3 offset:19456
v_mfma_f32_32x32x16_bf16 v[160:175], v[224:227], v[52:55], v[160:175]
s_waitcnt lgkmcnt(3)
ds_read_b128 v[224:227], v3 offset:20480
buffer_load_dwordx4 v[92:95], v243, s[8:11], s52 offen offset:3840 sc1
buffer_load_dwordx4 v2, s[8:11], s62 offen offset:1024  lds
v_mfma_f32_32x32x16_bf16 v[176:191], v[228:231], v[52:55], v[176:191]
s_waitcnt lgkmcnt(3)
ds_read_b128 v[228:231], v3 offset:21504
v_mfma_f32_32x32x16_bf16 v[192:207], v[232:235], v[52:55], v[192:207]
s_waitcnt vmcnt(13) lgkmcnt(3)
ds_read_b128 v[232:235], v3 offset:22528
v_mfma_f32_32x32x16_bf16 v[160:175], v[236:239], v[56:59], v[160:175]
s_waitcnt lgkmcnt(3)
ds_read_b128 v[236:239], v3 offset:23552
buffer_load_dwordx4 v[96:99], v243, s[8:11], s53 offen offset:0 sc1
v_mfma_f32_32x32x16_bf16 v[176:191], v[252:255], v[56:59], v[176:191]
s_waitcnt lgkmcnt(3)
ds_read_b128 v[252:255], v3 offset:24576
v_mfma_f32_32x32x16_bf16 v[192:207], v[224:227], v[56:59], v[192:207]
s_waitcnt vmcnt(13) lgkmcnt(3)
ds_read_b128 v[224:227], v3 offset:25600
buffer_load_dwordx4 v[100:103], v243, s[8:11], s53 offen offset:256 sc1
v_mfma_f32_32x32x16_bf16 v[160:175], v[228:231], v[60:63], v[160:175]
s_waitcnt lgkmcnt(3)
ds_read_b128 v[228:231], v3 offset:26624
buffer_load_dwordx4 v2, s[8:11], s62 offen offset:2048  lds
v_mfma_f32_32x32x16_bf16 v[176:191], v[232:235], v[60:63], v[176:191]
s_waitcnt lgkmcnt(3)
ds_read_b128 v[232:235], v3 offset:27648
v_mfma_f32_32x32x16_bf16 v[192:207], v[236:239], v[60:63], v[192:207]
s_waitcnt vmcnt(14) lgkmcnt(3)
ds_read_b128 v[236:239], v3 offset:28672
buffer_load_dwordx4 v[104:107], v243, s[8:11], s53 offen offset:512 sc1
v_mfma_f32_32x32x16_bf16 v[160:175], v[252:255], v[64:67], v[160:175]
s_waitcnt lgkmcnt(3)
ds_read_b128 v[252:255], v3 offset:29696
v_mfma_f32_32x32x16_bf16 v[176:191], v[224:227], v[64:67], v[176:191]
s_waitcnt lgkmcnt(3)
ds_read_b128 v[224:227], v3 offset:30720
v_mfma_f32_32x32x16_bf16 v[192:207], v[228:231], v[64:67], v[192:207]
s_waitcnt vmcnt(12) lgkmcnt(3)
ds_read_b128 v[228:231], v3 offset:31744
buffer_load_dwordx4 v[108:111], v243, s[8:11], s53 offen offset:768 sc1
buffer_load_dwordx4 v2, s[8:11], s62 offen offset:3072  lds
v_mfma_f32_32x32x16_bf16 v[160:175], v[232:235], v[68:71], v[160:175]
s_waitcnt lgkmcnt(3)
ds_read_b128 v[232:235], v3 offset:32768
v_add_f32 v244, v244, v246
v_add_f32 v245, v245, v247
v_add_f32 v248, v248, v250
v_mfma_f32_32x32x16_bf16 v[176:191], v[236:239], v[68:71], v[176:191]
s_waitcnt lgkmcnt(3)
ds_read_b128 v[236:239], v3 offset:33792
buffer_load_dwordx4 v[112:115], v243, s[8:11], s53 offen offset:1024 sc1
v_add_f32 v249, v249, v251
v_add_f32 v244, v244, v248
v_add_f32 v245, v245, v249
v_mfma_f32_32x32x16_bf16 v[192:207], v[252:255], v[68:71], v[192:207]
s_waitcnt vmcnt(14) lgkmcnt(3)
ds_read_b128 v[252:255], v3 offset:34816
v_permlane32_swap_b32 v244, v245
v_add_f32 v244, v244, v245
v_mov_b32 v245, v244
v_mfma_f32_32x32x16_bf16 v[160:175], v[224:227], v[72:75], v[160:175]
s_waitcnt lgkmcnt(3)
ds_read_b128 v[224:227], v3 offset:35840
v_permlane32_swap_b32 v244, v245
v_mul_f32 v244, 0xbb000000, v244
v_mul_f32 v245, 0x3b000000, v245
v_mfma_f32_32x32x16_bf16 v[176:191], v[228:231], v[72:75], v[176:191]
s_waitcnt lgkmcnt(3)
ds_read_b128 v[228:231], v3 offset:36864
buffer_load_dwordx4 v[116:119], v243, s[8:11], s53 offen offset:1280 sc1
v_fma_f32 v245, -v244, v244, v245
v_max_f32 v245, 0, v245
v_add_f32 v245, 0x3727c5ac, v245
v_mfma_f32_32x32x16_bf16 v[192:207], v[232:235], v[72:75], v[192:207]
s_waitcnt vmcnt(14) lgkmcnt(3)
ds_read_b128 v[232:235], v3 offset:37888
s_add_u32 m0, s60, 114688
s_add_u32 s62, s61, 114688
buffer_load_dwordx4 v2, s[8:11], s62 offen offset:0  lds
v_mov_b32_e64 v7, v245
v_rsq_f32 v6, v245
v_mfma_f32_32x32x16_bf16 v[160:175], v[236:239], v[76:79], v[160:175]
s_waitcnt lgkmcnt(3)
ds_read_b128 v[236:239], v3 offset:38912
buffer_load_dwordx4 v[120:123], v243, s[8:11], s53 offen offset:1536 sc1
v_cvt_pk_bf16_f32 v28, v244, v244
v_mul_f32 v6, 0xbfb8aa3b, v6
v_and_b32 v245, 0xffff0000, v28
v_mfma_f32_32x32x16_bf16 v[176:191], v[252:255], v[76:79], v[176:191]
s_waitcnt lgkmcnt(3)
ds_read_b128 v[252:255], v3 offset:39936
v_sub_f32 v245, v244, v245
v_mov_b32_e64 v30, 0
v_cvt_pk_bf16_f32 v29, v245, v30
v_mov_b32_e64 v31, 0
v_mfma_f32_32x32x16_bf16 v[192:207], v[224:227], v[76:79], v[192:207]
s_waitcnt vmcnt(15) lgkmcnt(3)
ds_read_b128 v[224:227], v3 offset:40960
v_mfma_f32_32x32x16_bf16 v[160:175], v[228:231], v[80:83], v[160:175]
s_waitcnt lgkmcnt(3)
ds_read_b128 v[228:231], v3 offset:41984
buffer_load_dwordx4 v[124:127], v243, s[8:11], s53 offen offset:1792 sc1
v_mfma_f32_32x32x16_bf16 v[176:191], v[232:235], v[80:83], v[176:191]
s_waitcnt lgkmcnt(3)
ds_read_b128 v[232:235], v3 offset:43008
v_mfma_f32_32x32x16_bf16 v[192:207], v[236:239], v[80:83], v[192:207]
s_waitcnt vmcnt(14) lgkmcnt(3)
ds_read_b128 v[236:239], v3 offset:44032
buffer_load_dwordx4 v2, s[8:11], s62 offen offset:1024  lds
v_mfma_f32_32x32x16_bf16 v[160:175], v[252:255], v[84:87], v[160:175]
s_waitcnt lgkmcnt(3)
ds_read_b128 v[252:255], v3 offset:45056
buffer_load_dwordx4 v[128:131], v243, s[8:11], s53 offen offset:2048 sc1
v_mfma_f32_32x32x16_bf16 v[176:191], v[224:227], v[84:87], v[176:191]
s_waitcnt lgkmcnt(3)
ds_read_b128 v[224:227], v3 offset:46080
v_mfma_f32_32x32x16_bf16 v[192:207], v[228:231], v[84:87], v[192:207]
s_waitcnt vmcnt(15) lgkmcnt(3)
ds_read_b128 v[228:231], v3 offset:47104
buffer_load_dwordx4 v[132:135], v243, s[8:11], s53 offen offset:2304 sc1
v_mfma_f32_32x32x16_bf16 v[160:175], v[232:235], v[88:91], v[160:175]
s_waitcnt lgkmcnt(3)
ds_read_b128 v[232:235], v3 offset:48128
v_mfma_f32_32x32x16_bf16 v[176:191], v[236:239], v[88:91], v[176:191]
s_waitcnt lgkmcnt(3)
s_barrier
ds_read_b128 v[236:239], v3 offset:49152
buffer_load_dwordx4 v2, s[8:11], s62 offen offset:2048  lds
v_mfma_f32_32x32x16_bf16 v[192:207], v[252:255], v[88:91], v[192:207]
s_waitcnt vmcnt(16) lgkmcnt(3)
ds_read_b128 v[252:255], v3 offset:50176
buffer_load_dwordx4 v[136:139], v243, s[8:11], s53 offen offset:2560 sc1
v_mfma_f32_32x32x16_bf16 v[160:175], v[224:227], v[92:95], v[160:175]
s_waitcnt lgkmcnt(3)
ds_read_b128 v[224:227], v3 offset:51200
v_mfma_f32_32x32x16_bf16 v[176:191], v[228:231], v[92:95], v[176:191]
s_waitcnt lgkmcnt(3)
ds_read_b128 v[228:231], v3 offset:52224
buffer_load_dwordx4 v[140:143], v243, s[8:11], s53 offen offset:2816 sc1
v_mfma_f32_32x32x16_bf16 v[192:207], v[232:235], v[92:95], v[192:207]
s_waitcnt vmcnt(16) lgkmcnt(3)
ds_read_b128 v[232:235], v3 offset:53248
v_mfma_f32_32x32x16_bf16 v[160:175], v[236:239], v[96:99], v[160:175]
s_waitcnt lgkmcnt(3)
ds_read_b128 v[236:239], v3 offset:54272
v_mfma_f32_32x32x16_bf16 v[176:191], v[252:255], v[96:99], v[176:191]
s_waitcnt lgkmcnt(3)
ds_read_b128 v[252:255], v3 offset:55296
buffer_load_dwordx4 v[144:147], v243, s[8:11], s53 offen offset:3072 sc1
buffer_load_dwordx4 v2, s[8:11], s62 offen offset:3072  lds
v_mfma_f32_32x32x16_bf16 v[192:207], v[224:227], v[96:99], v[192:207]
s_waitcnt vmcnt(17) lgkmcnt(3)
ds_read_b128 v[224:227], v3 offset:56320
v_mfma_f32_32x32x16_bf16 v[160:175], v[228:231], v[100:103], v[160:175]
s_waitcnt lgkmcnt(3)
ds_read_b128 v[228:231], v3 offset:57344
v_mfma_f32_32x32x16_bf16 v[176:191], v[232:235], v[100:103], v[176:191]
s_waitcnt lgkmcnt(3)
ds_read_b128 v[232:235], v3 offset:58368
buffer_load_dwordx4 v[148:151], v243, s[8:11], s53 offen offset:3328 sc1
v_mfma_f32_32x32x16_bf16 v[192:207], v[236:239], v[100:103], v[192:207]
s_waitcnt vmcnt(16) lgkmcnt(3)
ds_read_b128 v[236:239], v3 offset:59392
v_mfma_f32_32x32x16_bf16 v[160:175], v[252:255], v[104:107], v[160:175]
s_waitcnt lgkmcnt(3)
ds_read_b128 v[252:255], v3 offset:60416
buffer_load_dwordx4 v[152:155], v243, s[8:11], s53 offen offset:3584 sc1
v_mfma_f32_32x32x16_bf16 v[176:191], v[224:227], v[104:107], v[176:191]
s_waitcnt lgkmcnt(3)
ds_read_b128 v[224:227], v3 offset:61440
s_add_u32 m0, s60, 131072
s_add_u32 s62, s61, 131072
buffer_load_dwordx4 v2, s[8:11], s62 offen offset:0  lds
v_mfma_f32_32x32x16_bf16 v[192:207], v[228:231], v[104:107], v[192:207]
s_waitcnt vmcnt(17) lgkmcnt(3)
ds_read_b128 v[228:231], v3 offset:62464
v_mfma_f32_32x32x16_bf16 v[160:175], v[232:235], v[108:111], v[160:175]
s_waitcnt lgkmcnt(3)
ds_read_b128 v[232:235], v3 offset:63488
buffer_load_dwordx4 v[156:159], v243, s[8:11], s53 offen offset:3840 sc1
v_mfma_f32_32x32x16_bf16 v[176:191], v[236:239], v[108:111], v[176:191]
s_waitcnt lgkmcnt(3)
ds_read_b128 v[236:239], v3 offset:64512
v_mfma_f32_32x32x16_bf16 v[192:207], v[252:255], v[108:111], v[192:207]
s_waitcnt vmcnt(16) lgkmcnt(3)
ds_read_b128 v[252:255], v4 offset:0
v_mfma_f32_32x32x16_bf16 v[160:175], v[224:227], v[112:115], v[160:175]
s_waitcnt lgkmcnt(3)
ds_read_b128 v[224:227], v4 offset:1024
v_mfma_f32_32x32x16_bf16 v[176:191], v[228:231], v[112:115], v[176:191]
s_waitcnt lgkmcnt(3)
ds_read_b128 v[228:231], v4 offset:2048
buffer_load_dwordx4 v2, s[8:11], s62 offen offset:1024  lds
v_mfma_f32_32x32x16_bf16 v[192:207], v[232:235], v[112:115], v[192:207]
s_waitcnt vmcnt(16) lgkmcnt(3)
ds_read_b128 v[232:235], v4 offset:3072
v_mfma_f32_32x32x16_bf16 v[160:175], v[236:239], v[116:119], v[160:175]
s_waitcnt lgkmcnt(3)
ds_read_b128 v[236:239], v4 offset:4096
v_mfma_f32_32x32x16_bf16 v[176:191], v[252:255], v[116:119], v[176:191]
s_waitcnt lgkmcnt(3)
ds_read_b128 v[252:255], v4 offset:5120
buffer_load_dwordx4 v2, s[8:11], s62 offen offset:2048  lds
v_mfma_f32_32x32x16_bf16 v[192:207], v[224:227], v[116:119], v[192:207]
s_waitcnt vmcnt(15) lgkmcnt(3)
ds_read_b128 v[224:227], v4 offset:6144
v_mfma_f32_32x32x16_bf16 v[160:175], v[228:231], v[120:123], v[160:175]
s_waitcnt lgkmcnt(3)
ds_read_b128 v[228:231], v4 offset:7168
v_mfma_f32_32x32x16_bf16 v[176:191], v[232:235], v[120:123], v[176:191]
s_waitcnt lgkmcnt(3)
ds_read_b128 v[232:235], v4 offset:8192
buffer_load_dwordx4 v2, s[8:11], s62 offen offset:3072  lds
v_mfma_f32_32x32x16_bf16 v[192:207], v[236:239], v[120:123], v[192:207]
s_waitcnt vmcnt(15) lgkmcnt(3)
ds_read_b128 v[236:239], v4 offset:9216
v_mfma_f32_32x32x16_bf16 v[160:175], v[252:255], v[124:127], v[160:175]
s_waitcnt lgkmcnt(3)
ds_read_b128 v[252:255], v4 offset:10240
v_mfma_f32_32x32x16_bf16 v[176:191], v[224:227], v[124:127], v[176:191]
s_waitcnt lgkmcnt(3)
ds_read_b128 v[224:227], v4 offset:11264
s_add_u32 m0, s60, 147456
s_add_u32 s62, s61, 147456
buffer_load_dwordx4 v2, s[8:11], s62 offen offset:0  lds
v_mfma_f32_32x32x16_bf16 v[192:207], v[228:231], v[124:127], v[192:207]
s_waitcnt vmcnt(14) lgkmcnt(3)
ds_read_b128 v[228:231], v4 offset:12288
v_mfma_f32_32x32x16_bf16 v[160:175], v[232:235], v[128:131], v[160:175]
s_waitcnt lgkmcnt(3)
ds_read_b128 v[232:235], v4 offset:13312
v_mfma_f32_32x32x16_bf16 v[176:191], v[236:239], v[128:131], v[176:191]
s_waitcnt lgkmcnt(3)
ds_read_b128 v[236:239], v4 offset:14336
s_add_u32 s63, s85, 16384
buffer_load_dwordx4 a[0:3], v2, s[8:11], s63 offen offset:0
v_mfma_f32_32x32x16_bf16 v[192:207], v[252:255], v[128:131], v[192:207]
s_waitcnt vmcnt(14) lgkmcnt(3)
ds_read_b128 v[252:255], v4 offset:15360
v_mfma_f32_32x32x16_bf16 v[160:175], v[224:227], v[132:135], v[160:175]
s_waitcnt lgkmcnt(3)
ds_read_b128 v[224:227], v4 offset:16384
buffer_load_dwordx4 v2, s[8:11], s62 offen offset:1024  lds
v_mfma_f32_32x32x16_bf16 v[176:191], v[228:231], v[132:135], v[176:191]
s_waitcnt lgkmcnt(3)
ds_read_b128 v[228:231], v4 offset:17408
v_mfma_f32_32x32x16_bf16 v[192:207], v[232:235], v[132:135], v[192:207]
s_waitcnt vmcnt(13) lgkmcnt(3)
ds_read_b128 v[232:235], v4 offset:18432
v_mfma_f32_32x32x16_bf16 v[160:175], v[236:239], v[136:139], v[160:175]
s_waitcnt lgkmcnt(3)
ds_read_b128 v[236:239], v4 offset:19456
buffer_load_dwordx4 a[4:7], v2, s[8:11], s63 offen offset:1024
v_mfma_f32_32x32x16_bf16 v[176:191], v[252:255], v[136:139], v[176:191]
s_waitcnt lgkmcnt(3)
ds_read_b128 v[252:255], v4 offset:20480
v_mfma_f32_32x32x16_bf16 v[192:207], v[224:227], v[136:139], v[192:207]
s_waitcnt vmcnt(13) lgkmcnt(3)
ds_read_b128 v[224:227], v4 offset:21504
buffer_load_dwordx4 v2, s[8:11], s62 offen offset:2048  lds
v_mfma_f32_32x32x16_bf16 v[160:175], v[228:231], v[140:143], v[160:175]
s_waitcnt lgkmcnt(3)
ds_read_b128 v[228:231], v4 offset:22528
v_mfma_f32_32x32x16_bf16 v[176:191], v[232:235], v[140:143], v[176:191]
s_waitcnt lgkmcnt(3)
ds_read_b128 v[232:235], v4 offset:23552
v_mfma_f32_32x32x16_bf16 v[192:207], v[236:239], v[140:143], v[192:207]
s_waitcnt vmcnt(13) lgkmcnt(3)
ds_read_b128 v[236:239], v4 offset:24576
buffer_load_dwordx4 a[8:11], v2, s[8:11], s63 offen offset:2048
v_mfma_f32_32x32x16_bf16 v[160:175], v[252:255], v[144:147], v[160:175]
s_waitcnt lgkmcnt(3)
ds_read_b128 v[252:255], v4 offset:25600
v_mfma_f32_32x32x16_bf16 v[176:191], v[224:227], v[144:147], v[176:191]
s_waitcnt lgkmcnt(3)
ds_read_b128 v[224:227], v4 offset:26624
buffer_load_dwordx4 v2, s[8:11], s62 offen offset:3072  lds
v_mfma_f32_32x32x16_bf16 v[192:207], v[228:231], v[144:147], v[192:207]
s_waitcnt vmcnt(13) lgkmcnt(3)
ds_read_b128 v[228:231], v4 offset:27648
v_mfma_f32_32x32x16_bf16 v[160:175], v[232:235], v[148:151], v[160:175]
s_waitcnt lgkmcnt(3)
ds_read_b128 v[232:235], v4 offset:28672
v_mfma_f32_32x32x16_bf16 v[176:191], v[236:239], v[148:151], v[176:191]
s_waitcnt lgkmcnt(3)
ds_read_b128 v[236:239], v4 offset:29696
buffer_load_dwordx4 a[12:15], v2, s[8:11], s63 offen offset:3072
v_mfma_f32_32x32x16_bf16 v[192:207], v[252:255], v[148:151], v[192:207]
s_waitcnt vmcnt(13) lgkmcnt(3)
ds_read_b128 v[252:255], v4 offset:30720
v_mfma_f32_32x32x16_bf16 v[160:175], v[224:227], v[152:155], v[160:175]
s_waitcnt lgkmcnt(3)
ds_read_b128 v[224:227], v4 offset:31744
s_add_u32 m0, s60, 0
s_add_u32 s62, s61, 163840
buffer_load_dwordx4 v2, s[8:11], s62 offen offset:0  lds
v_mfma_f32_32x32x16_bf16 v[176:191], v[228:231], v[152:155], v[176:191]
s_waitcnt lgkmcnt(3)
s_barrier
ds_read_b128 v[228:231], v4 offset:32768
v_mfma_f32_32x32x16_bf16 v[192:207], v[232:235], v[152:155], v[192:207]
s_waitcnt vmcnt(12) lgkmcnt(3)
ds_read_b128 v[232:235], v4 offset:33792
v_mfma_f32_32x32x16_bf16 v[160:175], v[236:239], v[156:159], v[160:175]
s_waitcnt lgkmcnt(3)
ds_read_b128 v[236:239], v4 offset:34816
s_add_u32 s63, s85, 20480
buffer_load_dwordx4 a[16:19], v2, s[8:11], s63 offen offset:0
v_mfma_f32_32x32x16_bf16 v[176:191], v[252:255], v[156:159], v[176:191]
s_waitcnt lgkmcnt(3)
ds_read_b128 v[252:255], v4 offset:35840
v_mfma_f32_32x32x16_bf16 v[192:207], v[224:227], v[156:159], v[192:207]
s_waitcnt lgkmcnt(3)
ds_read_b128 v[224:227], v4 offset:36864
buffer_load_dwordx4 v2, s[8:11], s62 offen offset:1024  lds
v_mfma_f32_32x32x16_bf16 v[160:175], v[228:231], v[28:31], v[160:175]
s_waitcnt lgkmcnt(3)
ds_read_b128 v[228:231], v4 offset:37888
v_mfma_f32_32x32x16_bf16 v[176:191], v[232:235], v[28:31], v[176:191]
s_waitcnt lgkmcnt(3)
ds_read_b128 v[232:235], v4 offset:38912
v_mfma_f32_32x32x16_bf16 v[192:207], v[236:239], v[28:31], v[192:207]
s_waitcnt lgkmcnt(3)
ds_read_b128 v[236:239], v4 offset:39936
buffer_load_dwordx4 a[20:23], v2, s[8:11], s63 offen offset:1024
v_mfma_f32_32x32x16_bf16 v[208:223], v[252:255], v[32:35], 0
s_waitcnt lgkmcnt(3)
ds_read_b128 v[252:255], v4 offset:40960
v_mul_f32 v244, v6, v160
v_mul_f32 v245, v6, v161
v_exp_f32 v244, v244
v_mfma_f32_32x32x16_bf16 v[208:223], v[224:227], v[36:39], v[208:223]
s_waitcnt lgkmcnt(3)
ds_read_b128 v[224:227], v4 offset:41984
buffer_load_dwordx4 v2, s[8:11], s62 offen offset:2048  lds
v_exp_f32 v245, v245
v_mul_f32 v246, v160, v168
v_mfma_f32_32x32x16_bf16 v[208:223], v[228:231], v[40:43], v[208:223]
s_waitcnt lgkmcnt(3)
ds_read_b128 v[228:231], v4 offset:43008
v_mul_f32 v247, v161, v169
v_fma_f32 v244, v244, v7, v7
v_fma_f32 v245, v245, v7, v7
v_mfma_f32_32x32x16_bf16 v[208:223], v[232:235], v[44:47], v[208:223]
s_waitcnt lgkmcnt(3)
ds_read_b128 v[232:235], v4 offset:44032
v_rcp_f32 v244, v244
v_rcp_f32 v245, v245
v_mfma_f32_32x32x16_bf16 v[208:223], v[236:239], v[48:51], v[208:223]
s_waitcnt lgkmcnt(3)
ds_read_b128 v[236:239], v4 offset:45056
buffer_load_dwordx4 a[24:27], v2, s[8:11], s63 offen offset:2048
v_mul_f32 v246, v246, v244
v_mul_f32 v247, v247, v245
v_cvt_pk_bf16_f32 v248, v246, v247
v_mfma_f32_32x32x16_bf16 v[208:223], v[252:255], v[52:55], v[208:223]
s_waitcnt lgkmcnt(3)
ds_read_b128 v[252:255], v4 offset:46080
v_mul_f32 v244, v6, v162
v_mul_f32_e64 v245, v6, v163
v_exp_f32 v244, v244
v_mfma_f32_32x32x16_bf16 v[208:223], v[224:227], v[56:59], v[208:223]
s_waitcnt lgkmcnt(3)
ds_read_b128 v[224:227], v4 offset:47104
buffer_load_dwordx4 v2, s[8:11], s62 offen offset:3072  lds
v_exp_f32 v245, v245
v_mul_f32 v246, v162, v170
v_mfma_f32_32x32x16_bf16 v[208:223], v[228:231], v[60:63], v[208:223]
s_waitcnt lgkmcnt(3)
ds_read_b128 v[228:231], v4 offset:48128
v_mul_f32 v247, v163, v171
v_fma_f32 v244, v244, v7, v7
v_fma_f32 v245, v245, v7, v7
v_mfma_f32_32x32x16_bf16 v[208:223], v[232:235], v[64:67], v[208:223]
s_waitcnt lgkmcnt(3)
ds_read_b128 v[232:235], v4 offset:49152
v_rcp_f32 v244, v244
v_rcp_f32 v245, v245
v_mfma_f32_32x32x16_bf16 v[208:223], v[236:239], v[68:71], v[208:223]
s_waitcnt lgkmcnt(3)
ds_read_b128 v[236:239], v4 offset:50176
buffer_load_dwordx4 a[28:31], v2, s[8:11], s63 offen offset:3072
v_mul_f32 v246, v246, v244
v_mul_f32 v247, v247, v245
v_cvt_pk_bf16_f32 v249, v246, v247
v_mfma_f32_32x32x16_bf16 v[208:223], v[252:255], v[72:75], v[208:223]
s_waitcnt lgkmcnt(3)
ds_read_b128 v[252:255], v4 offset:51200
v_mul_f32 v244, v6, v164
v_mul_f32_e64 v245, v6, v165
v_exp_f32 v244, v244
v_mfma_f32_32x32x16_bf16 v[208:223], v[224:227], v[76:79], v[208:223]
s_waitcnt lgkmcnt(3)
ds_read_b128 v[224:227], v4 offset:52224
s_add_u32 m0, s60, 16384
s_add_u32 s62, s61, 180224
buffer_load_dwordx4 v2, s[8:11], s62 offen offset:0  lds
v_exp_f32 v245, v245
v_mul_f32 v246, v164, v172
v_mfma_f32_32x32x16_bf16 v[208:223], v[228:231], v[80:83], v[208:223]
s_waitcnt lgkmcnt(3)
ds_read_b128 v[228:231], v4 offset:53248
v_mul_f32 v247, v165, v173
v_fma_f32 v244, v244, v7, v7
v_fma_f32 v245, v245, v7, v7
v_mfma_f32_32x32x16_bf16 v[208:223], v[232:235], v[84:87], v[208:223]
s_waitcnt lgkmcnt(3)
ds_read_b128 v[232:235], v4 offset:54272
v_rcp_f32 v244, v244
v_rcp_f32 v245, v245
v_mfma_f32_32x32x16_bf16 v[208:223], v[236:239], v[88:91], v[208:223]
s_waitcnt lgkmcnt(3)
ds_read_b128 v[236:239], v4 offset:55296
s_add_u32 s63, s85, 24576
buffer_load_dwordx4 a[32:35], v2, s[8:11], s63 offen offset:0
v_mul_f32 v246, v246, v244
v_mul_f32 v247, v247, v245
v_cvt_pk_bf16_f32 v250, v246, v247
v_mfma_f32_32x32x16_bf16 v[208:223], v[252:255], v[92:95], v[208:223]
s_waitcnt lgkmcnt(3)
ds_read_b128 v[252:255], v4 offset:56320
v_mul_f32 v244, v6, v166
v_mul_f32_e64 v245, v6, v167
v_exp_f32 v244, v244
v_mfma_f32_32x32x16_bf16 v[208:223], v[224:227], v[96:99], v[208:223]
s_waitcnt lgkmcnt(3)
ds_read_b128 v[224:227], v4 offset:57344
buffer_load_dwordx4 v2, s[8:11], s62 offen offset:1024  lds
v_exp_f32 v245, v245
v_mul_f32 v246, v166, v174
v_mfma_f32_32x32x16_bf16 v[208:223], v[228:231], v[100:103], v[208:223]
s_waitcnt lgkmcnt(3)
ds_read_b128 v[228:231], v4 offset:58368
v_mul_f32 v247, v167, v175
v_fma_f32 v244, v244, v7, v7
v_fma_f32 v245, v245, v7, v7
v_mfma_f32_32x32x16_bf16 v[208:223], v[232:235], v[104:107], v[208:223]
s_waitcnt lgkmcnt(3)
ds_read_b128 v[232:235], v4 offset:59392
v_rcp_f32 v244, v244
v_rcp_f32 v245, v245
v_mfma_f32_32x32x16_bf16 v[208:223], v[236:239], v[108:111], v[208:223]
s_waitcnt lgkmcnt(3)
ds_read_b128 v[236:239], v4 offset:60416
buffer_load_dwordx4 a[36:39], v2, s[8:11], s63 offen offset:1024
v_mul_f32 v246, v246, v244
v_mul_f32 v247, v247, v245
v_cvt_pk_bf16_f32 v251, v246, v247
v_mfma_f32_32x32x16_bf16 v[208:223], v[252:255], v[112:115], v[208:223]
s_waitcnt lgkmcnt(3)
ds_read_b128 v[252:255], v4 offset:61440
buffer_store_dwordx4 v[248:251], v2, s[8:11], s54 offen offset:0 sc1
v_mul_f32 v244, v6, v176
v_mul_f32 v245, v6, v177
v_mfma_f32_32x32x16_bf16 v[208:223], v[224:227], v[116:119], v[208:223]
s_waitcnt lgkmcnt(3)
ds_read_b128 v[224:227], v4 offset:62464
buffer_load_dwordx4 v2, s[8:11], s62 offen offset:2048  lds
v_exp_f32 v244, v244
v_mfma_f32_32x32x16_bf16 v[208:223], v[228:231], v[120:123], v[208:223]
s_waitcnt lgkmcnt(3)
ds_read_b128 v[228:231], v4 offset:63488
v_exp_f32 v245, v245
v_mul_f32 v246, v176, v184
v_mul_f32 v247, v177, v185
v_mfma_f32_32x32x16_bf16 v[208:223], v[232:235], v[124:127], v[208:223]
s_waitcnt lgkmcnt(3)
ds_read_b128 v[232:235], v4 offset:64512
v_fma_f32 v244, v244, v7, v7
v_fma_f32 v245, v245, v7, v7
v_rcp_f32 v244, v244
v_mfma_f32_32x32x16_bf16 v[208:223], v[236:239], v[128:131], v[208:223]
s_waitcnt lgkmcnt(3)
s_waitcnt vmcnt(15)
s_barrier
ds_read_b128 v[236:239], v5 offset:0
buffer_load_dwordx4 a[40:43], v2, s[8:11], s63 offen offset:2048
v_mfma_f32_32x32x16_bf16 v[208:223], v[252:255], v[132:135], v[208:223]
s_waitcnt lgkmcnt(3)
ds_read_b128 v[252:255], v5 offset:1024
v_rcp_f32 v245, v245
v_mfma_f32_32x32x16_bf16 v[208:223], v[224:227], v[136:139], v[208:223]
s_waitcnt lgkmcnt(3)
ds_read_b128 v[224:227], v5 offset:2048
buffer_load_dwordx4 v2, s[8:11], s62 offen offset:3072  lds
v_mul_f32 v246, v246, v244
v_mul_f32_e64 v247, v247, v245
v_cvt_pk_bf16_f32 v24, v246, v247
v_mfma_f32_32x32x16_bf16 v[208:223], v[228:231], v[140:143], v[208:223]
s_waitcnt lgkmcnt(3)
ds_read_b128 v[228:231], v5 offset:3072
v_mul_f32 v244, v6, v178
v_mul_f32 v245, v6, v179
v_exp_f32 v244, v244
v_mfma_f32_32x32x16_bf16 v[208:223], v[232:235], v[144:147], v[208:223]
s_waitcnt lgkmcnt(3)
ds_read_b128 v[232:235], v5 offset:4096
v_exp_f32 v245, v245
v_mul_f32_e64 v246, v178, v186
v_mul_f32 v247, v179, v187
v_mfma_f32_32x32x16_bf16 v[208:223], v[236:239], v[148:151], v[208:223]
s_waitcnt lgkmcnt(3)
ds_read_b128 v[236:239], v5 offset:5120
buffer_load_dwordx4 a[44:47], v2, s[8:11], s63 offen offset:3072
v_fma_f32 v244, v244, v7, v7
v_fma_f32 v245, v245, v7, v7
v_mfma_f32_32x32x16_bf16 v[208:223], v[252:255], v[152:155], v[208:223]
s_waitcnt lgkmcnt(3)
ds_read_b128 v[252:255], v5 offset:6144
v_rcp_f32 v244, v244
v_rcp_f32 v245, v245
v_mfma_f32_32x32x16_bf16 v[208:223], v[224:227], v[156:159], v[208:223]
s_waitcnt lgkmcnt(3)
ds_read_b128 v[224:227], v5 offset:7168
s_add_u32 m0, s60, 32768
s_add_u32 s62, s61, 196608
buffer_load_dwordx4 v2, s[8:11], s62 offen offset:0  lds
v_mul_f32 v246, v246, v244
v_mul_f32 v247, v247, v245
v_cvt_pk_bf16_f32 v25, v246, v247
v_mfma_f32_32x32x16_bf16 v[208:223], v[228:231], v[28:31], v[208:223]
s_waitcnt lgkmcnt(3)
ds_read_b128 v[228:231], v5 offset:8192
v_mul_f32 v244, v6, v180
v_mul_f32 v245, v6, v181
v_exp_f32 v244, v244
v_mfma_f32_32x32x16_bf16 v[160:175], v[232:235], v[32:35], 0
s_waitcnt lgkmcnt(3)
ds_read_b128 v[232:235], v5 offset:9216
v_exp_f32 v245, v245
v_mul_f32_e64 v246, v180, v188
v_mul_f32 v247, v181, v189
v_mfma_f32_32x32x16_bf16 v[160:175], v[236:239], v[36:39], v[160:175]
s_waitcnt lgkmcnt(3)
ds_read_b128 v[236:239], v5 offset:10240
s_add_u32 s63, s85, 28672
buffer_load_dwordx4 a[48:51], v2, s[8:11], s63 offen offset:0
v_fma_f32 v244, v244, v7, v7
v_fma_f32 v245, v245, v7, v7
v_mfma_f32_32x32x16_bf16 v[160:175], v[252:255], v[40:43], v[160:175]
s_waitcnt lgkmcnt(3)
ds_read_b128 v[252:255], v5 offset:11264
v_rcp_f32 v244, v244
v_rcp_f32 v245, v245
v_mfma_f32_32x32x16_bf16 v[160:175], v[224:227], v[44:47], v[160:175]
s_waitcnt lgkmcnt(3)
ds_read_b128 v[224:227], v5 offset:12288
buffer_load_dwordx4 v2, s[8:11], s62 offen offset:1024  lds
v_mul_f32 v246, v246, v244
v_mul_f32 v247, v247, v245
v_cvt_pk_bf16_f32 v26, v246, v247
v_mfma_f32_32x32x16_bf16 v[160:175], v[228:231], v[48:51], v[160:175]
s_waitcnt lgkmcnt(3)
ds_read_b128 v[228:231], v5 offset:13312
v_mul_f32 v244, v6, v182
v_mul_f32 v245, v6, v183
v_exp_f32 v244, v244
v_mfma_f32_32x32x16_bf16 v[160:175], v[232:235], v[52:55], v[160:175]
s_waitcnt lgkmcnt(3)
ds_read_b128 v[232:235], v5 offset:14336
v_exp_f32 v245, v245
v_mul_f32_e64 v246, v182, v190
v_mul_f32 v247, v183, v191
v_mfma_f32_32x32x16_bf16 v[160:175], v[236:239], v[56:59], v[160:175]
s_waitcnt lgkmcnt(3)
ds_read_b128 v[236:239], v5 offset:15360
buffer_load_dwordx4 a[52:55], v2, s[8:11], s63 offen offset:1024
v_fma_f32 v244, v244, v7, v7
v_fma_f32 v245, v245, v7, v7
v_mfma_f32_32x32x16_bf16 v[160:175], v[252:255], v[60:63], v[160:175]
s_waitcnt lgkmcnt(3)
ds_read_b128 v[252:255], v5 offset:16384
v_rcp_f32 v244, v244
v_rcp_f32 v245, v245
v_mfma_f32_32x32x16_bf16 v[160:175], v[224:227], v[64:67], v[160:175]
s_waitcnt lgkmcnt(3)
ds_read_b128 v[224:227], v5 offset:17408
buffer_load_dwordx4 v2, s[8:11], s62 offen offset:2048  lds
v_mul_f32 v246, v246, v244
v_mul_f32 v247, v247, v245
v_cvt_pk_bf16_f32 v27, v246, v247
v_mfma_f32_32x32x16_bf16 v[160:175], v[228:231], v[68:71], v[160:175]
s_waitcnt lgkmcnt(3)
ds_read_b128 v[228:231], v5 offset:18432
buffer_store_dwordx4 v[24:27], v2, s[8:11], s54 offen offset:1024 sc1
v_mul_f32 v244, v6, v192
v_mul_f32 v245, v6, v193
v_mfma_f32_32x32x16_bf16 v[160:175], v[232:235], v[72:75], v[160:175]
s_waitcnt lgkmcnt(3)
ds_read_b128 v[232:235], v5 offset:19456
v_exp_f32_e64 v244, v244
v_exp_f32 v245, v245
v_mfma_f32_32x32x16_bf16 v[160:175], v[236:239], v[76:79], v[160:175]
s_waitcnt lgkmcnt(3)
ds_read_b128 v[236:239], v5 offset:20480
buffer_load_dwordx4 a[56:59], v2, s[8:11], s63 offen offset:2048
v_mul_f32_e64 v246, v192, v200
v_mul_f32 v247, v193, v201
v_fma_f32 v244, v244, v7, v7
v_mfma_f32_32x32x16_bf16 v[160:175], v[252:255], v[80:83], v[160:175]
s_waitcnt lgkmcnt(3)
ds_read_b128 v[252:255], v5 offset:21504
v_fma_f32 v245, v245, v7, v7
v_rcp_f32 v244, v244
v_mfma_f32_32x32x16_bf16 v[160:175], v[224:227], v[84:87], v[160:175]
s_waitcnt lgkmcnt(3)
ds_read_b128 v[224:227], v5 offset:22528
buffer_load_dwordx4 v2, s[8:11], s62 offen offset:3072  lds
v_rcp_f32 v245, v245
v_mfma_f32_32x32x16_bf16 v[160:175], v[228:231], v[88:91], v[160:175]
s_waitcnt lgkmcnt(3)
ds_read_b128 v[228:231], v5 offset:23552
v_mul_f32 v246, v246, v244
v_mul_f32 v247, v247, v245
v_cvt_pk_bf16_f32 v248, v246, v247
v_mul_f32 v244, v6, v194
v_mfma_f32_32x32x16_bf16 v[160:175], v[232:235], v[92:95], v[160:175]
s_waitcnt lgkmcnt(3)
ds_read_b128 v[232:235], v5 offset:24576
v_mul_f32_e64 v245, v6, v195
v_exp_f32 v244, v244
v_mfma_f32_32x32x16_bf16 v[160:175], v[236:239], v[96:99], v[160:175]
s_waitcnt lgkmcnt(3)
ds_read_b128 v[236:239], v5 offset:25600
buffer_load_dwordx4 a[60:63], v2, s[8:11], s63 offen offset:3072
v_exp_f32_e64 v245, v245
v_mul_f32 v246, v194, v202
v_mfma_f32_32x32x16_bf16 v[160:175], v[252:255], v[100:103], v[160:175]
s_waitcnt lgkmcnt(3)
ds_read_b128 v[252:255], v5 offset:26624
v_mul_f32 v247, v195, v203
v_fma_f32 v244, v244, v7, v7
v_fma_f32 v245, v245, v7, v7
v_mfma_f32_32x32x16_bf16 v[160:175], v[224:227], v[104:107], v[160:175]
s_waitcnt lgkmcnt(3)
ds_read_b128 v[224:227], v5 offset:27648
s_add_u32 m0, s60, 49152
s_add_u32 s62, s61, 212992
buffer_load_dwordx4 v2, s[8:11], s62 offen offset:0  lds
v_rcp_f32 v244, v244
v_mfma_f32_32x32x16_bf16 v[160:175], v[228:231], v[108:111], v[160:175]
s_waitcnt lgkmcnt(3)
ds_read_b128 v[228:231], v5 offset:28672
v_rcp_f32 v245, v245
v_mfma_f32_32x32x16_bf16 v[160:175], v[232:235], v[112:115], v[160:175]
s_waitcnt lgkmcnt(3)
ds_read_b128 v[232:235], v5 offset:29696
v_mul_f32 v246, v246, v244
v_mul_f32 v247, v247, v245
v_cvt_pk_bf16_f32 v249, v246, v247
v_mul_f32 v244, v6, v196
v_mfma_f32_32x32x16_bf16 v[160:175], v[236:239], v[116:119], v[160:175]
s_waitcnt lgkmcnt(3)
ds_read_b128 v[236:239], v5 offset:30720
s_add_u32 s63, s85, 32768
buffer_load_dwordx4 a[64:67], v2, s[8:11], s63 offen offset:0
v_mul_f32 v245, v6, v197
v_exp_f32 v244, v244
v_mfma_f32_32x32x16_bf16 v[160:175], v[252:255], v[120:123], v[160:175]
s_waitcnt lgkmcnt(3)
ds_read_b128 v[252:255], v5 offset:31744
v_exp_f32 v245, v245
v_mul_f32 v246, v196, v204
v_mul_f32 v247, v197, v205
v_mfma_f32_32x32x16_bf16 v[160:175], v[224:227], v[124:127], v[160:175]
s_waitcnt lgkmcnt(3)
s_waitcnt vmcnt(12)
s_barrier
ds_read_b128 v[224:227], v3 offset:0
buffer_load_dwordx4 v2, s[8:11], s62 offen offset:1024  lds
v_fma_f32 v244, v244, v7, v7
v_mfma_f32_32x32x16_bf16 v[160:175], v[228:231], v[128:131], v[160:175]
s_waitcnt lgkmcnt(3)
ds_read_b128 v[228:231], v3 offset:1024
v_fma_f32 v245, v245, v7, v7
v_rcp_f32 v244, v244
v_mfma_f32_32x32x16_bf16 v[160:175], v[232:235], v[132:135], v[160:175]
s_waitcnt lgkmcnt(3)
ds_read_b128 v[232:235], v3 offset:2048
v_rcp_f32 v245, v245
v_mfma_f32_32x32x16_bf16 v[160:175], v[236:239], v[136:139], v[160:175]
s_waitcnt lgkmcnt(3)
ds_read_b128 v[236:239], v3 offset:3072
buffer_load_dwordx4 a[68:71], v2, s[8:11], s63 offen offset:1024
v_mul_f32 v246, v246, v244
v_mul_f32 v247, v247, v245
v_cvt_pk_bf16_f32 v250, v246, v247
v_mfma_f32_32x32x16_bf16 v[160:175], v[252:255], v[140:143], v[160:175]
s_waitcnt lgkmcnt(3)
ds_read_b128 v[252:255], v3 offset:4096
v_mul_f32 v244, v6, v198
v_mul_f32_e64 v245, v6, v199
v_exp_f32 v244, v244
v_mfma_f32_32x32x16_bf16 v[160:175], v[224:227], v[144:147], v[160:175]
s_waitcnt lgkmcnt(3)
ds_read_b128 v[224:227], v3 offset:5120
buffer_load_dwordx4 v2, s[8:11], s62 offen offset:2048  lds
v_exp_f32 v245, v245
v_mul_f32 v246, v198, v206
v_mfma_f32_32x32x16_bf16 v[160:175], v[228:231], v[148:151], v[160:175]
s_waitcnt lgkmcnt(3)
ds_read_b128 v[228:231], v3 offset:6144
v_mul_f32 v247, v199, v207
v_fma_f32 v244, v244, v7, v7
v_fma_f32 v245, v245, v7, v7
v_mfma_f32_32x32x16_bf16 v[160:175], v[232:235], v[152:155], v[160:175]
s_waitcnt lgkmcnt(3)
ds_read_b128 v[232:235], v3 offset:7168
v_rcp_f32 v244, v244
v_rcp_f32 v245, v245
v_mfma_f32_32x32x16_bf16 v[160:175], v[236:239], v[156:159], v[160:175]
s_waitcnt lgkmcnt(3)
ds_read_b128 v[236:239], v3 offset:8192
buffer_load_dwordx4 a[72:75], v2, s[8:11], s63 offen offset:2048
v_mul_f32 v246, v246, v244
v_mul_f32 v247, v247, v245
v_cvt_pk_bf16_f32 v251, v246, v247
v_mfma_f32_32x32x16_bf16 v[160:175], v[252:255], v[28:31], v[160:175]
s_waitcnt lgkmcnt(3)
ds_read_b128 v[252:255], v3 offset:9216
buffer_store_dwordx4 v[248:251], v2, s[8:11], s54 offen offset:2048 sc1
v_mul_f32 v244, v6, v208
v_mul_f32 v245, v6, v209
v_mfma_f32_32x32x16_bf16 v[176:191], v[224:227], v[32:35], 0
s_waitcnt lgkmcnt(3)
ds_read_b128 v[224:227], v3 offset:10240
buffer_load_dwordx4 v2, s[8:11], s62 offen offset:3072  lds
v_exp_f32 v244, v244
v_mfma_f32_32x32x16_bf16 v[176:191], v[228:231], v[36:39], v[176:191]
s_waitcnt lgkmcnt(3)
ds_read_b128 v[228:231], v3 offset:11264
v_exp_f32 v245, v245
v_mul_f32 v246, v208, v216
v_mul_f32 v247, v209, v217
v_mfma_f32_32x32x16_bf16 v[176:191], v[232:235], v[40:43], v[176:191]
s_waitcnt lgkmcnt(3)
ds_read_b128 v[232:235], v3 offset:12288
v_fma_f32 v244, v244, v7, v7
v_fma_f32 v245, v245, v7, v7
v_rcp_f32 v244, v244
v_mfma_f32_32x32x16_bf16 v[176:191], v[236:239], v[44:47], v[176:191]
s_waitcnt lgkmcnt(3)
ds_read_b128 v[236:239], v3 offset:13312
buffer_load_dwordx4 a[76:79], v2, s[8:11], s63 offen offset:3072
v_rcp_f32 v245, v245
v_mfma_f32_32x32x16_bf16 v[176:191], v[252:255], v[48:51], v[176:191]
s_waitcnt lgkmcnt(3)
ds_read_b128 v[252:255], v3 offset:14336
v_mul_f32 v246, v246, v244
v_mul_f32 v247, v247, v245
v_cvt_pk_bf16_f32 v24, v246, v247
v_mul_f32 v244, v6, v210
v_mfma_f32_32x32x16_bf16 v[176:191], v[224:227], v[52:55], v[176:191]
s_waitcnt lgkmcnt(3)
ds_read_b128 v[224:227], v3 offset:15360
s_add_u32 m0, s60, 65536
s_add_u32 s62, s61, 229376
s_cmp_ge_u32 s3, 2
s_cselect_b32 s62, 0x40000000, s62
buffer_load_dwordx4 v2, s[8:11], s62 offen offset:0  lds
v_mul_f32 v245, v6, v211
v_exp_f32 v244, v244
v_mfma_f32_32x32x16_bf16 v[176:191], v[228:231], v[56:59], v[176:191]
s_waitcnt lgkmcnt(3)
ds_read_b128 v[228:231], v3 offset:16384
v_exp_f32 v245, v245
v_mul_f32_e64 v246, v210, v218
v_mul_f32 v247, v211, v219
v_mfma_f32_32x32x16_bf16 v[176:191], v[232:235], v[60:63], v[176:191]
s_waitcnt lgkmcnt(3)
ds_read_b128 v[232:235], v3 offset:17408
v_fma_f32 v244, v244, v7, v7
v_fma_f32 v245, v245, v7, v7
v_rcp_f32 v244, v244
v_mfma_f32_32x32x16_bf16 v[176:191], v[236:239], v[64:67], v[176:191]
s_waitcnt lgkmcnt(3)
ds_read_b128 v[236:239], v3 offset:18432
s_add_u32 s63, s85, 36864
buffer_load_dwordx4 a[80:83], v2, s[8:11], s63 offen offset:0
v_rcp_f32 v245, v245
v_mfma_f32_32x32x16_bf16 v[176:191], v[252:255], v[68:71], v[176:191]
s_waitcnt lgkmcnt(3)
ds_read_b128 v[252:255], v3 offset:19456
v_mul_f32 v246, v246, v244
v_mul_f32 v247, v247, v245
v_cvt_pk_bf16_f32 v25, v246, v247
v_mul_f32 v244, v6, v212
v_mfma_f32_32x32x16_bf16 v[176:191], v[224:227], v[72:75], v[176:191]
s_waitcnt lgkmcnt(3)
ds_read_b128 v[224:227], v3 offset:20480
buffer_load_dwordx4 v2, s[8:11], s62 offen offset:1024  lds
v_mul_f32 v245, v6, v213
v_exp_f32 v244, v244
v_mfma_f32_32x32x16_bf16 v[176:191], v[228:231], v[76:79], v[176:191]
s_waitcnt lgkmcnt(3)
ds_read_b128 v[228:231], v3 offset:21504
v_exp_f32 v245, v245
v_mul_f32_e64 v246, v212, v220
v_mul_f32 v247, v213, v221
v_mfma_f32_32x32x16_bf16 v[176:191], v[232:235], v[80:83], v[176:191]
s_waitcnt lgkmcnt(3)
ds_read_b128 v[232:235], v3 offset:22528
v_fma_f32 v244, v244, v7, v7
v_fma_f32 v245, v245, v7, v7
v_rcp_f32 v244, v244
v_mfma_f32_32x32x16_bf16 v[176:191], v[236:239], v[84:87], v[176:191]
s_waitcnt lgkmcnt(3)
ds_read_b128 v[236:239], v3 offset:23552
buffer_load_dwordx4 a[84:87], v2, s[8:11], s63 offen offset:1024
v_rcp_f32 v245, v245
v_mfma_f32_32x32x16_bf16 v[176:191], v[252:255], v[88:91], v[176:191]
s_waitcnt lgkmcnt(3)
ds_read_b128 v[252:255], v3 offset:24576
v_mul_f32 v246, v246, v244
v_mul_f32 v247, v247, v245
v_cvt_pk_bf16_f32 v26, v246, v247
v_mul_f32 v244, v6, v214
v_mfma_f32_32x32x16_bf16 v[176:191], v[224:227], v[92:95], v[176:191]
s_waitcnt lgkmcnt(3)
ds_read_b128 v[224:227], v3 offset:25600
buffer_load_dwordx4 v2, s[8:11], s62 offen offset:2048  lds
v_mul_f32 v245, v6, v215
v_exp_f32 v244, v244
v_mfma_f32_32x32x16_bf16 v[176:191], v[228:231], v[96:99], v[176:191]
s_waitcnt lgkmcnt(3)
ds_read_b128 v[228:231], v3 offset:26624
v_exp_f32 v245, v245
v_mul_f32_e64 v246, v214, v222
v_mul_f32 v247, v215, v223
v_mfma_f32_32x32x16_bf16 v[176:191], v[232:235], v[100:103], v[176:191]
s_waitcnt lgkmcnt(3)
ds_read_b128 v[232:235], v3 offset:27648
v_fma_f32 v244, v244, v7, v7
v_fma_f32 v245, v245, v7, v7
v_rcp_f32 v244, v244
v_mfma_f32_32x32x16_bf16 v[176:191], v[236:239], v[104:107], v[176:191]
s_waitcnt lgkmcnt(3)
ds_read_b128 v[236:239], v3 offset:28672
buffer_load_dwordx4 a[88:91], v2, s[8:11], s63 offen offset:2048
v_rcp_f32 v245, v245
v_mfma_f32_32x32x16_bf16 v[176:191], v[252:255], v[108:111], v[176:191]
s_waitcnt lgkmcnt(3)
ds_read_b128 v[252:255], v3 offset:29696
v_mul_f32_e64 v246, v246, v244
v_mul_f32 v247, v247, v245
v_cvt_pk_bf16_f32 v27, v246, v247
v_mfma_f32_32x32x16_bf16 v[176:191], v[224:227], v[112:115], v[176:191]
s_waitcnt lgkmcnt(3)
ds_read_b128 v[224:227], v3 offset:30720
buffer_load_dwordx4 v2, s[8:11], s62 offen offset:3072  lds
buffer_store_dwordx4 v[24:27], v2, s[8:11], s54 offen offset:3072 sc1
v_mul_f32 v244, v6, v160
v_mfma_f32_32x32x16_bf16 v[176:191], v[228:231], v[116:119], v[176:191]
s_waitcnt lgkmcnt(3)
ds_read_b128 v[228:231], v3 offset:31744
v_mul_f32_e64 v245, v6, v161
v_exp_f32 v244, v244
v_mfma_f32_32x32x16_bf16 v[176:191], v[232:235], v[120:123], v[176:191]
s_waitcnt lgkmcnt(3)
s_waitcnt vmcnt(9)
s_barrier
ds_read_b128 v[232:235], v3 offset:32768
v_exp_f32 v245, v245
v_mfma_f32_32x32x16_bf16 v[176:191], v[236:239], v[124:127], v[176:191]
s_waitcnt lgkmcnt(3)
ds_read_b128 v[236:239], v3 offset:33792
buffer_load_dwordx4 a[92:95], v2, s[8:11], s63 offen offset:3072
v_mul_f32_e64 v246, v160, v168
v_mul_f32 v247, v161, v169
v_fma_f32 v244, v244, v7, v7
v_mfma_f32_32x32x16_bf16 v[176:191], v[252:255], v[128:131], v[176:191]
s_waitcnt lgkmcnt(3)
ds_read_b128 v[252:255], v3 offset:34816
v_fma_f32 v245, v245, v7, v7
v_rcp_f32 v244, v244
v_mfma_f32_32x32x16_bf16 v[176:191], v[224:227], v[132:135], v[176:191]
s_waitcnt lgkmcnt(3)
ds_read_b128 v[224:227], v3 offset:35840
s_add_u32 s63, s85, 40960
buffer_load_dwordx4 a[96:99], v2, s[8:11], s63 offen offset:0
v_rcp_f32 v245, v245
v_mfma_f32_32x32x16_bf16 v[176:191], v[228:231], v[136:139], v[176:191]
s_waitcnt lgkmcnt(3)
ds_read_b128 v[228:231], v3 offset:36864
v_mul_f32 v246, v246, v244
v_mul_f32 v247, v247, v245
v_cvt_pk_bf16_f32 v248, v246, v247
v_mul_f32 v244, v6, v162
v_mfma_f32_32x32x16_bf16 v[176:191], v[232:235], v[140:143], v[176:191]
s_waitcnt lgkmcnt(3)
ds_read_b128 v[232:235], v3 offset:37888
buffer_load_dwordx4 a[100:103], v2, s[8:11], s63 offen offset:1024
v_mul_f32 v245, v6, v163
v_exp_f32 v244, v244
v_mfma_f32_32x32x16_bf16 v[176:191], v[236:239], v[144:147], v[176:191]
s_waitcnt lgkmcnt(3)
ds_read_b128 v[236:239], v3 offset:38912
v_exp_f32 v245, v245
v_mul_f32_e64 v246, v162, v170
v_mul_f32 v247, v163, v171
v_mfma_f32_32x32x16_bf16 v[176:191], v[252:255], v[148:151], v[176:191]
s_waitcnt lgkmcnt(3)
ds_read_b128 v[252:255], v3 offset:39936
buffer_load_dwordx4 a[104:107], v2, s[8:11], s63 offen offset:2048
v_fma_f32 v244, v244, v7, v7
v_fma_f32 v245, v245, v7, v7
v_mfma_f32_32x32x16_bf16 v[176:191], v[224:227], v[152:155], v[176:191]
s_waitcnt lgkmcnt(3)
ds_read_b128 v[224:227], v3 offset:40960
s_waitcnt vmcnt(4)
v_mov_b32 v8, 1
s_or_b32 s99, s87, s68
buffer_store_dword v8, v9, s[8:11], s99 offen
s_or_b32 s99, s87, s69
buffer_store_dword v8, v9, s[8:11], s99 offen sc1
v_mfma_f32_32x32x16_bf16 v[176:191], v[228:231], v[156:159], v[176:191]
s_waitcnt lgkmcnt(3)
ds_read_b128 v[228:231], v3 offset:41984
buffer_load_dwordx4 a[108:111], v2, s[8:11], s63 offen offset:3072
v_rcp_f32 v244, v244
v_mfma_f32_32x32x16_bf16 v[176:191], v[232:235], v[28:31], v[176:191]
s_waitcnt lgkmcnt(3)
ds_read_b128 v[232:235], v3 offset:43008
v_rcp_f32 v245, v245
v_mfma_f32_32x32x16_bf16 v[192:207], v[236:239], v[32:35], 0
s_waitcnt lgkmcnt(3)
ds_read_b128 v[236:239], v3 offset:44032
s_add_u32 s63, s85, 45056
buffer_load_dwordx4 a[112:115], v2, s[8:11], s63 offen offset:0
v_mul_f32 v246, v246, v244
v_mul_f32 v247, v247, v245
v_cvt_pk_bf16_f32 v249, v246, v247
v_mfma_f32_32x32x16_bf16 v[192:207], v[252:255], v[36:39], v[192:207]
s_waitcnt lgkmcnt(3)
ds_read_b128 v[252:255], v3 offset:45056
v_mul_f32 v244, v6, v164
v_mul_f32_e64 v245, v6, v165
v_exp_f32 v244, v244
v_mfma_f32_32x32x16_bf16 v[192:207], v[224:227], v[40:43], v[192:207]
s_waitcnt lgkmcnt(3)
ds_read_b128 v[224:227], v3 offset:46080
buffer_load_dwordx4 a[116:119], v2, s[8:11], s63 offen offset:1024
v_exp_f32 v245, v245
v_mul_f32 v246, v164, v172
v_mfma_f32_32x32x16_bf16 v[192:207], v[228:231], v[44:47], v[192:207]
s_waitcnt lgkmcnt(3)
ds_read_b128 v[228:231], v3 offset:47104
v_mul_f32 v247, v165, v173
v_fma_f32 v244, v244, v7, v7
v_fma_f32 v245, v245, v7, v7
v_mfma_f32_32x32x16_bf16 v[192:207], v[232:235], v[48:51], v[192:207]
s_waitcnt lgkmcnt(3)
ds_read_b128 v[232:235], v3 offset:48128
buffer_load_dwordx4 a[120:123], v2, s[8:11], s63 offen offset:2048
v_rcp_f32 v244, v244
v_mfma_f32_32x32x16_bf16 v[192:207], v[236:239], v[52:55], v[192:207]
s_waitcnt lgkmcnt(3)
ds_read_b128 v[236:239], v3 offset:49152
v_rcp_f32 v245, v245
v_mfma_f32_32x32x16_bf16 v[192:207], v[252:255], v[56:59], v[192:207]
s_waitcnt lgkmcnt(3)
ds_read_b128 v[252:255], v3 offset:50176
buffer_load_dwordx4 a[124:127], v2, s[8:11], s63 offen offset:3072
v_mul_f32 v246, v246, v244
v_mul_f32_e64 v247, v247, v245
v_cvt_pk_bf16_f32 v250, v246, v247
v_mfma_f32_32x32x16_bf16 v[192:207], v[224:227], v[60:63], v[192:207]
s_waitcnt lgkmcnt(3)
ds_read_b128 v[224:227], v3 offset:51200
v_mul_f32 v244, v6, v166
v_mul_f32_e64 v245, v6, v167
v_exp_f32 v244, v244
v_mfma_f32_32x32x16_bf16 v[192:207], v[228:231], v[64:67], v[192:207]
s_waitcnt lgkmcnt(3)
ds_read_b128 v[228:231], v3 offset:52224
s_add_u32 s63, s85, 49152
buffer_load_dwordx4 a[128:131], v2, s[8:11], s63 offen offset:0
v_exp_f32 v245, v245
v_mul_f32 v246, v166, v174
v_mfma_f32_32x32x16_bf16 v[192:207], v[232:235], v[68:71], v[192:207]
s_waitcnt lgkmcnt(3)
ds_read_b128 v[232:235], v3 offset:53248
v_mul_f32 v247, v167, v175
v_fma_f32 v244, v244, v7, v7
v_fma_f32 v245, v245, v7, v7
v_mfma_f32_32x32x16_bf16 v[192:207], v[236:239], v[72:75], v[192:207]
s_waitcnt lgkmcnt(3)
ds_read_b128 v[236:239], v3 offset:54272
buffer_load_dwordx4 a[132:135], v2, s[8:11], s63 offen offset:1024
v_rcp_f32 v244, v244
v_mfma_f32_32x32x16_bf16 v[192:207], v[252:255], v[76:79], v[192:207]
s_waitcnt lgkmcnt(3)
ds_read_b128 v[252:255], v3 offset:55296
v_rcp_f32 v245, v245
v_mfma_f32_32x32x16_bf16 v[192:207], v[224:227], v[80:83], v[192:207]
s_waitcnt lgkmcnt(3)
ds_read_b128 v[224:227], v3 offset:56320
buffer_load_dwordx4 a[136:139], v2, s[8:11], s63 offen offset:2048
v_mul_f32 v246, v246, v244
v_mul_f32 v247, v247, v245
v_cvt_pk_bf16_f32 v251, v246, v247
v_mfma_f32_32x32x16_bf16 v[192:207], v[228:231], v[84:87], v[192:207]
s_waitcnt lgkmcnt(3)
ds_read_b128 v[228:231], v3 offset:57344
buffer_store_dwordx4 v[248:251], v2, s[8:11], s82 offen offset:0 sc1
v_mul_f32_e64 v244, v6, v176
v_mul_f32 v245, v6, v177
v_mfma_f32_32x32x16_bf16 v[192:207], v[232:235], v[88:91], v[192:207]
s_waitcnt lgkmcnt(3)
ds_read_b128 v[232:235], v3 offset:58368
buffer_load_dwordx4 a[140:143], v2, s[8:11], s63 offen offset:3072
v_exp_f32 v244, v244
v_mfma_f32_32x32x16_bf16 v[192:207], v[236:239], v[92:95], v[192:207]
s_waitcnt lgkmcnt(3)
ds_read_b128 v[236:239], v3 offset:59392
v_exp_f32 v245, v245
v_mul_f32 v246, v176, v184
v_mul_f32 v247, v177, v185
v_mfma_f32_32x32x16_bf16 v[192:207], v[252:255], v[96:99], v[192:207]
s_waitcnt lgkmcnt(3)
ds_read_b128 v[252:255], v3 offset:60416
s_add_u32 s63, s85, 53248
buffer_load_dwordx4 a[144:147], v2, s[8:11], s63 offen offset:0
v_fma_f32 v244, v244, v7, v7
v_fma_f32 v245, v245, v7, v7
v_mfma_f32_32x32x16_bf16 v[192:207], v[224:227], v[100:103], v[192:207]
s_waitcnt lgkmcnt(3)
ds_read_b128 v[224:227], v3 offset:61440
v_rcp_f32 v244, v244
v_rcp_f32 v245, v245
v_mfma_f32_32x32x16_bf16 v[192:207], v[228:231], v[104:107], v[192:207]
s_waitcnt lgkmcnt(3)
ds_read_b128 v[228:231], v3 offset:62464
buffer_load_dwordx4 a[148:151], v2, s[8:11], s63 offen offset:1024
v_mul_f32 v246, v246, v244
v_mul_f32 v247, v247, v245
v_cvt_pk_bf16_f32 v24, v246, v247
v_mfma_f32_32x32x16_bf16 v[192:207], v[232:235], v[108:111], v[192:207]
s_waitcnt lgkmcnt(3)
ds_read_b128 v[232:235], v3 offset:63488
v_mul_f32 v244, v6, v178
v_mul_f32_e64 v245, v6, v179
v_exp_f32 v244, v244
v_mfma_f32_32x32x16_bf16 v[192:207], v[236:239], v[112:115], v[192:207]
s_waitcnt lgkmcnt(3)
ds_read_b128 v[236:239], v3 offset:64512
buffer_load_dwordx4 a[152:155], v2, s[8:11], s63 offen offset:2048
v_exp_f32 v245, v245
v_mul_f32 v246, v178, v186
v_mfma_f32_32x32x16_bf16 v[192:207], v[252:255], v[116:119], v[192:207]
s_waitcnt lgkmcnt(3)
s_barrier
ds_read_b128 v[252:255], v4 offset:0
v_mul_f32 v247, v179, v187
v_fma_f32 v244, v244, v7, v7
v_mfma_f32_32x32x16_bf16 v[192:207], v[224:227], v[120:123], v[192:207]
s_waitcnt lgkmcnt(3)
ds_read_b128 v[224:227], v4 offset:1024
buffer_load_dwordx4 a[156:159], v2, s[8:11], s63 offen offset:3072
v_fma_f32 v245, v245, v7, v7
v_rcp_f32 v244, v244
v_mfma_f32_32x32x16_bf16 v[192:207], v[228:231], v[124:127], v[192:207]
s_waitcnt lgkmcnt(3)
ds_read_b128 v[228:231], v4 offset:2048
v_rcp_f32 v245, v245
v_mfma_f32_32x32x16_bf16 v[192:207], v[232:235], v[128:131], v[192:207]
s_waitcnt lgkmcnt(3)
ds_read_b128 v[232:235], v4 offset:3072
v_mul_f32 v246, v246, v244
v_mul_f32 v247, v247, v245
v_cvt_pk_bf16_f32 v25, v246, v247
v_mul_f32 v244, v6, v180
v_mfma_f32_32x32x16_bf16 v[192:207], v[236:239], v[132:135], v[192:207]
s_waitcnt lgkmcnt(3)
ds_read_b128 v[236:239], v4 offset:4096
v_mul_f32 v245, v6, v181
v_exp_f32 v244, v244
v_mfma_f32_32x32x16_bf16 v[192:207], v[252:255], v[136:139], v[192:207]
s_waitcnt lgkmcnt(3)
ds_read_b128 v[252:255], v4 offset:5120
v_exp_f32 v245, v245
v_mul_f32_e64 v246, v180, v188
v_mul_f32 v247, v181, v189
v_mfma_f32_32x32x16_bf16 v[192:207], v[224:227], v[140:143], v[192:207]
s_waitcnt lgkmcnt(3)
ds_read_b128 v[224:227], v4 offset:6144
v_fma_f32 v244, v244, v7, v7
v_fma_f32 v245, v245, v7, v7
v_rcp_f32_e64 v244, v244
v_mfma_f32_32x32x16_bf16 v[192:207], v[228:231], v[144:147], v[192:207]
s_waitcnt lgkmcnt(3)
v_rcp_f32 v245, v245
v_mfma_f32_32x32x16_bf16 v[192:207], v[232:235], v[148:151], v[192:207]
s_waitcnt lgkmcnt(2)
v_mul_f32 v246, v246, v244
v_mul_f32_e64 v247, v247, v245
v_cvt_pk_bf16_f32 v26, v246, v247
v_mul_f32 v244, v6, v182
v_mul_f32 v245, v6, v183
v_mfma_f32_32x32x16_bf16 v[192:207], v[236:239], v[152:155], v[192:207]
s_waitcnt lgkmcnt(1)
v_cmp_gt_u32 vcc, 8, v1
v_lshlrev_b32_e64 v240, 2, v1
v_mov_b32 v10, 0x80000000
v_cndmask_b32 v240, v10, v240, vcc
s_lshl_b32 s32, s6, 7
s_lshl_b32 s33, s3, 5
s_add_u32 s32, s32, s33
s_add_u32 s86, s32, 24576
buffer_load_dword v10, v240, s[8:11], s86 offen sc1
v_mfma_f32_32x32x16_bf16 v[192:207], v[252:255], v[156:159], v[192:207]
s_waitcnt lgkmcnt(0)
v_exp_f32 v244, v244
v_exp_f32 v245, v245
v_mul_f32 v246, v182, v190
v_mfma_f32_32x32x16_bf16 v[192:207], v[224:227], v[28:31], v[192:207]
v_mul_f32_e64 v247, v183, v191
v_fma_f32 v244, v244, v7, v7
v_fma_f32 v245, v245, v7, v7
v_rcp_f32 v244, v244
v_rcp_f32 v245, v245
v_mul_f32 v246, v246, v244
v_mul_f32 v247, v247, v245
v_cvt_pk_bf16_f32 v27, v246, v247
buffer_store_dwordx4 v[24:27], v2, s[8:11], s82 offen offset:1024 sc1
s_nop 2
v_mul_f32 v244, v6, v192
v_mul_f32 v245, v6, v193
v_exp_f32 v244, v244
v_exp_f32 v245, v245
v_mul_f32 v246, v192, v200
v_mul_f32_e64 v247, v193, v201
v_fma_f32 v244, v244, v7, v7
v_fma_f32 v245, v245, v7, v7
v_rcp_f32 v244, v244
v_rcp_f32 v245, v245
v_mul_f32 v246, v246, v244
v_mul_f32 v247, v247, v245
v_cvt_pk_bf16_f32 v248, v246, v247
v_mul_f32 v244, v6, v194
v_mul_f32 v245, v6, v195
v_exp_f32 v244, v244
v_exp_f32 v245, v245
v_mul_f32 v246, v194, v202
v_mul_f32 v247, v195, v203
v_fma_f32 v244, v244, v7, v7
v_fma_f32 v245, v245, v7, v7
v_rcp_f32 v244, v244
v_rcp_f32 v245, v245
v_mul_f32 v246, v246, v244
v_mul_f32 v247, v247, v245
v_cvt_pk_bf16_f32 v249, v246, v247
v_mul_f32 v244, v6, v196
v_mul_f32 v245, v6, v197
v_exp_f32 v244, v244
v_exp_f32 v245, v245
v_mul_f32 v246, v196, v204
v_mul_f32 v247, v197, v205
v_fma_f32 v244, v244, v7, v7
v_fma_f32 v245, v245, v7, v7
v_rcp_f32 v244, v244
v_rcp_f32 v245, v245
v_mul_f32 v246, v246, v244
v_mul_f32 v247, v247, v245
v_cvt_pk_bf16_f32 v250, v246, v247
v_mul_f32 v244, v6, v198
v_mul_f32 v245, v6, v199
v_exp_f32 v244, v244
v_exp_f32 v245, v245
v_mul_f32 v246, v198, v206
v_mul_f32 v247, v199, v207
v_fma_f32 v244, v244, v7, v7
v_fma_f32 v245, v245, v7, v7
v_rcp_f32 v244, v244
v_rcp_f32 v245, v245
v_mul_f32 v246, v246, v244
v_mul_f32 v247, v247, v245
v_cvt_pk_bf16_f32 v251, v246, v247
buffer_store_dwordx4 v[248:251], v2, s[8:11], s82 offen offset:2048 sc1
v_mov_b32_e64 v115, v240
s_waitcnt vmcnt(2)
v_cmp_gt_u32 vcc, 1, v10
s_nop 0
s_and_b32 s99, vcc_lo, 0xff
s_cbranch_scc1 L_spin25
L_back25:
s_mul_i32 s32, s6, 229376
s_mul_i32 s33, s3, 28672
s_add_u32 s32, s32, s33
s_add_u32 s59, s32, 17694720
s_add_u32 s32, s7, 0
s_and_b32 s32, s32, 0
s_mul_i32 s32, s32, 7168
s_add_u32 s34, s59, s32
s_add_u32 s34, s34, 0
s_add_u32 s32, s7, 1
s_and_b32 s32, s32, 0
s_mul_i32 s32, s32, 7168
s_add_u32 s35, s59, s32
s_add_u32 s35, s35, 7168
s_add_u32 s32, s7, 2
s_and_b32 s32, s32, 0
s_mul_i32 s32, s32, 7168
s_add_u32 s36, s59, s32
s_add_u32 s36, s36, 14336
s_add_u32 s32, s7, 3
s_and_b32 s32, s32, 0
s_mul_i32 s32, s32, 7168
s_add_u32 s37, s59, s32
s_add_u32 s37, s37, 21504
s_add_u32 s58, s34, 114688
buffer_load_dwordx4 v[64:67], v2, s[8:11], s58 offen offset:0 sc1
buffer_load_dwordx4 v[68:71], v2, s[8:11], s58 offen offset:1024 sc1
buffer_load_dwordx4 v[72:75], v2, s[8:11], s58 offen offset:2048 sc1
buffer_load_dwordx4 v[76:79], v2, s[8:11], s58 offen offset:3072 sc1
s_add_u32 s58, s35, 114688
buffer_load_dwordx4 v[80:83], v2, s[8:11], s58 offen offset:0 sc1
buffer_load_dwordx4 v[84:87], v2, s[8:11], s58 offen offset:1024 sc1
s_add_u32 s32, s60, 49152
v_add_u32_e64 v3, s32, v2
v_xor_b32 v4, 128, v3
v_and_b32_e64 v28, 7, v1
v_lshrrev_b32 v29, 3, v1
s_lshl_b32 s32, s3, 7
v_lshl_add_u32 v30, v28, 4, s32
v_bfe_u32 v31, v1, 4, 1
v_lshlrev_b32 v5, 7, v31
v_xor_b32 v30, v30, v5
v_bfe_u32 v5, v1, 3, 2
v_lshl_add_u32 v30, v5, 10, v30
v_lshrrev_b32_e64 v5, 5, v1
v_mul_u32_u24 v5, 16384, v5
v_add_u32_e64 v30, v30, v5
v_add_u32 v5, 49152, v30
v_lshlrev_b32_e64 v30, 4, v28
v_lshl_add_u32 v30, v31, 2, v30
v_and_b32 v31, 0x28, v1
v_cmp_eq_u32 vcc, 0, v31
v_mov_b32 v31, 0x80000000
s_nop 0
v_cndmask_b32 v6, v31, v30, vcc
v_lshlrev_b32_e64 v30, 10, v28
v_lshl_add_u32 v7, v29, 4, v30
v_add_u32_e64 v112, s60, v2
v_add_u32 v113, 0x10000, v112
v_add_u32 v114, 0x20000, v112
s_waitcnt vmcnt(6)
v_mov_b32 v8, 2
s_or_b32 s99, s87, s68
buffer_store_dword v8, v9, s[8:11], s99 offen
s_or_b32 s99, s87, s69
buffer_store_dword v8, v9, s[8:11], s99 offen sc1
buffer_load_dwordx4 v[88:91], v2, s[8:11], s58 offen offset:2048 sc1
buffer_load_dwordx4 v[92:95], v2, s[8:11], s58 offen offset:3072 sc1
s_add_u32 s58, s36, 114688
buffer_load_dwordx4 v[96:99], v2, s[8:11], s58 offen offset:0 sc1
buffer_load_dwordx4 v[100:103], v2, s[8:11], s58 offen offset:1024 sc1
buffer_load_dwordx4 v[104:107], v2, s[8:11], s58 offen offset:2048 sc1
buffer_load_dwordx4 v[108:111], v2, s[8:11], s58 offen offset:3072 sc1
s_add_u32 s87, s89, 12288
s_waitcnt vmcnt(13)
v_mfma_f32_32x32x16_bf16 v[128:143], a[192:195], v[64:67], 0
v_mfma_f32_32x32x16_bf16 v[144:159], a[196:199], v[64:67], 0
s_waitcnt vmcnt(12)
s_add_u32 s58, s37, 114688
buffer_load_dwordx4 v[64:67], v2, s[8:11], s58 offen offset:0 sc1
buffer_load_dword v10, v115, s[8:11], s86 offen sc1
v_mfma_f32_32x32x16_bf16 v[128:143], a[200:203], v[68:71], v[128:143]
v_mfma_f32_32x32x16_bf16 v[144:159], a[204:207], v[68:71], v[144:159]
s_waitcnt vmcnt(13)
buffer_load_dwordx4 v[68:71], v2, s[8:11], s58 offen offset:1024 sc1
v_mfma_f32_32x32x16_bf16 v[128:143], a[208:211], v[72:75], v[128:143]
v_mfma_f32_32x32x16_bf16 v[144:159], a[212:215], v[72:75], v[144:159]
s_waitcnt vmcnt(13)
buffer_load_dwordx4 v[72:75], v2, s[8:11], s58 offen offset:2048 sc1
v_mfma_f32_32x32x16_bf16 v[128:143], a[216:219], v[76:79], v[128:143]
v_mfma_f32_32x32x16_bf16 v[144:159], a[220:223], v[76:79], v[144:159]
s_waitcnt vmcnt(13)
buffer_load_dwordx4 v[76:79], v2, s[8:11], s58 offen offset:3072 sc1
v_mfma_f32_32x32x16_bf16 v[128:143], a[224:227], v[80:83], v[128:143]
v_mfma_f32_32x32x16_bf16 v[144:159], a[228:231], v[80:83], v[144:159]
s_waitcnt vmcnt(13)
v_mfma_f32_32x32x16_bf16 v[128:143], a[232:235], v[84:87], v[128:143]
v_mfma_f32_32x32x16_bf16 v[144:159], a[236:239], v[84:87], v[144:159]
s_waitcnt vmcnt(10)
v_mfma_f32_32x32x16_bf16 v[128:143], a[240:243], v[88:91], v[128:143]
v_mfma_f32_32x32x16_bf16 v[144:159], a[244:247], v[88:91], v[144:159]
s_waitcnt vmcnt(9)
v_mfma_f32_32x32x16_bf16 v[128:143], a[248:251], v[92:95], v[128:143]
v_mfma_f32_32x32x16_bf16 v[144:159], a[252:255], v[92:95], v[144:159]
s_waitcnt vmcnt(8)
v_mfma_f32_32x32x16_bf16 v[128:143], a[0:3], v[96:99], v[128:143]
v_mfma_f32_32x32x16_bf16 v[144:159], a[4:7], v[96:99], v[144:159]
s_waitcnt vmcnt(7)
v_mfma_f32_32x32x16_bf16 v[128:143], a[8:11], v[100:103], v[128:143]
v_mfma_f32_32x32x16_bf16 v[144:159], a[12:15], v[100:103], v[144:159]
s_waitcnt vmcnt(6)
s_waitcnt vmcnt(3)
v_cmp_gt_u32 vcc, 2, v10
s_nop 0
s_and_b32 s99, vcc_lo, 0xff
s_cbranch_scc1 L_spin26
L_back26:
s_add_u32 s58, s34, 118784
buffer_load_dwordx4 v[80:83], v2, s[8:11], s58 offen offset:0 sc1
buffer_load_dwordx4 v[84:87], v2, s[8:11], s58 offen offset:1024 sc1
v_mfma_f32_32x32x16_bf16 v[128:143], a[16:19], v[104:107], v[128:143]
s_barrier
v_mfma_f32_32x32x16_bf16 v[144:159], a[20:23], v[104:107], v[144:159]
buffer_load_dwordx4 v[88:91], v2, s[8:11], s58 offen offset:2048 sc1
s_add_u32 s58, s35, 118784
buffer_load_dwordx4 v[92:95], v2, s[8:11], s58 offen offset:0 sc1
v_mfma_f32_32x32x16_bf16 v[128:143], a[24:27], v[108:111], v[128:143]
v_mfma_f32_32x32x16_bf16 v[144:159], a[28:31], v[108:111], v[144:159]
buffer_load_dwordx4 v[96:99], v2, s[8:11], s58 offen offset:1024 sc1
buffer_load_dwordx4 v[100:103], v2, s[8:11], s58 offen offset:2048 sc1
v_mfma_f32_32x32x16_bf16 v[128:143], a[32:35], v[64:67], v[128:143]
v_mfma_f32_32x32x16_bf16 v[144:159], a[36:39], v[64:67], v[144:159]
s_waitcnt vmcnt(8)
s_add_u32 s58, s36, 118784
buffer_load_dwordx4 v[104:107], v2, s[8:11], s58 offen offset:0 sc1
buffer_load_dwordx4 v[108:111], v2, s[8:11], s58 offen offset:1024 sc1
v_mfma_f32_32x32x16_bf16 v[128:143], a[40:43], v[68:71], v[128:143]
v_mfma_f32_32x32x16_bf16 v[144:159], a[44:47], v[68:71], v[144:159]
s_waitcnt vmcnt(9)
buffer_load_dwordx4 v[64:67], v2, s[8:11], s58 offen offset:2048 sc1
s_add_u32 s58, s37, 118784
buffer_load_dwordx4 v[68:71], v2, s[8:11], s58 offen offset:0 sc1
v_mfma_f32_32x32x16_bf16 v[128:143], a[48:51], v[72:75], v[128:143]
v_mfma_f32_32x32x16_bf16 v[144:159], a[52:55], v[72:75], v[144:159]
s_waitcnt vmcnt(10)
buffer_load_dwordx4 v[72:75], v2, s[8:11], s58 offen offset:1024 sc1
v_mfma_f32_32x32x16_bf16 v[128:143], a[56:59], v[76:79], v[128:143]
v_mfma_f32_32x32x16_bf16 v[144:159], a[60:63], v[76:79], v[144:159]
s_waitcnt vmcnt(10)
buffer_load_dwordx4 v[76:79], v2, s[8:11], s58 offen offset:2048 sc1
v_mfma_f32_32x32x16_bf16 v[128:143], a[64:67], v[80:83], v[128:143]
v_mfma_f32_32x32x16_bf16 v[144:159], a[68:71], v[80:83], v[144:159]
s_waitcnt vmcnt(10)
s_add_u32 s58, s34, 0
buffer_load_dwordx4 v[80:83], v2, s[8:11], s58 offen offset:0 sc1
v_mfma_f32_32x32x16_bf16 v[128:143], a[72:75], v[84:87], v[128:143]
v_mfma_f32_32x32x16_bf16 v[144:159], a[76:79], v[84:87], v[144:159]
s_waitcnt vmcnt(10)
buffer_load_dwordx4 v[84:87], v2, s[8:11], s58 offen offset:1024 sc1
v_mfma_f32_32x32x16_bf16 v[128:143], a[80:83], v[88:91], v[128:143]
v_mfma_f32_32x32x16_bf16 v[144:159], a[84:87], v[88:91], v[144:159]
s_waitcnt vmcnt(10)
buffer_load_dwordx4 v[88:91], v2, s[8:11], s58 offen offset:2048 sc1
v_mfma_f32_32x32x16_bf16 v[128:143], a[88:91], v[92:95], v[128:143]
v_mfma_f32_32x32x16_bf16 v[144:159], a[92:95], v[92:95], v[144:159]
s_waitcnt vmcnt(10)
buffer_load_dwordx4 v[92:95], v2, s[8:11], s58 offen offset:3072 sc1
v_mfma_f32_32x32x16_bf16 v[128:143], a[96:99], v[96:99], v[128:143]
s_add_u32 s32, s55, 11403264
buffer_load_dwordx4 v[20:23], v2, s[8:11], s32 offen sc1
v_mfma_f32_32x32x16_bf16 v[144:159], a[100:103], v[96:99], v[144:159]
s_waitcnt vmcnt(11)
s_add_u32 s58, s35, 0
buffer_load_dwordx4 v[96:99], v2, s[8:11], s58 offen offset:0 sc1
v_mfma_f32_32x32x16_bf16 v[128:143], a[104:107], v[100:103], v[128:143]
v_mfma_f32_32x32x16_bf16 v[144:159], a[108:111], v[100:103], v[144:159]
s_waitcnt vmcnt(11)
buffer_load_dwordx4 v[100:103], v2, s[8:11], s58 offen offset:1024 sc1
v_mfma_f32_32x32x16_bf16 v[128:143], a[112:115], v[104:107], v[128:143]
s_add_u32 s32, s55, 11436032
buffer_load_dwordx4 v[24:27], v2, s[8:11], s32 offen sc1
v_mfma_f32_32x32x16_bf16 v[144:159], a[116:119], v[104:107], v[144:159]
s_waitcnt vmcnt(12)
buffer_load_dwordx4 v[104:107], v2, s[8:11], s58 offen offset:2048 sc1
v_mfma_f32_32x32x16_bf16 v[128:143], a[120:123], v[108:111], v[128:143]
v_mfma_f32_32x32x16_bf16 v[144:159], a[124:127], v[108:111], v[144:159]
s_waitcnt vmcnt(12)
buffer_load_dwordx4 v[108:111], v2, s[8:11], s58 offen offset:3072 sc1
v_mfma_f32_32x32x16_bf16 v[128:143], a[128:131], v[64:67], v[128:143]
v_mfma_f32_32x32x16_bf16 v[144:159], a[132:135], v[64:67], v[144:159]
s_waitcnt vmcnt(12)
s_add_u32 s58, s36, 0
buffer_load_dwordx4 v[64:67], v2, s[8:11], s58 offen offset:0 sc1
v_mfma_f32_32x32x16_bf16 v[128:143], a[136:139], v[68:71], v[128:143]
v_mfma_f32_32x32x16_bf16 v[144:159], a[140:143], v[68:71], v[144:159]
s_waitcnt vmcnt(12)
buffer_load_dwordx4 v[68:71], v2, s[8:11], s58 offen offset:1024 sc1
v_mfma_f32_32x32x16_bf16 v[128:143], a[144:147], v[72:75], v[128:143]
v_mfma_f32_32x32x16_bf16 v[144:159], a[148:151], v[72:75], v[144:159]
s_waitcnt vmcnt(12)
buffer_load_dwordx4 v[72:75], v2, s[8:11], s58 offen offset:2048 sc1
v_mfma_f32_32x32x16_bf16 v[128:143], a[152:155], v[76:79], v[128:143]
v_mfma_f32_32x32x16_bf16 v[144:159], a[156:159], v[76:79], v[144:159]
s_waitcnt vmcnt(12)
buffer_load_dwordx4 v[76:79], v2, s[8:11], s58 offen offset:3072 sc1
v_mfma_f32_32x32x16_bf16 v[160:175], a[192:195], v[80:83], 0
v_mfma_f32_32x32x16_bf16 v[176:191], a[196:199], v[80:83], 0
s_waitcnt vmcnt(12)
s_add_u32 s58, s37, 0
buffer_load_dwordx4 v[80:83], v2, s[8:11], s58 offen offset:0 sc1
v_mfma_f32_32x32x16_bf16 v[160:175], a[200:203], v[84:87], v[160:175]
s_nop 2
ds_write_b128 v3, v[128:131] offset:0
v_mfma_f32_32x32x16_bf16 v[176:191], a[204:207], v[84:87], v[176:191]
s_waitcnt vmcnt(12)
buffer_load_dwordx4 v[84:87], v2, s[8:11], s58 offen offset:1024 sc1
v_mfma_f32_32x32x16_bf16 v[160:175], a[208:211], v[88:91], v[160:175]
ds_write_b128 v3, v[132:135] offset:1024
v_mfma_f32_32x32x16_bf16 v[176:191], a[212:215], v[88:91], v[176:191]
s_waitcnt vmcnt(12)
buffer_load_dwordx4 v[88:91], v2, s[8:11], s58 offen offset:2048 sc1
v_mfma_f32_32x32x16_bf16 v[160:175], a[216:219], v[92:95], v[160:175]
ds_write_b128 v4, v[136:139] offset:2048
v_mfma_f32_32x32x16_bf16 v[176:191], a[220:223], v[92:95], v[176:191]
s_waitcnt vmcnt(11)
buffer_load_dwordx4 v[92:95], v2, s[8:11], s58 offen offset:3072 sc1
v_mfma_f32_32x32x16_bf16 v[160:175], a[224:227], v[96:99], v[160:175]
ds_write_b128 v4, v[140:143] offset:3072
v_mfma_f32_32x32x16_bf16 v[176:191], a[228:231], v[96:99], v[176:191]
s_waitcnt vmcnt(11)
s_add_u32 s58, s34, 4096
buffer_load_dwordx4 v[96:99], v2, s[8:11], s58 offen offset:0 sc1
v_mfma_f32_32x32x16_bf16 v[160:175], a[232:235], v[100:103], v[160:175]
ds_write_b128 v3, v[144:147] offset:16384
v_mfma_f32_32x32x16_bf16 v[176:191], a[236:239], v[100:103], v[176:191]
s_waitcnt vmcnt(10)
buffer_load_dwordx4 v[100:103], v2, s[8:11], s58 offen offset:1024 sc1
v_mfma_f32_32x32x16_bf16 v[160:175], a[240:243], v[104:107], v[160:175]
ds_write_b128 v3, v[148:151] offset:17408
v_mfma_f32_32x32x16_bf16 v[176:191], a[244:247], v[104:107], v[176:191]
s_waitcnt vmcnt(10)
buffer_load_dwordx4 v[104:107], v2, s[8:11], s58 offen offset:2048 sc1
v_mfma_f32_32x32x16_bf16 v[160:175], a[248:251], v[108:111], v[160:175]
ds_write_b128 v4, v[152:155] offset:18432
v_mfma_f32_32x32x16_bf16 v[176:191], a[252:255], v[108:111], v[176:191]
s_waitcnt vmcnt(10)
s_add_u32 s58, s35, 4096
buffer_load_dwordx4 v[108:111], v2, s[8:11], s58 offen offset:0 sc1
v_mfma_f32_32x32x16_bf16 v[160:175], a[0:3], v[64:67], v[160:175]
ds_write_b128 v4, v[156:159] offset:19456
v_mfma_f32_32x32x16_bf16 v[176:191], a[4:7], v[64:67], v[176:191]
s_waitcnt vmcnt(10)
buffer_load_dwordx4 v[64:67], v2, s[8:11], s58 offen offset:1024 sc1
v_mfma_f32_32x32x16_bf16 v[160:175], a[8:11], v[68:71], v[160:175]
v_mfma_f32_32x32x16_bf16 v[176:191], a[12:15], v[68:71], v[176:191]
s_waitcnt vmcnt(10)
buffer_load_dwordx4 v[68:71], v2, s[8:11], s58 offen offset:2048 sc1
v_mfma_f32_32x32x16_bf16 v[160:175], a[16:19], v[72:75], v[160:175]
s_waitcnt lgkmcnt(0)
s_barrier
ds_read_b128 v[192:195], v5 offset:0
ds_read_b128 v[196:199], v5 offset:512
v_mfma_f32_32x32x16_bf16 v[176:191], a[20:23], v[72:75], v[176:191]
s_waitcnt vmcnt(10)
s_add_u32 s58, s36, 4096
buffer_load_dwordx4 v[72:75], v2, s[8:11], s58 offen offset:0 sc1
ds_read_b128 v[200:203], v5 offset:4096
ds_read_b128 v[204:207], v5 offset:4608
v_mfma_f32_32x32x16_bf16 v[160:175], a[24:27], v[76:79], v[160:175]
ds_read_b128 v[208:211], v5 offset:8192
ds_read_b128 v[212:215], v5 offset:8704
ds_read_b128 v[216:219], v5 offset:12288
v_mfma_f32_32x32x16_bf16 v[176:191], a[28:31], v[76:79], v[176:191]
s_waitcnt vmcnt(10)
buffer_load_dwordx4 v[76:79], v2, s[8:11], s58 offen offset:1024 sc1
ds_read_b128 v[220:223], v5 offset:12800
s_waitcnt lgkmcnt(4)
v_add_f32_e64 v192, v192, v200
v_mfma_f32_32x32x16_bf16 v[160:175], a[32:35], v[80:83], v[160:175]
v_add_f32 v193, v193, v201
v_add_f32 v194, v194, v202
v_add_f32 v195, v195, v203
v_add_f32 v196, v196, v204
v_add_f32 v197, v197, v205
v_add_f32 v198, v198, v206
v_mfma_f32_32x32x16_bf16 v[176:191], a[36:39], v[80:83], v[176:191]
s_waitcnt vmcnt(10)
buffer_load_dwordx4 v[80:83], v2, s[8:11], s58 offen offset:2048 sc1
v_add_f32 v199, v199, v207
v_lshlrev_b32_e64 v200, 16, v24
v_and_b32 v201, 0xffff0000, v24
v_lshlrev_b32_e64 v202, 16, v25
v_and_b32 v203, 0xffff0000, v25
v_mfma_f32_32x32x16_bf16 v[160:175], a[40:43], v[84:87], v[160:175]
v_lshlrev_b32_e64 v204, 16, v26
v_and_b32 v205, 0xffff0000, v26
v_lshlrev_b32_e64 v206, 16, v27
v_and_b32 v207, 0xffff0000, v27
v_add_f32_e64 v192, v192, v200
v_add_f32 v193, v193, v201
v_mfma_f32_32x32x16_bf16 v[176:191], a[44:47], v[84:87], v[176:191]
s_waitcnt vmcnt(10)
s_add_u32 s58, s37, 4096
buffer_load_dwordx4 v[84:87], v2, s[8:11], s58 offen offset:0 sc1
v_add_f32 v194, v194, v202
v_add_f32 v195, v195, v203
v_add_f32 v196, v196, v204
v_add_f32 v197, v197, v205
v_add_f32_e64 v198, v198, v206
v_mfma_f32_32x32x16_bf16 v[160:175], a[48:51], v[88:91], v[160:175]
v_add_f32 v199, v199, v207
s_waitcnt lgkmcnt(0)
v_add_f32 v208, v208, v216
v_add_f32 v209, v209, v217
v_add_f32 v210, v210, v218
v_add_f32 v211, v211, v219
v_mfma_f32_32x32x16_bf16 v[176:191], a[52:55], v[88:91], v[176:191]
s_waitcnt vmcnt(10)
buffer_load_dwordx4 v[88:91], v2, s[8:11], s58 offen offset:1024 sc1
v_add_f32 v212, v212, v220
v_add_f32 v213, v213, v221
v_add_f32 v214, v214, v222
v_add_f32 v215, v215, v223
v_add_f32 v192, v192, v208
v_mfma_f32_32x32x16_bf16 v[160:175], a[56:59], v[92:95], v[160:175]
v_add_f32 v193, v193, v209
v_add_f32 v194, v194, v210
v_add_f32 v195, v195, v211
v_add_f32 v196, v196, v212
v_add_f32 v197, v197, v213
v_add_f32 v198, v198, v214
v_mfma_f32_32x32x16_bf16 v[176:191], a[60:63], v[92:95], v[176:191]
s_waitcnt vmcnt(10)
buffer_load_dwordx4 v[92:95], v2, s[8:11], s58 offen offset:2048 sc1
v_add_f32 v199, v199, v215
v_cvt_pk_bf16_f32 v24, v192, v193
v_cvt_pk_bf16_f32 v25, v194, v195
v_cvt_pk_bf16_f32 v26, v196, v197
v_cvt_pk_bf16_f32 v27, v198, v199
v_mfma_f32_32x32x16_bf16 v[160:175], a[64:67], v[96:99], v[160:175]
s_add_u32 s32, s57, 32768
buffer_store_dwordx4 v[24:27], v7, s[20:23], s32 offen
v_mfma_f32_32x32x16_bf16 v[176:191], a[68:71], v[96:99], v[176:191]
s_waitcnt vmcnt(11)
v_mfma_f32_32x32x16_bf16 v[160:175], a[72:75], v[100:103], v[160:175]
v_mfma_f32_32x32x16_bf16 v[176:191], a[76:79], v[100:103], v[176:191]
s_waitcnt vmcnt(10)
v_mfma_f32_32x32x16_bf16 v[160:175], a[80:83], v[104:107], v[160:175]
v_mfma_f32_32x32x16_bf16 v[176:191], a[84:87], v[104:107], v[176:191]
s_waitcnt vmcnt(9)
v_mfma_f32_32x32x16_bf16 v[160:175], a[88:91], v[108:111], v[160:175]
v_mfma_f32_32x32x16_bf16 v[176:191], a[92:95], v[108:111], v[176:191]
s_waitcnt vmcnt(8)
v_mfma_f32_32x32x16_bf16 v[160:175], a[96:99], v[64:67], v[160:175]
v_mfma_f32_32x32x16_bf16 v[176:191], a[100:103], v[64:67], v[176:191]
s_waitcnt vmcnt(7)
v_mfma_f32_32x32x16_bf16 v[160:175], a[104:107], v[68:71], v[160:175]
v_mfma_f32_32x32x16_bf16 v[176:191], a[108:111], v[68:71], v[176:191]
s_waitcnt vmcnt(6)
v_mfma_f32_32x32x16_bf16 v[160:175], a[112:115], v[72:75], v[160:175]
v_mfma_f32_32x32x16_bf16 v[176:191], a[116:119], v[72:75], v[176:191]
s_waitcnt vmcnt(5)
v_mfma_f32_32x32x16_bf16 v[160:175], a[120:123], v[76:79], v[160:175]
v_mfma_f32_32x32x16_bf16 v[176:191], a[124:127], v[76:79], v[176:191]
s_waitcnt vmcnt(4)
v_mfma_f32_32x32x16_bf16 v[160:175], a[128:131], v[80:83], v[160:175]
v_mfma_f32_32x32x16_bf16 v[176:191], a[132:135], v[80:83], v[176:191]
s_waitcnt vmcnt(3)
v_mfma_f32_32x32x16_bf16 v[160:175], a[136:139], v[84:87], v[160:175]
v_mfma_f32_32x32x16_bf16 v[176:191], a[140:143], v[84:87], v[176:191]
s_waitcnt vmcnt(2)
v_mfma_f32_32x32x16_bf16 v[160:175], a[144:147], v[88:91], v[160:175]
v_mfma_f32_32x32x16_bf16 v[176:191], a[148:151], v[88:91], v[176:191]
s_waitcnt vmcnt(1)
v_mfma_f32_32x32x16_bf16 v[160:175], a[152:155], v[92:95], v[160:175]
v_mfma_f32_32x32x16_bf16 v[176:191], a[156:159], v[92:95], v[176:191]
s_nop 10
ds_write_b128 v3, v[160:163] offset:32768
ds_write_b128 v3, v[164:167] offset:33792
ds_write_b128 v4, v[168:171] offset:34816
ds_write_b128 v4, v[172:175] offset:35840
ds_write_b128 v3, v[176:179] offset:49152
ds_write_b128 v3, v[180:183] offset:50176
ds_write_b128 v4, v[184:187] offset:51200
ds_write_b128 v4, v[188:191] offset:52224
s_waitcnt lgkmcnt(0)
s_barrier
ds_read_b128 v[192:195], v5 offset:32768
ds_read_b128 v[196:199], v5 offset:33280
ds_read_b128 v[200:203], v5 offset:36864
ds_read_b128 v[204:207], v5 offset:37376
ds_read_b128 v[208:211], v5 offset:40960
ds_read_b128 v[212:215], v5 offset:41472
ds_read_b128 v[216:219], v5 offset:45056
ds_read_b128 v[220:223], v5 offset:45568
s_waitcnt lgkmcnt(4)
v_pk_add_f32 v[192:193], v[192:193], v[200:201]
v_pk_add_f32 v[194:195], v[194:195], v[202:203]
v_pk_add_f32 v[196:197], v[196:197], v[204:205]
v_pk_add_f32 v[198:199], v[198:199], v[206:207]
v_lshlrev_b32 v200, 16, v20
v_and_b32 v201, 0xffff0000, v20
v_lshlrev_b32_e64 v202, 16, v21
v_and_b32 v203, 0xffff0000, v21
v_lshlrev_b32_e64 v204, 16, v22
v_and_b32 v205, 0xffff0000, v22
v_lshlrev_b32 v206, 16, v23
v_and_b32 v207, 0xffff0000, v23
v_pk_add_f32 v[192:193], v[192:193], v[200:201]
v_pk_add_f32 v[194:195], v[194:195], v[202:203]
v_pk_add_f32 v[196:197], v[196:197], v[204:205]
v_pk_add_f32 v[198:199], v[198:199], v[206:207]
s_waitcnt lgkmcnt(0)
v_pk_add_f32 v[208:209], v[208:209], v[216:217]
v_pk_add_f32 v[210:211], v[210:211], v[218:219]
v_pk_add_f32 v[212:213], v[212:213], v[220:221]
v_pk_add_f32 v[214:215], v[214:215], v[222:223]
v_pk_add_f32 v[192:193], v[192:193], v[208:209]
v_pk_add_f32 v[194:195], v[194:195], v[210:211]
v_pk_add_f32 v[196:197], v[196:197], v[212:213]
v_pk_add_f32 v[198:199], v[198:199], v[214:215]
v_cvt_pk_bf16_f32 v20, v192, v193
v_cvt_pk_bf16_f32 v21, v194, v195
v_cvt_pk_bf16_f32 v22, v196, v197
v_cvt_pk_bf16_f32 v23, v198, v199
s_add_u32 s32, s57, 0
buffer_store_dwordx4 v[20:23], v7, s[20:23], s32 offen
s_endpgm
s_nop 0
L_tag_spin:
s_sub_u32 s98, s98, 1
s_cbranch_scc1 L_tag_give
buffer_load_dword v170, v9, s[28:31], 0 offen sc1
s_waitcnt vmcnt(0)
v_readfirstlane_b32 s91, v170
s_nop 0
s_cmp_eq_u32 s91, 0
s_nop 1
s_cbranch_scc1 L_tag_spin
s_branch L_tag_ok
L_tag_give:
s_mov_b32 s98, 0
s_branch L_tag_ok
L_gb_spin:
s_sub_u32 s98, s98, 1
s_cbranch_scc1 L_gb_give
s_sleep 2
buffer_load_dword v170, v9, s[28:31], 0 offen sc1
s_waitcnt vmcnt(0)
v_readfirstlane_b32 s32, v170
s_nop 0
s_cmp_eq_u32 s32, s91
s_nop 1
s_cbranch_scc1 L_gb_same
s_mov_b32 s91, s32
v_mov_b32_e64 v176, s91
v_not_b32 v177, v176
buffer_store_dwordx4 v[176:179], v171, s[8:11], s75 offen sc1
s_nop 1
L_gb_same:
buffer_load_dwordx4 v[36:39], v2, s[8:11], s75 offen offset:0 sc1
buffer_load_dwordx4 v[40:43], v2, s[8:11], s75 offen offset:1024 sc1
buffer_load_dwordx4 v[44:47], v2, s[8:11], s75 offen offset:2048 sc1
buffer_load_dwordx4 v[48:51], v2, s[8:11], s75 offen offset:3072 sc1
buffer_load_dword v10, v172, s[8:11], s77 offen offset:8 sc1
s_waitcnt vmcnt(0)
s_not_b32 s32, s91
v_xor_b32 v36, s91, v36
v_xor_b32 v37, s32, v37
v_xor_b32 v40, s91, v40
v_xor_b32 v41, s32, v41
v_xor_b32 v44, s91, v44
v_xor_b32 v45, s32, v45
v_xor_b32 v48, s91, v48
v_xor_b32 v49, s32, v49
v_or3_b32 v36, v36, v37, v40
v_or3_b32 v44, v44, v45, v41
v_or3_b32 v36, v36, v48, v49
v_or_b32_e64 v36, v36, v44
v_cmp_ne_u32 vcc, 0, v36
s_nop 3
s_cbranch_vccnz L_gb_spin
s_branch L_gb_ok
L_gb_give:
s_mov_b32 s98, 0
s_branch L_gb_ok
L_alt0:
s_nop 4
buffer_store_dwordx4 v[148:151], v2, s[8:11], s54 offen sc1
s_nop 0
s_branch L_back0
L_alt1:
s_nop 4
buffer_store_dwordx4 v[144:147], v2, s[8:11], s53 offen sc1
s_nop 0
s_branch L_back1
L_spin2:
s_sub_u32 s98, s98, 1
s_cbranch_scc1 L_give2
buffer_load_dword v10, v153, s[8:11], s86 offen sc1
s_waitcnt vmcnt(0)
v_cmp_gt_u32 vcc, 1, v10
s_nop 0
s_and_b32 s99, vcc_lo, 0xffffffff
s_nop 1
s_cbranch_scc1 L_spin2
s_branch L_back2
L_give2:
s_mov_b32 s98, 0
s_branch L_back2
L_spin3:
s_sub_u32 s98, s98, 1
s_cbranch_scc1 L_give3
buffer_load_dword v10, v153, s[8:11], s86 offen sc1
s_waitcnt vmcnt(1)
v_cmp_gt_u32 vcc, 2, v157
s_nop 0
s_and_b32 s99, vcc_lo, 0xffffffff
s_nop 1
s_cbranch_scc0 L_back3
buffer_load_dword v157, v153, s[8:11], s86 offen sc1
s_waitcnt vmcnt(1)
v_cmp_gt_u32 vcc, 2, v10
s_nop 0
s_and_b32 s99, vcc_lo, 0xffffffff
s_nop 1
s_cbranch_scc1 L_spin3
s_branch L_back3
L_give3:
s_mov_b32 s98, 0
s_branch L_back3
L_alt4:
s_nop 4
buffer_store_dwordx4 v[20:23], v154, s[8:11], s58 offen sc1
s_nop 0
s_branch L_back4
L_alt5:
s_nop 4
buffer_store_dwordx4 v[24:27], v154, s[8:11], s58 offen sc1
s_nop 0
s_branch L_back5
L_alt6:
s_nop 4
buffer_store_dword v224, v155, s[8:11], s58 offen sc1
s_branch L_back6
L_spin7:
s_sub_u32 s98, s98, 1
s_cbranch_scc1 L_give7
buffer_load_dword v10, v242, s[8:11], s86 offen sc1
s_waitcnt vmcnt(1)
v_cmp_gt_u32 vcc, 1, v20
s_nop 0
s_and_b32 s99, vcc_lo, 0xffff
s_nop 1
s_cbranch_scc0 L_back7
buffer_load_dword v20, v242, s[8:11], s86 offen sc1
s_waitcnt vmcnt(1)
v_cmp_gt_u32 vcc, 1, v10
s_nop 0
s_and_b32 s99, vcc_lo, 0xffff
s_nop 1
s_cbranch_scc1 L_spin7
s_branch L_back7
L_give7:
s_mov_b32 s98, 0
s_branch L_back7
L_spin8:
s_sub_u32 s98, s98, 1
s_cbranch_scc1 L_give8
buffer_load_dword v10, v115, s[8:11], s86 offen sc1
s_waitcnt vmcnt(0)
v_cmp_gt_u32 vcc, 1, v10
s_nop 0
s_and_b32 s99, vcc_lo, 0xff
s_nop 1
s_cbranch_scc1 L_spin8
s_branch L_back8
L_give8:
s_mov_b32 s98, 0
s_branch L_back8
L_spin9:
s_sub_u32 s98, s98, 1
s_cbranch_scc1 L_give9
buffer_load_dword v10, v115, s[8:11], s86 offen sc1
s_waitcnt vmcnt(0)
v_cmp_gt_u32 vcc, 2, v10
s_nop 0
s_and_b32 s99, vcc_lo, 0xff
s_nop 1
s_cbranch_scc1 L_spin9
s_branch L_back9
L_give9:
s_mov_b32 s98, 0
s_branch L_back9
L_alt10:
s_nop 4
buffer_store_dwordx4 v[24:27], v2, s[8:11], s32 offen sc1
s_nop 0
s_branch L_back10
L_alt11:
s_nop 4
buffer_store_dword v224, v6, s[8:11], s32 offen sc1
s_branch L_back11
L_spin12:
s_sub_u32 s98, s98, 1
s_cbranch_scc1 L_give12
buffer_load_dword v10, v115, s[8:11], s86 offen sc1
s_waitcnt vmcnt(0)
v_cmp_gt_u32 vcc, 1, v10
s_nop 0
s_and_b32 s99, vcc_lo, 0xffffffff
s_nop 1
s_cbranch_scc1 L_spin12
s_branch L_back12
L_give12:
s_mov_b32 s98, 0
s_branch L_back12
L_alt13:
s_nop 4
buffer_store_dwordx4 v[20:23], v2, s[8:11], s32 offen sc1
s_nop 0
s_branch L_back13
L_alt14:
s_nop 4
buffer_store_dword v224, v6, s[8:11], s32 offen sc1
s_branch L_back14
L_spin15:
s_sub_u32 s98, s98, 1
s_cbranch_scc1 L_give15
buffer_load_dword v10, v115, s[8:11], s86 offen sc1
s_waitcnt vmcnt(0)
v_cmp_gt_u32 vcc, 2, v10
s_nop 0
s_and_b32 s99, vcc_lo, 0xffffffff
s_nop 1
s_cbranch_scc1 L_spin15
s_branch L_back15
L_give15:
s_mov_b32 s98, 0
s_branch L_back15
L_spin16:
s_sub_u32 s98, s98, 1
s_cbranch_scc1 L_give16
buffer_load_dword v10, v115, s[8:11], s86 offen sc1
s_waitcnt vmcnt(0)
v_cmp_gt_u32 vcc, s50, v10
s_nop 0
s_and_b32 s99, vcc_lo, 0xffff
s_nop 1
s_cbranch_scc1 L_spin16
s_branch L_back16
L_give16:
s_mov_b32 s98, 0
s_branch L_back16
L_alt17:
s_nop 4
buffer_store_dwordx4 v[148:151], v2, s[8:11], s54 offen sc1
s_nop 0
s_branch L_back17
L_alt18:
s_nop 4
buffer_store_dwordx4 v[144:147], v2, s[8:11], s53 offen sc1
s_nop 0
s_branch L_back18
L_spin19:
s_sub_u32 s98, s98, 1
s_cbranch_scc1 L_give19
buffer_load_dword v10, v153, s[8:11], s86 offen sc1
s_waitcnt vmcnt(0)
v_cmp_gt_u32 vcc, 1, v10
s_nop 0
s_and_b32 s99, vcc_lo, 0xffffffff
s_nop 1
s_cbranch_scc1 L_spin19
s_branch L_back19
L_give19:
s_mov_b32 s98, 0
s_branch L_back19
L_spin20:
s_sub_u32 s98, s98, 1
s_cbranch_scc1 L_give20
buffer_load_dword v10, v153, s[8:11], s86 offen sc1
s_waitcnt vmcnt(1)
v_cmp_gt_u32 vcc, 2, v157
s_nop 0
s_and_b32 s99, vcc_lo, 0xffffffff
s_nop 1
s_cbranch_scc0 L_back20
buffer_load_dword v157, v153, s[8:11], s86 offen sc1
s_waitcnt vmcnt(1)
v_cmp_gt_u32 vcc, 2, v10
s_nop 0
s_and_b32 s99, vcc_lo, 0xffffffff
s_nop 1
s_cbranch_scc1 L_spin20
s_branch L_back20
L_give20:
s_mov_b32 s98, 0
s_branch L_back20
L_alt21:
s_nop 4
buffer_store_dwordx4 v[20:23], v154, s[8:11], s58 offen sc1
s_nop 0
s_branch L_back21
L_alt22:
s_nop 4
buffer_store_dwordx4 v[24:27], v154, s[8:11], s58 offen sc1
s_nop 0
s_branch L_back22
L_alt23:
s_nop 4
buffer_store_dword v224, v155, s[8:11], s58 offen sc1
s_branch L_back23
L_spin24:
s_sub_u32 s98, s98, 1
s_cbranch_scc1 L_give24
buffer_load_dword v10, v242, s[8:11], s86 offen sc1
s_waitcnt vmcnt(1)
v_cmp_gt_u32 vcc, 1, v20
s_nop 0
s_and_b32 s99, vcc_lo, 0xffff
s_nop 1
s_cbranch_scc0 L_back24
buffer_load_dword v20, v242, s[8:11], s86 offen sc1
s_waitcnt vmcnt(1)
v_cmp_gt_u32 vcc, 1, v10
s_nop 0
s_and_b32 s99, vcc_lo, 0xffff
s_nop 1
s_cbranch_scc1 L_spin24
s_branch L_back24
L_give24:
s_mov_b32 s98, 0
s_branch L_back24
L_spin25:
s_sub_u32 s98, s98, 1
s_cbranch_scc1 L_give25
buffer_load_dword v10, v115, s[8:11], s86 offen sc1
s_waitcnt vmcnt(0)
v_cmp_gt_u32 vcc, 1, v10
s_nop 0
s_and_b32 s99, vcc_lo, 0xff
s_nop 1
s_cbranch_scc1 L_spin25
s_branch L_back25
L_give25:
s_mov_b32 s98, 0
s_branch L_back25
L_spin26:
s_sub_u32 s98, s98, 1
s_cbranch_scc1 L_give26
buffer_load_dword v10, v115, s[8:11], s86 offen sc1
s_waitcnt vmcnt(0)
v_cmp_gt_u32 vcc, 2, v10
s_nop 0
s_and_b32 s99, vcc_lo, 0xff
s_nop 1
s_cbranch_scc1 L_spin26
s_branch L_back26
L_give26:
s_mov_b32 s98, 0
s_branch L_back26
L_end:
s_endpgm
.section .rodata,"a"
.p2align 6
.amdhsa_kernel interleave_layers__sliding_local_dilated__swiglu_ffn__prompt_kernel
  .amdhsa_next_free_vgpr 512
  .amdhsa_next_free_sgpr 102
  .amdhsa_accum_offset 256
  .amdhsa_group_segment_fixed_size 0
  .amdhsa_kernarg_size 80
  .amdhsa_user_sgpr_count 2
  .amdhsa_user_sgpr_kernarg_segment_ptr 1
  .amdhsa_system_sgpr_workgroup_id_x 1
.end_amdhsa_kernel
```
